```python
import torch

def _softmax(x, axis=-1):
    return torch.softmax(x, dim=axis)
def _gelu(x):
    return torch.nn.functional.gelu(x, approximate="tanh")
def _silu(x):
    return torch.nn.functional.silu(x)
def _sigmoid(x):
    return torch.sigmoid(x)
def _layernorm(x, axis=-1, eps=1e-5):
    m = x.mean(dim=axis, keepdim=True)
    v = x.var(dim=axis, keepdim=True, unbiased=False)
    return (x - m) / torch.sqrt(v + eps)
def _scatter_add(tgt, idx, src, axis=0):
    return tgt.clone().index_add_(axis, idx, src)
def _segment_sum(src, seg, n):
    out = torch.zeros((n,) + src.shape[1:], dtype=src.dtype)
    return out.index_add_(0, seg, src)
def _pad(x, pw):
    flat = tuple(v for pair in reversed(pw) for v in pair)
    return torch.nn.functional.pad(x, flat)

kernel_name = 'concat_heads__gqa_block_cached__gqa_block_cached__near_ridge'

def setup_inputs():

    _w = (lambda a: (lambda t: t.to(torch.bfloat16) if t.is_floating_point() else t)(torch.as_tensor(a)))
    def _A_setup():
        B, Sq, D = 16, 48, 512
        Hq, Hkv, Sk, Dh = 32, 8, 512, 128
        assert Hq % Hkv == 0, (Hq, Hkv)
        return {
            "x": _w((lambda *s: torch.randn(*s, dtype=torch.bfloat16) * 0.8)(B, Sq, D)),
            "k_cache": _w((lambda *s: torch.randn(*s, dtype=torch.bfloat16) * 0.8)(B, Hkv, Sk, Dh)),
            "v_cache": _w((lambda *s: torch.randn(*s, dtype=torch.bfloat16) * 0.05)(B, Hkv, Sk, Dh)),
            "wq": _w((lambda *s: torch.randn(*s, dtype=torch.bfloat16) * 0.8)(D, Hq * Dh) * (D ** -0.5)),
            "wo": _w((lambda *s: torch.randn(*s, dtype=torch.bfloat16) * 0.05)(Hq * Dh, D) * ((Hq * Dh) ** -0.5)),
        }
    _A_in = _A_setup()

    def _B_setup():
        B, Sq, D = 16, 48, 512
        Hq, Hkv, Sk, Dh = 32, 8, 512, 128
        assert Hq % Hkv == 0, (Hq, Hkv)
        return {
            "x": _w((lambda *s: torch.randn(*s, dtype=torch.bfloat16) * 0.8)(B, Sq, D)),
            "k_cache": _w((lambda *s: torch.randn(*s, dtype=torch.bfloat16) * 0.8)(B, Hkv, Sk, Dh)),
            "v_cache": _w((lambda *s: torch.randn(*s, dtype=torch.bfloat16) * 0.05)(B, Hkv, Sk, Dh)),
            "wq": _w((lambda *s: torch.randn(*s, dtype=torch.bfloat16) * 0.8)(D, Hq * Dh) * (D ** -0.5)),
            "wo": _w((lambda *s: torch.randn(*s, dtype=torch.bfloat16) * 0.05)(Hq * Dh, D) * ((Hq * Dh) ** -0.5)),
        }
    _B_in = _B_setup()

    return {
        "A_x": _A_in["x"],
        "A_k_cache": _A_in["k_cache"],
        "A_v_cache": _A_in["v_cache"],
        "A_wq": _A_in["wq"],
        "A_wo": _A_in["wo"],
        "B_x": _B_in["x"],
        "B_k_cache": _B_in["k_cache"],
        "B_v_cache": _B_in["v_cache"],
        "B_wq": _B_in["wq"],
        "B_wo": _B_in["wo"],
    }

def reference(A_x, A_k_cache, A_v_cache, A_wq, A_wo, B_x, B_k_cache, B_v_cache, B_wq, B_wo):
    def _A_ref(x, k_cache, v_cache, wq, wo):
        B, Sq, D = x.shape
        Hq, Dh = 32, 128
        Hkv = k_cache.shape[1]
        rep = Hq // Hkv
        q = (lambda x, *d: x.permute(*d))((x @ wq).reshape(B, Sq, Hq, Dh), 0, 2, 1, 3)
        k = (lambda x, n, axis: torch.repeat_interleave(x, n, dim=axis))(k_cache, rep, axis=1)
        v = (lambda x, n, axis: torch.repeat_interleave(x, n, dim=axis))(v_cache, rep, axis=1)
        scores = torch.einsum("bhqd,bhkd->bhqk", q, k) * (Dh ** -0.5)
        p = _softmax(scores, axis=-1)
        o = torch.einsum("bhqk,bhkd->bhqd", p, v)
        return (lambda x, *d: x.permute(*d))(o, 0, 2, 1, 3).reshape(B, Sq, Hq * Dh) @ wo

    def _B_ref(x, k_cache, v_cache, wq, wo):
        B, Sq, D = x.shape
        Hq, Dh = 32, 128
        Hkv = k_cache.shape[1]
        rep = Hq // Hkv
        q = (lambda x, *d: x.permute(*d))((x @ wq).reshape(B, Sq, Hq, Dh), 0, 2, 1, 3)
        k = (lambda x, n, axis: torch.repeat_interleave(x, n, dim=axis))(k_cache, rep, axis=1)
        v = (lambda x, n, axis: torch.repeat_interleave(x, n, dim=axis))(v_cache, rep, axis=1)
        scores = torch.einsum("bhqd,bhkd->bhqk", q, k) * (Dh ** -0.5)
        p = _softmax(scores, axis=-1)
        o = torch.einsum("bhqk,bhkd->bhqd", p, v)
        return (lambda x, *d: x.permute(*d))(o, 0, 2, 1, 3).reshape(B, Sq, Hq * Dh) @ wo

    a = _A_ref(A_x, A_k_cache, A_v_cache, A_wq, A_wo)
    b = _B_ref(B_x, B_k_cache, B_v_cache, B_wq, B_wo)
    return torch.concatenate([a, b], axis=-1)
```

```asm
; @launch kernel=concat_heads__gqa_block_cached__gqa_block_cached__near_ridge_kernel grid=(256,1,1) block=(256,1,1) lds=163840
; @launch kernel=reduce_kernel grid=(384,1,1) block=(256,1,1) lds=0
.amdgcn_target "amdgcn-amd-amdhsa--gfx950"
.text
.globl concat_heads__gqa_block_cached__gqa_block_cached__near_ridge_kernel
.p2align 8
.type concat_heads__gqa_block_cached__gqa_block_cached__near_ridge_kernel,@function
concat_heads__gqa_block_cached__gqa_block_cached__near_ridge_kernel:
    s_cmp_ge_u32 s2, 256
    s_cbranch_scc1 L_exit
    s_load_dwordx16 s[16:31], s[0:1], 0
    s_load_dwordx8 s[32:39], s[0:1], 64
    s_load_dwordx2 s[40:41], s[0:1], 96
    s_bfe_u32 s72, s2, 0x10002
    s_and_b32 s70, s2, 3
    s_lshl_b32 s70, s70, 1
    s_bfe_u32 s79, s2, 0x10003
    s_or_b32 s70, s70, s79
    s_lshr_b32 s71, s2, 4
    v_lshrrev_b32 v248, 6, v0
    s_nop 0
    v_readfirstlane_b32 s73, v248
    v_and_b32 v1, 15, v0
    v_bfe_u32 v2, v0, 4, 2
    s_mov_b32 s82, 0x5040100
    s_mov_b32 s83, 0x7060302
    s_mov_b32 s86, 0x3e0293ee
    s_mov_b32 s87, 0x41800000
    v_lshlrev_b32 v248, 4, v1
    v_lshl_add_u32 v3, v2, 16, v248
    v_add_u32 v4, 4, v1
    v_and_b32 v4, 15, v4
    v_lshlrev_b32 v5, 10, v1
    v_lshl_add_u32 v30, v2, 13, v248
    v_add_u32 v31, 0x1000, v30
    v_add_u32 v249, 4, v2
    v_and_b32 v249, 15, v249
    v_xor_b32 v249, v249, v1
    v_lshlrev_b32 v249, 4, v249
    v_lshl_add_u32 v12, v2, 8, v249
    v_add_u32 v249, 8, v2
    v_and_b32 v249, 15, v249
    v_xor_b32 v249, v249, v1
    v_lshlrev_b32 v249, 4, v249
    v_lshl_add_u32 v13, v2, 8, v249
    v_add_u32 v249, 12, v2
    v_and_b32 v249, 15, v249
    v_xor_b32 v249, v249, v1
    v_lshlrev_b32 v249, 4, v249
    v_lshl_add_u32 v14, v2, 8, v249
    v_add_u32 v249, 16, v2
    v_and_b32 v249, 15, v249
    v_xor_b32 v249, v249, v1
    v_lshlrev_b32 v249, 4, v249
    v_lshl_add_u32 v15, v2, 8, v249
    v_add_u32 v249, 0, v2
    v_lshlrev_b32 v249, 1, v249
    v_xor_b32 v249, v249, v1
    v_lshlrev_b32 v249, 4, v249
    v_lshl_add_u32 v16, v2, 8, v249
    v_add_u32 v249, 4, v2
    v_lshlrev_b32 v249, 1, v249
    v_xor_b32 v249, v249, v1
    v_lshlrev_b32 v249, 4, v249
    v_lshl_add_u32 v17, v2, 8, v249
    v_add_u32 v250, 4, v1
    v_and_b32 v250, 15, v250
    v_lshl_add_u32 v249, v2, 2, 0
    v_xor_b32 v249, v249, v250
    v_lshlrev_b32 v249, 4, v249
    v_lshl_add_u32 v18, v1, 8, v249
    v_lshl_add_u32 v249, v2, 2, 1
    v_xor_b32 v249, v249, v250
    v_lshlrev_b32 v249, 4, v249
    v_lshl_add_u32 v19, v1, 8, v249
    v_lshl_add_u32 v249, v2, 2, 2
    v_xor_b32 v249, v249, v250
    v_lshlrev_b32 v249, 4, v249
    v_lshl_add_u32 v20, v1, 8, v249
    v_lshl_add_u32 v249, v2, 2, 3
    v_xor_b32 v249, v249, v250
    v_lshlrev_b32 v249, 4, v249
    v_lshl_add_u32 v21, v1, 8, v249
    v_lshrrev_b32 v251, 2, v1
    v_lshl_add_u32 v252, v2, 2, v251
    v_and_b32 v253, 7, v252
    v_and_b32 v254, 3, v1
    v_lshlrev_b32 v254, 3, v254
    v_lshl_add_u32 v254, v252, 8, v254
    v_xor_b32 v249, 0, v253
    v_lshl_add_u32 v22, v249, 5, v254
    v_xor_b32 v249, 1, v253
    v_lshl_add_u32 v23, v249, 5, v254
    v_xor_b32 v249, 2, v253
    v_lshl_add_u32 v24, v249, 5, v254
    v_xor_b32 v249, 3, v253
    v_lshl_add_u32 v25, v249, 5, v254
    v_xor_b32 v249, 4, v253
    v_lshl_add_u32 v26, v249, 5, v254
    v_xor_b32 v249, 5, v253
    v_lshl_add_u32 v27, v249, 5, v254
    v_xor_b32 v249, 6, v253
    v_lshl_add_u32 v28, v249, 5, v254
    v_xor_b32 v249, 7, v253
    v_lshl_add_u32 v29, v249, 5, v254
    s_waitcnt lgkmcnt(0)
    s_cmp_eq_u32 s72, 0
    s_cselect_b64 s[44:45], s[16:17], s[26:27]
    s_mov_b32 s46, 0xc0000
    s_mov_b32 s47, 0x20000
    s_cselect_b64 s[48:49], s[18:19], s[28:29]
    s_mov_b32 s50, 0x1000000
    s_mov_b32 s51, 0x20000
    s_cselect_b64 s[52:53], s[20:21], s[30:31]
    s_mov_b32 s54, 0x1000000
    s_mov_b32 s55, 0x20000
    s_cselect_b64 s[56:57], s[22:23], s[32:33]
    s_mov_b32 s58, 0x400000
    s_mov_b32 s59, 0x20000
    s_cselect_b64 s[60:61], s[24:25], s[34:35]
    s_mov_b32 s62, 0x400000
    s_mov_b32 s63, 0x20000
    s_mov_b64 s[64:65], s[40:41]
    s_mov_b32 s66, 0xc00000
    s_mov_b32 s67, 0x20000
    s_mul_i32 s74, s71, 0xc000
    s_add_u32 s75, s74, 0x4000
    s_add_u32 s76, s74, 0x8000
    s_lshl_b32 s79, s70, 2
    s_add_u32 s79, s79, s73
    s_lshl_b32 s88, s79, 8
    s_lshl_b32 s84, s73, 12
    s_lshl_b32 s79, s71, 3
    s_add_u32 s79, s79, s70
    s_lshl_b32 s78, s79, 17
    s_add_u32 s78, s78, s84
    s_lshl_b32 s80, s72, 7
    s_add_u32 s79, s79, s80
    s_mul_i32 s85, s79, 0xc000
    s_mul_i32 s80, s73, 0x3000
    s_add_u32 s85, s85, s80
    v_and_b32 v32, 63, v0
    v_lshrrev_b32 v33, 2, v32
    v_and_b32 v34, 3, v32
    v_lshlrev_b32 v34, 4, v34
    v_lshl_add_u32 v9, v33, 10, v34
    v_lshlrev_b32 v34, 4, v2
    v_lshl_add_u32 v8, v1, 6, v34
    v_add_u32 v8, 0x1c000, v8
    s_add_u32 s79, s73, 0
    s_mul_i32 s80, s79, 43
    s_lshr_b32 s80, s80, 7
    s_mul_i32 s92, s80, 3
    s_sub_u32 s92, s79, s92
    s_lshl_b32 s79, s79, 10
    s_add_u32 m0, s79, 0x1c000
    s_add_u32 s80, s80, s71
    s_and_b32 s80, s80, 15
    s_lshl_b32 s80, s80, 6
    s_lshl_b32 s92, s92, 14
    s_add_u32 s80, s80, s92
    s_add_u32 s80, s80, s74
    buffer_load_dwordx4 v9, s[44:47], s80 offen lds
    s_add_u32 s79, s73, 4
    s_mul_i32 s80, s79, 43
    s_lshr_b32 s80, s80, 7
    s_mul_i32 s92, s80, 3
    s_sub_u32 s92, s79, s92
    s_lshl_b32 s79, s79, 10
    s_add_u32 m0, s79, 0x1c000
    s_add_u32 s80, s80, s71
    s_and_b32 s80, s80, 15
    s_lshl_b32 s80, s80, 6
    s_lshl_b32 s92, s92, 14
    s_add_u32 s80, s80, s92
    s_add_u32 s80, s80, s74
    buffer_load_dwordx4 v9, s[44:47], s80 offen lds
    s_add_u32 s79, s73, 8
    s_mul_i32 s80, s79, 43
    s_lshr_b32 s80, s80, 7
    s_mul_i32 s92, s80, 3
    s_sub_u32 s92, s79, s92
    s_lshl_b32 s79, s79, 10
    s_add_u32 m0, s79, 0x1c000
    s_add_u32 s80, s80, s71
    s_and_b32 s80, s80, 15
    s_lshl_b32 s80, s80, 6
    s_lshl_b32 s92, s92, 14
    s_add_u32 s80, s80, s92
    s_add_u32 s80, s80, s74
    buffer_load_dwordx4 v9, s[44:47], s80 offen lds
    s_add_u32 s89, s71, 0
    s_and_b32 s89, s89, 15
    s_lshl_b32 s89, s89, 18
    s_add_u32 s77, s88, s89
    buffer_load_dwordx4 v[64:67], v3, s[56:59], s77 offen
    s_add_u32 s77, s77, 0x2000
    buffer_load_dwordx4 v[68:71], v3, s[56:59], s77 offen
    s_add_u32 s77, s77, 0x2000
    buffer_load_dwordx4 v[72:75], v3, s[56:59], s77 offen
    s_add_u32 s77, s77, 0x2000
    buffer_load_dwordx4 v[76:79], v3, s[56:59], s77 offen
    s_add_u32 s77, s77, 0x2000
    buffer_load_dwordx4 v[80:83], v3, s[56:59], s77 offen
    s_add_u32 s77, s77, 0x2000
    buffer_load_dwordx4 v[84:87], v3, s[56:59], s77 offen
    s_add_u32 s77, s77, 0x2000
    buffer_load_dwordx4 v[88:91], v3, s[56:59], s77 offen
    s_add_u32 s77, s77, 0x2000
    buffer_load_dwordx4 v[92:95], v3, s[56:59], s77 offen
    s_add_u32 s79, s73, 12
    s_mul_i32 s80, s79, 43
    s_lshr_b32 s80, s80, 7
    s_mul_i32 s92, s80, 3
    s_sub_u32 s92, s79, s92
    s_lshl_b32 s79, s79, 10
    s_add_u32 m0, s79, 0x1c000
    s_add_u32 s80, s80, s71
    s_and_b32 s80, s80, 15
    s_lshl_b32 s80, s80, 6
    s_lshl_b32 s92, s92, 14
    s_add_u32 s80, s80, s92
    s_add_u32 s80, s80, s74
    buffer_load_dwordx4 v9, s[44:47], s80 offen lds
    s_add_u32 s79, s73, 16
    s_mul_i32 s80, s79, 43
    s_lshr_b32 s80, s80, 7
    s_mul_i32 s92, s80, 3
    s_sub_u32 s92, s79, s92
    s_lshl_b32 s79, s79, 10
    s_add_u32 m0, s79, 0x1c000
    s_add_u32 s80, s80, s71
    s_and_b32 s80, s80, 15
    s_lshl_b32 s80, s80, 6
    s_lshl_b32 s92, s92, 14
    s_add_u32 s80, s80, s92
    s_add_u32 s80, s80, s74
    buffer_load_dwordx4 v9, s[44:47], s80 offen lds
    s_add_u32 s79, s73, 20
    s_mul_i32 s80, s79, 43
    s_lshr_b32 s80, s80, 7
    s_mul_i32 s92, s80, 3
    s_sub_u32 s92, s79, s92
    s_lshl_b32 s79, s79, 10
    s_add_u32 m0, s79, 0x1c000
    s_add_u32 s80, s80, s71
    s_and_b32 s80, s80, 15
    s_lshl_b32 s80, s80, 6
    s_lshl_b32 s92, s92, 14
    s_add_u32 s80, s80, s92
    s_add_u32 s80, s80, s74
    buffer_load_dwordx4 v9, s[44:47], s80 offen lds
    s_add_u32 s79, s73, 24
    s_mul_i32 s80, s79, 43
    s_lshr_b32 s80, s80, 7
    s_mul_i32 s92, s80, 3
    s_sub_u32 s92, s79, s92
    s_lshl_b32 s79, s79, 10
    s_add_u32 m0, s79, 0x1c000
    s_add_u32 s80, s80, s71
    s_and_b32 s80, s80, 15
    s_lshl_b32 s80, s80, 6
    s_lshl_b32 s92, s92, 14
    s_add_u32 s80, s80, s92
    s_add_u32 s80, s80, s74
    buffer_load_dwordx4 v9, s[44:47], s80 offen lds
    s_add_u32 s79, s73, 28
    s_mul_i32 s80, s79, 43
    s_lshr_b32 s80, s80, 7
    s_mul_i32 s92, s80, 3
    s_sub_u32 s92, s79, s92
    s_lshl_b32 s79, s79, 10
    s_add_u32 m0, s79, 0x1c000
    s_add_u32 s80, s80, s71
    s_and_b32 s80, s80, 15
    s_lshl_b32 s80, s80, 6
    s_lshl_b32 s92, s92, 14
    s_add_u32 s80, s80, s92
    s_add_u32 s80, s80, s74
    buffer_load_dwordx4 v9, s[44:47], s80 offen lds
    s_add_u32 s79, s73, 32
    s_mul_i32 s80, s79, 43
    s_lshr_b32 s80, s80, 7
    s_mul_i32 s92, s80, 3
    s_sub_u32 s92, s79, s92
    s_lshl_b32 s79, s79, 10
    s_add_u32 m0, s79, 0x1c000
    s_add_u32 s80, s80, s71
    s_and_b32 s80, s80, 15
    s_lshl_b32 s80, s80, 6
    s_lshl_b32 s92, s92, 14
    s_add_u32 s80, s80, s92
    s_add_u32 s80, s80, s74
    buffer_load_dwordx4 v9, s[44:47], s80 offen lds
    s_add_u32 s79, s73, 36
    s_mul_i32 s80, s79, 43
    s_lshr_b32 s80, s80, 7
    s_mul_i32 s92, s80, 3
    s_sub_u32 s92, s79, s92
    s_lshl_b32 s79, s79, 10
    s_add_u32 m0, s79, 0x1c000
    s_add_u32 s80, s80, s71
    s_and_b32 s80, s80, 15
    s_lshl_b32 s80, s80, 6
    s_lshl_b32 s92, s92, 14
    s_add_u32 s80, s80, s92
    s_add_u32 s80, s80, s74
    buffer_load_dwordx4 v9, s[44:47], s80 offen lds
    s_add_u32 s79, s73, 40
    s_mul_i32 s80, s79, 43
    s_lshr_b32 s80, s80, 7
    s_mul_i32 s92, s80, 3
    s_sub_u32 s92, s79, s92
    s_lshl_b32 s79, s79, 10
    s_add_u32 m0, s79, 0x1c000
    s_add_u32 s80, s80, s71
    s_and_b32 s80, s80, 15
    s_lshl_b32 s80, s80, 6
    s_lshl_b32 s92, s92, 14
    s_add_u32 s80, s80, s92
    s_add_u32 s80, s80, s74
    buffer_load_dwordx4 v9, s[44:47], s80 offen lds
    s_add_u32 s79, s73, 44
    s_mul_i32 s80, s79, 43
    s_lshr_b32 s80, s80, 7
    s_mul_i32 s92, s80, 3
    s_sub_u32 s92, s79, s92
    s_lshl_b32 s79, s79, 10
    s_add_u32 m0, s79, 0x1c000
    s_add_u32 s80, s80, s71
    s_and_b32 s80, s80, 15
    s_lshl_b32 s80, s80, 6
    s_lshl_b32 s92, s92, 14
    s_add_u32 s80, s80, s92
    s_add_u32 s80, s80, s74
    buffer_load_dwordx4 v9, s[44:47], s80 offen lds
    s_add_u32 s89, s71, 1
    s_and_b32 s89, s89, 15
    s_lshl_b32 s89, s89, 18
    s_add_u32 s77, s88, s89
    buffer_load_dwordx4 v[96:99], v3, s[56:59], s77 offen
    s_add_u32 s77, s77, 0x2000
    buffer_load_dwordx4 v[100:103], v3, s[56:59], s77 offen
    s_add_u32 s77, s77, 0x2000
    buffer_load_dwordx4 v[104:107], v3, s[56:59], s77 offen
    s_add_u32 s77, s77, 0x2000
    buffer_load_dwordx4 v[108:111], v3, s[56:59], s77 offen
    s_add_u32 s77, s77, 0x2000
    buffer_load_dwordx4 v[112:115], v3, s[56:59], s77 offen
    s_add_u32 s77, s77, 0x2000
    buffer_load_dwordx4 v[116:119], v3, s[56:59], s77 offen
    s_add_u32 s77, s77, 0x2000
    buffer_load_dwordx4 v[120:123], v3, s[56:59], s77 offen
    s_add_u32 s77, s77, 0x2000
    buffer_load_dwordx4 v[124:127], v3, s[56:59], s77 offen
    s_waitcnt vmcnt(25)
    s_barrier
    ds_read_b128 a[96:99], v8
    ds_read_b128 a[100:103], v8 offset:1024
    ds_read_b128 a[104:107], v8 offset:2048
    ds_read_b128 a[108:111], v8 offset:3072
    ds_read_b128 a[112:115], v8 offset:4096
    ds_read_b128 a[116:119], v8 offset:5120
    s_waitcnt vmcnt(23)
    v_perm_b32 v32, v68, v64, s82
    s_waitcnt vmcnt(21)
    v_perm_b32 v33, v76, v72, s82
    s_waitcnt vmcnt(19)
    v_perm_b32 v34, v84, v80, s82
    s_waitcnt vmcnt(17)
    v_perm_b32 v35, v92, v88, s82
    v_perm_b32 v36, v68, v64, s83
    v_perm_b32 v37, v76, v72, s83
    v_perm_b32 v38, v84, v80, s83
    v_perm_b32 v39, v92, v88, s83
    v_perm_b32 v40, v69, v65, s82
    v_perm_b32 v41, v77, v73, s82
    v_perm_b32 v42, v85, v81, s82
    v_perm_b32 v43, v93, v89, s82
    v_perm_b32 v44, v69, v65, s83
    v_perm_b32 v45, v77, v73, s83
    v_perm_b32 v46, v85, v81, s83
    v_perm_b32 v47, v93, v89, s83
    v_perm_b32 v48, v70, v66, s82
    v_perm_b32 v49, v78, v74, s82
    v_perm_b32 v50, v86, v82, s82
    v_perm_b32 v51, v94, v90, s82
    v_perm_b32 v52, v70, v66, s83
    v_perm_b32 v53, v78, v74, s83
    v_perm_b32 v54, v86, v82, s83
    v_perm_b32 v55, v94, v90, s83
    v_perm_b32 v56, v71, v67, s82
    v_perm_b32 v57, v79, v75, s82
    v_perm_b32 v58, v87, v83, s82
    v_perm_b32 v59, v95, v91, s82
    v_perm_b32 v60, v71, v67, s83
    v_perm_b32 v61, v79, v75, s83
    v_perm_b32 v62, v87, v83, s83
    v_perm_b32 v63, v95, v91, s83
    s_add_u32 s89, s71, 2
    s_and_b32 s89, s89, 15
    s_lshl_b32 s89, s89, 18
    s_add_u32 s77, s88, s89
    buffer_load_dwordx4 v[128:131], v3, s[56:59], s77 offen
    s_add_u32 s77, s77, 0x2000
    buffer_load_dwordx4 v[132:135], v3, s[56:59], s77 offen
    s_add_u32 s77, s77, 0x2000
    buffer_load_dwordx4 v[136:139], v3, s[56:59], s77 offen
    s_add_u32 s77, s77, 0x2000
    buffer_load_dwordx4 v[140:143], v3, s[56:59], s77 offen
    s_add_u32 s77, s77, 0x2000
    buffer_load_dwordx4 v[144:147], v3, s[56:59], s77 offen
    s_add_u32 s77, s77, 0x2000
    buffer_load_dwordx4 v[148:151], v3, s[56:59], s77 offen
    s_add_u32 s77, s77, 0x2000
    buffer_load_dwordx4 v[152:155], v3, s[56:59], s77 offen
    s_add_u32 s77, s77, 0x2000
    buffer_load_dwordx4 v[156:159], v3, s[56:59], s77 offen
    ds_read_b128 a[120:123], v8 offset:6144
    ds_read_b128 a[124:127], v8 offset:7168
    ds_read_b128 a[128:131], v8 offset:8192
    s_waitcnt lgkmcnt(8)
    v_mfma_f32_16x16x32_bf16 a[0:3], v[32:35], a[96:99], 0
    s_waitcnt lgkmcnt(7)
    v_mfma_f32_16x16x32_bf16 a[4:7], v[32:35], a[100:103], 0
    s_waitcnt lgkmcnt(6)
    v_mfma_f32_16x16x32_bf16 a[8:11], v[32:35], a[104:107], 0
    s_waitcnt vmcnt(14)
    v_perm_b32 v32, v100, v96, s82
    s_waitcnt vmcnt(12)
    v_perm_b32 v33, v108, v104, s82
    s_waitcnt vmcnt(10)
    v_perm_b32 v34, v116, v112, s82
    s_waitcnt vmcnt(8)
    v_perm_b32 v35, v124, v120, s82
    v_mfma_f32_16x16x32_bf16 a[12:15], v[36:39], a[96:99], 0
    v_mfma_f32_16x16x32_bf16 a[16:19], v[36:39], a[100:103], 0
    v_mfma_f32_16x16x32_bf16 a[20:23], v[36:39], a[104:107], 0
    v_perm_b32 v36, v100, v96, s83
    v_perm_b32 v37, v108, v104, s83
    v_perm_b32 v38, v116, v112, s83
    v_perm_b32 v39, v124, v120, s83
    v_mfma_f32_16x16x32_bf16 a[24:27], v[40:43], a[96:99], 0
    v_mfma_f32_16x16x32_bf16 a[28:31], v[40:43], a[100:103], 0
    v_mfma_f32_16x16x32_bf16 a[32:35], v[40:43], a[104:107], 0
    v_perm_b32 v40, v101, v97, s82
    v_perm_b32 v41, v109, v105, s82
    v_perm_b32 v42, v117, v113, s82
    v_perm_b32 v43, v125, v121, s82
    v_mfma_f32_16x16x32_bf16 a[36:39], v[44:47], a[96:99], 0
    v_mfma_f32_16x16x32_bf16 a[40:43], v[44:47], a[100:103], 0
    v_mfma_f32_16x16x32_bf16 a[44:47], v[44:47], a[104:107], 0
    v_perm_b32 v44, v101, v97, s83
    v_perm_b32 v45, v109, v105, s83
    v_perm_b32 v46, v117, v113, s83
    v_perm_b32 v47, v125, v121, s83
    s_add_u32 s89, s71, 3
    s_and_b32 s89, s89, 15
    s_lshl_b32 s89, s89, 18
    s_add_u32 s77, s88, s89
    buffer_load_dwordx4 v[160:163], v3, s[56:59], s77 offen
    s_add_u32 s77, s77, 0x2000
    buffer_load_dwordx4 v[164:167], v3, s[56:59], s77 offen
    s_add_u32 s77, s77, 0x2000
    buffer_load_dwordx4 v[168:171], v3, s[56:59], s77 offen
    s_add_u32 s77, s77, 0x2000
    buffer_load_dwordx4 v[172:175], v3, s[56:59], s77 offen
    s_add_u32 s77, s77, 0x2000
    buffer_load_dwordx4 v[176:179], v3, s[56:59], s77 offen
    s_add_u32 s77, s77, 0x2000
    buffer_load_dwordx4 v[180:183], v3, s[56:59], s77 offen
    s_add_u32 s77, s77, 0x2000
    buffer_load_dwordx4 v[184:187], v3, s[56:59], s77 offen
    s_add_u32 s77, s77, 0x2000
    buffer_load_dwordx4 v[188:191], v3, s[56:59], s77 offen
    v_mfma_f32_16x16x32_bf16 a[48:51], v[48:51], a[96:99], 0
    v_mfma_f32_16x16x32_bf16 a[52:55], v[48:51], a[100:103], 0
    v_mfma_f32_16x16x32_bf16 a[56:59], v[48:51], a[104:107], 0
    v_perm_b32 v48, v102, v98, s82
    v_perm_b32 v49, v110, v106, s82
    v_perm_b32 v50, v118, v114, s82
    v_perm_b32 v51, v126, v122, s82
    v_mfma_f32_16x16x32_bf16 a[60:63], v[52:55], a[96:99], 0
    v_mfma_f32_16x16x32_bf16 a[64:67], v[52:55], a[100:103], 0
    v_mfma_f32_16x16x32_bf16 a[68:71], v[52:55], a[104:107], 0
    v_perm_b32 v52, v102, v98, s83
    v_perm_b32 v53, v110, v106, s83
    v_perm_b32 v54, v118, v114, s83
    v_perm_b32 v55, v126, v122, s83
    v_mfma_f32_16x16x32_bf16 a[72:75], v[56:59], a[96:99], 0
    v_mfma_f32_16x16x32_bf16 a[76:79], v[56:59], a[100:103], 0
    v_mfma_f32_16x16x32_bf16 a[80:83], v[56:59], a[104:107], 0
    v_perm_b32 v56, v103, v99, s82
    v_perm_b32 v57, v111, v107, s82
    v_perm_b32 v58, v119, v115, s82
    v_perm_b32 v59, v127, v123, s82
    v_mfma_f32_16x16x32_bf16 a[84:87], v[60:63], a[96:99], 0
    v_mfma_f32_16x16x32_bf16 a[88:91], v[60:63], a[100:103], 0
    v_mfma_f32_16x16x32_bf16 a[92:95], v[60:63], a[104:107], 0
    v_perm_b32 v60, v103, v99, s83
    v_perm_b32 v61, v111, v107, s83
    v_perm_b32 v62, v119, v115, s83
    v_perm_b32 v63, v127, v123, s83
    s_add_u32 s89, s71, 4
    s_and_b32 s89, s89, 15
    s_lshl_b32 s89, s89, 18
    s_add_u32 s77, s88, s89
    buffer_load_dwordx4 v[192:195], v3, s[56:59], s77 offen
    s_add_u32 s77, s77, 0x2000
    buffer_load_dwordx4 v[196:199], v3, s[56:59], s77 offen
    s_add_u32 s77, s77, 0x2000
    buffer_load_dwordx4 v[200:203], v3, s[56:59], s77 offen
    s_add_u32 s77, s77, 0x2000
    buffer_load_dwordx4 v[204:207], v3, s[56:59], s77 offen
    s_add_u32 s77, s77, 0x2000
    buffer_load_dwordx4 v[208:211], v3, s[56:59], s77 offen
    s_add_u32 s77, s77, 0x2000
    buffer_load_dwordx4 v[212:215], v3, s[56:59], s77 offen
    s_add_u32 s77, s77, 0x2000
    buffer_load_dwordx4 v[216:219], v3, s[56:59], s77 offen
    s_add_u32 s77, s77, 0x2000
    buffer_load_dwordx4 v[220:223], v3, s[56:59], s77 offen
    ds_read_b128 a[96:99], v8 offset:9216
    ds_read_b128 a[100:103], v8 offset:10240
    ds_read_b128 a[104:107], v8 offset:11264
    s_waitcnt lgkmcnt(8)
    v_mfma_f32_16x16x32_bf16 a[0:3], v[32:35], a[108:111], a[0:3]
    s_waitcnt lgkmcnt(7)
    v_mfma_f32_16x16x32_bf16 a[4:7], v[32:35], a[112:115], a[4:7]
    s_waitcnt lgkmcnt(6)
    v_mfma_f32_16x16x32_bf16 a[8:11], v[32:35], a[116:119], a[8:11]
    s_waitcnt vmcnt(22)
    v_perm_b32 v32, v132, v128, s82
    s_waitcnt vmcnt(20)
    v_perm_b32 v33, v140, v136, s82
    s_waitcnt vmcnt(18)
    v_perm_b32 v34, v148, v144, s82
    s_waitcnt vmcnt(16)
    v_perm_b32 v35, v156, v152, s82
    v_mfma_f32_16x16x32_bf16 a[12:15], v[36:39], a[108:111], a[12:15]
    v_mfma_f32_16x16x32_bf16 a[16:19], v[36:39], a[112:115], a[16:19]
    v_mfma_f32_16x16x32_bf16 a[20:23], v[36:39], a[116:119], a[20:23]
    v_perm_b32 v36, v132, v128, s83
    v_perm_b32 v37, v140, v136, s83
    v_perm_b32 v38, v148, v144, s83
    v_perm_b32 v39, v156, v152, s83
    v_mfma_f32_16x16x32_bf16 a[24:27], v[40:43], a[108:111], a[24:27]
    v_mfma_f32_16x16x32_bf16 a[28:31], v[40:43], a[112:115], a[28:31]
    v_mfma_f32_16x16x32_bf16 a[32:35], v[40:43], a[116:119], a[32:35]
    v_perm_b32 v40, v133, v129, s82
    v_perm_b32 v41, v141, v137, s82
    v_perm_b32 v42, v149, v145, s82
    v_perm_b32 v43, v157, v153, s82
    v_mfma_f32_16x16x32_bf16 a[36:39], v[44:47], a[108:111], a[36:39]
    v_mfma_f32_16x16x32_bf16 a[40:43], v[44:47], a[112:115], a[40:43]
    v_mfma_f32_16x16x32_bf16 a[44:47], v[44:47], a[116:119], a[44:47]
    v_perm_b32 v44, v133, v129, s83
    v_perm_b32 v45, v141, v137, s83
    v_perm_b32 v46, v149, v145, s83
    v_perm_b32 v47, v157, v153, s83
    s_add_u32 s89, s71, 5
    s_and_b32 s89, s89, 15
    s_lshl_b32 s89, s89, 18
    s_add_u32 s77, s88, s89
    buffer_load_dwordx4 v[224:227], v3, s[56:59], s77 offen
    s_add_u32 s77, s77, 0x2000
    buffer_load_dwordx4 v[228:231], v3, s[56:59], s77 offen
    s_add_u32 s77, s77, 0x2000
    buffer_load_dwordx4 v[232:235], v3, s[56:59], s77 offen
    s_add_u32 s77, s77, 0x2000
    buffer_load_dwordx4 v[236:239], v3, s[56:59], s77 offen
    s_add_u32 s77, s77, 0x2000
    buffer_load_dwordx4 v[240:243], v3, s[56:59], s77 offen
    s_add_u32 s77, s77, 0x2000
    buffer_load_dwordx4 v[244:247], v3, s[56:59], s77 offen
    s_add_u32 s77, s77, 0x2000
    buffer_load_dwordx4 v[248:251], v3, s[56:59], s77 offen
    s_add_u32 s77, s77, 0x2000
    buffer_load_dwordx4 v[252:255], v3, s[56:59], s77 offen
    v_mfma_f32_16x16x32_bf16 a[48:51], v[48:51], a[108:111], a[48:51]
    v_mfma_f32_16x16x32_bf16 a[52:55], v[48:51], a[112:115], a[52:55]
    v_mfma_f32_16x16x32_bf16 a[56:59], v[48:51], a[116:119], a[56:59]
    v_perm_b32 v48, v134, v130, s82
    v_perm_b32 v49, v142, v138, s82
    v_perm_b32 v50, v150, v146, s82
    v_perm_b32 v51, v158, v154, s82
    v_mfma_f32_16x16x32_bf16 a[60:63], v[52:55], a[108:111], a[60:63]
    v_mfma_f32_16x16x32_bf16 a[64:67], v[52:55], a[112:115], a[64:67]
    v_mfma_f32_16x16x32_bf16 a[68:71], v[52:55], a[116:119], a[68:71]
    v_perm_b32 v52, v134, v130, s83
    v_perm_b32 v53, v142, v138, s83
    v_perm_b32 v54, v150, v146, s83
    v_perm_b32 v55, v158, v154, s83
    v_mfma_f32_16x16x32_bf16 a[72:75], v[56:59], a[108:111], a[72:75]
    v_mfma_f32_16x16x32_bf16 a[76:79], v[56:59], a[112:115], a[76:79]
    v_mfma_f32_16x16x32_bf16 a[80:83], v[56:59], a[116:119], a[80:83]
    v_perm_b32 v56, v135, v131, s82
    v_perm_b32 v57, v143, v139, s82
    v_perm_b32 v58, v151, v147, s82
    v_perm_b32 v59, v159, v155, s82
    v_mfma_f32_16x16x32_bf16 a[84:87], v[60:63], a[108:111], a[84:87]
    v_mfma_f32_16x16x32_bf16 a[88:91], v[60:63], a[112:115], a[88:91]
    v_mfma_f32_16x16x32_bf16 a[92:95], v[60:63], a[116:119], a[92:95]
    v_perm_b32 v60, v135, v131, s83
    v_perm_b32 v61, v143, v139, s83
    v_perm_b32 v62, v151, v147, s83
    v_perm_b32 v63, v159, v155, s83
    s_add_u32 s89, s71, 6
    s_and_b32 s89, s89, 15
    s_lshl_b32 s89, s89, 18
    s_add_u32 s77, s88, s89
    buffer_load_dwordx4 v[64:67], v3, s[56:59], s77 offen
    s_add_u32 s77, s77, 0x2000
    buffer_load_dwordx4 v[68:71], v3, s[56:59], s77 offen
    s_add_u32 s77, s77, 0x2000
    buffer_load_dwordx4 v[72:75], v3, s[56:59], s77 offen
    s_add_u32 s77, s77, 0x2000
    buffer_load_dwordx4 v[76:79], v3, s[56:59], s77 offen
    s_add_u32 s77, s77, 0x2000
    buffer_load_dwordx4 v[80:83], v3, s[56:59], s77 offen
    s_add_u32 s77, s77, 0x2000
    buffer_load_dwordx4 v[84:87], v3, s[56:59], s77 offen
    s_add_u32 s77, s77, 0x2000
    buffer_load_dwordx4 v[88:91], v3, s[56:59], s77 offen
    s_add_u32 s77, s77, 0x2000
    buffer_load_dwordx4 v[92:95], v3, s[56:59], s77 offen
    s_barrier
    ds_read_b128 a[108:111], v8 offset:12288
    ds_read_b128 a[112:115], v8 offset:13312
    ds_read_b128 a[116:119], v8 offset:14336
    s_waitcnt lgkmcnt(8)
    v_mfma_f32_16x16x32_bf16 a[0:3], v[32:35], a[120:123], a[0:3]
    s_waitcnt lgkmcnt(7)
    v_mfma_f32_16x16x32_bf16 a[4:7], v[32:35], a[124:127], a[4:7]
    s_waitcnt lgkmcnt(6)
    v_mfma_f32_16x16x32_bf16 a[8:11], v[32:35], a[128:131], a[8:11]
    s_waitcnt vmcnt(30)
    v_perm_b32 v32, v164, v160, s82
    s_waitcnt vmcnt(28)
    v_perm_b32 v33, v172, v168, s82
    s_waitcnt vmcnt(26)
    v_perm_b32 v34, v180, v176, s82
    s_waitcnt vmcnt(24)
    v_perm_b32 v35, v188, v184, s82
    v_mfma_f32_16x16x32_bf16 a[12:15], v[36:39], a[120:123], a[12:15]
    v_mfma_f32_16x16x32_bf16 a[16:19], v[36:39], a[124:127], a[16:19]
    v_mfma_f32_16x16x32_bf16 a[20:23], v[36:39], a[128:131], a[20:23]
    v_perm_b32 v36, v164, v160, s83
    v_perm_b32 v37, v172, v168, s83
    v_perm_b32 v38, v180, v176, s83
    v_perm_b32 v39, v188, v184, s83
    v_mfma_f32_16x16x32_bf16 a[24:27], v[40:43], a[120:123], a[24:27]
    v_mfma_f32_16x16x32_bf16 a[28:31], v[40:43], a[124:127], a[28:31]
    v_mfma_f32_16x16x32_bf16 a[32:35], v[40:43], a[128:131], a[32:35]
    v_perm_b32 v40, v165, v161, s82
    v_perm_b32 v41, v173, v169, s82
    v_perm_b32 v42, v181, v177, s82
    v_perm_b32 v43, v189, v185, s82
    v_mfma_f32_16x16x32_bf16 a[36:39], v[44:47], a[120:123], a[36:39]
    v_mfma_f32_16x16x32_bf16 a[40:43], v[44:47], a[124:127], a[40:43]
    v_mfma_f32_16x16x32_bf16 a[44:47], v[44:47], a[128:131], a[44:47]
    v_perm_b32 v44, v165, v161, s83
    v_perm_b32 v45, v173, v169, s83
    v_perm_b32 v46, v181, v177, s83
    v_perm_b32 v47, v189, v185, s83
    s_add_u32 s89, s71, 7
    s_and_b32 s89, s89, 15
    s_lshl_b32 s89, s89, 18
    s_add_u32 s77, s88, s89
    buffer_load_dwordx4 v[96:99], v3, s[56:59], s77 offen
    s_add_u32 s77, s77, 0x2000
    buffer_load_dwordx4 v[100:103], v3, s[56:59], s77 offen
    s_add_u32 s77, s77, 0x2000
    buffer_load_dwordx4 v[104:107], v3, s[56:59], s77 offen
    s_add_u32 s77, s77, 0x2000
    buffer_load_dwordx4 v[108:111], v3, s[56:59], s77 offen
    s_add_u32 s77, s77, 0x2000
    buffer_load_dwordx4 v[112:115], v3, s[56:59], s77 offen
    s_add_u32 s77, s77, 0x2000
    buffer_load_dwordx4 v[116:119], v3, s[56:59], s77 offen
    s_add_u32 s77, s77, 0x2000
    buffer_load_dwordx4 v[120:123], v3, s[56:59], s77 offen
    s_add_u32 s77, s77, 0x2000
    buffer_load_dwordx4 v[124:127], v3, s[56:59], s77 offen
    v_mfma_f32_16x16x32_bf16 a[48:51], v[48:51], a[120:123], a[48:51]
    v_mfma_f32_16x16x32_bf16 a[52:55], v[48:51], a[124:127], a[52:55]
    v_mfma_f32_16x16x32_bf16 a[56:59], v[48:51], a[128:131], a[56:59]
    v_perm_b32 v48, v166, v162, s82
    v_perm_b32 v49, v174, v170, s82
    v_perm_b32 v50, v182, v178, s82
    v_perm_b32 v51, v190, v186, s82
    v_mfma_f32_16x16x32_bf16 a[60:63], v[52:55], a[120:123], a[60:63]
    v_mfma_f32_16x16x32_bf16 a[64:67], v[52:55], a[124:127], a[64:67]
    v_mfma_f32_16x16x32_bf16 a[68:71], v[52:55], a[128:131], a[68:71]
    v_perm_b32 v52, v166, v162, s83
    v_perm_b32 v53, v174, v170, s83
    v_perm_b32 v54, v182, v178, s83
    v_perm_b32 v55, v190, v186, s83
    v_mfma_f32_16x16x32_bf16 a[72:75], v[56:59], a[120:123], a[72:75]
    v_mfma_f32_16x16x32_bf16 a[76:79], v[56:59], a[124:127], a[76:79]
    v_mfma_f32_16x16x32_bf16 a[80:83], v[56:59], a[128:131], a[80:83]
    v_perm_b32 v56, v167, v163, s82
    v_perm_b32 v57, v175, v171, s82
    v_perm_b32 v58, v183, v179, s82
    v_perm_b32 v59, v191, v187, s82
    v_mfma_f32_16x16x32_bf16 a[84:87], v[60:63], a[120:123], a[84:87]
    v_mfma_f32_16x16x32_bf16 a[88:91], v[60:63], a[124:127], a[88:91]
    v_mfma_f32_16x16x32_bf16 a[92:95], v[60:63], a[128:131], a[92:95]
    v_perm_b32 v60, v167, v163, s83
    v_perm_b32 v61, v175, v171, s83
    v_perm_b32 v62, v183, v179, s83
    v_perm_b32 v63, v191, v187, s83
    s_add_u32 s89, s71, 8
    s_and_b32 s89, s89, 15
    s_lshl_b32 s89, s89, 18
    s_add_u32 s77, s88, s89
    buffer_load_dwordx4 v[128:131], v3, s[56:59], s77 offen
    s_add_u32 s77, s77, 0x2000
    buffer_load_dwordx4 v[132:135], v3, s[56:59], s77 offen
    s_add_u32 s77, s77, 0x2000
    buffer_load_dwordx4 v[136:139], v3, s[56:59], s77 offen
    s_add_u32 s77, s77, 0x2000
    buffer_load_dwordx4 v[140:143], v3, s[56:59], s77 offen
    s_add_u32 s77, s77, 0x2000
    buffer_load_dwordx4 v[144:147], v3, s[56:59], s77 offen
    s_add_u32 s77, s77, 0x2000
    buffer_load_dwordx4 v[148:151], v3, s[56:59], s77 offen
    s_add_u32 s77, s77, 0x2000
    buffer_load_dwordx4 v[152:155], v3, s[56:59], s77 offen
    s_add_u32 s77, s77, 0x2000
    buffer_load_dwordx4 v[156:159], v3, s[56:59], s77 offen
    ds_read_b128 a[120:123], v8 offset:15360
    ds_read_b128 a[124:127], v8 offset:16384
    ds_read_b128 a[128:131], v8 offset:17408
    s_waitcnt lgkmcnt(8)
    v_mfma_f32_16x16x32_bf16 a[0:3], v[32:35], a[96:99], a[0:3]
    s_waitcnt lgkmcnt(7)
    v_mfma_f32_16x16x32_bf16 a[4:7], v[32:35], a[100:103], a[4:7]
    s_waitcnt lgkmcnt(6)
    v_mfma_f32_16x16x32_bf16 a[8:11], v[32:35], a[104:107], a[8:11]
    s_waitcnt vmcnt(38)
    v_perm_b32 v32, v196, v192, s82
    s_waitcnt vmcnt(36)
    v_perm_b32 v33, v204, v200, s82
    s_waitcnt vmcnt(34)
    v_perm_b32 v34, v212, v208, s82
    s_waitcnt vmcnt(32)
    v_perm_b32 v35, v220, v216, s82
    v_mfma_f32_16x16x32_bf16 a[12:15], v[36:39], a[96:99], a[12:15]
    v_mfma_f32_16x16x32_bf16 a[16:19], v[36:39], a[100:103], a[16:19]
    v_mfma_f32_16x16x32_bf16 a[20:23], v[36:39], a[104:107], a[20:23]
    v_perm_b32 v36, v196, v192, s83
    v_perm_b32 v37, v204, v200, s83
    v_perm_b32 v38, v212, v208, s83
    v_perm_b32 v39, v220, v216, s83
    v_mfma_f32_16x16x32_bf16 a[24:27], v[40:43], a[96:99], a[24:27]
    v_mfma_f32_16x16x32_bf16 a[28:31], v[40:43], a[100:103], a[28:31]
    v_mfma_f32_16x16x32_bf16 a[32:35], v[40:43], a[104:107], a[32:35]
    v_perm_b32 v40, v197, v193, s82
    v_perm_b32 v41, v205, v201, s82
    v_perm_b32 v42, v213, v209, s82
    v_perm_b32 v43, v221, v217, s82
    v_mfma_f32_16x16x32_bf16 a[36:39], v[44:47], a[96:99], a[36:39]
    v_mfma_f32_16x16x32_bf16 a[40:43], v[44:47], a[100:103], a[40:43]
    v_mfma_f32_16x16x32_bf16 a[44:47], v[44:47], a[104:107], a[44:47]
    v_perm_b32 v44, v197, v193, s83
    v_perm_b32 v45, v205, v201, s83
    v_perm_b32 v46, v213, v209, s83
    v_perm_b32 v47, v221, v217, s83
    v_mfma_f32_16x16x32_bf16 a[48:51], v[48:51], a[96:99], a[48:51]
    v_mfma_f32_16x16x32_bf16 a[52:55], v[48:51], a[100:103], a[52:55]
    v_mfma_f32_16x16x32_bf16 a[56:59], v[48:51], a[104:107], a[56:59]
    v_perm_b32 v48, v198, v194, s82
    v_perm_b32 v49, v206, v202, s82
    v_perm_b32 v50, v214, v210, s82
    v_perm_b32 v51, v222, v218, s82
    v_mfma_f32_16x16x32_bf16 a[60:63], v[52:55], a[96:99], a[60:63]
    v_mfma_f32_16x16x32_bf16 a[64:67], v[52:55], a[100:103], a[64:67]
    v_mfma_f32_16x16x32_bf16 a[68:71], v[52:55], a[104:107], a[68:71]
    v_perm_b32 v52, v198, v194, s83
    v_perm_b32 v53, v206, v202, s83
    v_perm_b32 v54, v214, v210, s83
    v_perm_b32 v55, v222, v218, s83
    v_mfma_f32_16x16x32_bf16 a[72:75], v[56:59], a[96:99], a[72:75]
    v_mfma_f32_16x16x32_bf16 a[76:79], v[56:59], a[100:103], a[76:79]
    v_mfma_f32_16x16x32_bf16 a[80:83], v[56:59], a[104:107], a[80:83]
    v_perm_b32 v56, v199, v195, s82
    v_perm_b32 v57, v207, v203, s82
    v_perm_b32 v58, v215, v211, s82
    v_perm_b32 v59, v223, v219, s82
    v_mfma_f32_16x16x32_bf16 a[84:87], v[60:63], a[96:99], a[84:87]
    v_mfma_f32_16x16x32_bf16 a[88:91], v[60:63], a[100:103], a[88:91]
    v_mfma_f32_16x16x32_bf16 a[92:95], v[60:63], a[104:107], a[92:95]
    v_perm_b32 v60, v199, v195, s83
    v_perm_b32 v61, v207, v203, s83
    v_perm_b32 v62, v215, v211, s83
    v_perm_b32 v63, v223, v219, s83
    s_add_u32 s89, s71, 9
    s_and_b32 s89, s89, 15
    s_lshl_b32 s89, s89, 18
    s_add_u32 s77, s88, s89
    buffer_load_dwordx4 v[160:163], v3, s[56:59], s77 offen
    s_add_u32 s77, s77, 0x2000
    buffer_load_dwordx4 v[164:167], v3, s[56:59], s77 offen
    s_add_u32 s77, s77, 0x2000
    buffer_load_dwordx4 v[168:171], v3, s[56:59], s77 offen
    s_add_u32 s77, s77, 0x2000
    buffer_load_dwordx4 v[172:175], v3, s[56:59], s77 offen
    s_add_u32 s77, s77, 0x2000
    buffer_load_dwordx4 v[176:179], v3, s[56:59], s77 offen
    s_add_u32 s77, s77, 0x2000
    buffer_load_dwordx4 v[180:183], v3, s[56:59], s77 offen
    s_add_u32 s77, s77, 0x2000
    buffer_load_dwordx4 v[184:187], v3, s[56:59], s77 offen
    s_add_u32 s77, s77, 0x2000
    buffer_load_dwordx4 v[188:191], v3, s[56:59], s77 offen
    ds_read_b128 a[96:99], v8 offset:18432
    ds_read_b128 a[100:103], v8 offset:19456
    ds_read_b128 a[104:107], v8 offset:20480
    s_waitcnt lgkmcnt(8)
    v_mfma_f32_16x16x32_bf16 a[0:3], v[32:35], a[108:111], a[0:3]
    s_waitcnt lgkmcnt(7)
    v_mfma_f32_16x16x32_bf16 a[4:7], v[32:35], a[112:115], a[4:7]
    s_waitcnt lgkmcnt(6)
    v_mfma_f32_16x16x32_bf16 a[8:11], v[32:35], a[116:119], a[8:11]
    s_waitcnt vmcnt(38)
    v_perm_b32 v32, v228, v224, s82
    s_waitcnt vmcnt(36)
    v_perm_b32 v33, v236, v232, s82
    s_waitcnt vmcnt(34)
    v_perm_b32 v34, v244, v240, s82
    s_waitcnt vmcnt(32)
    v_perm_b32 v35, v252, v248, s82
    v_mfma_f32_16x16x32_bf16 a[12:15], v[36:39], a[108:111], a[12:15]
    v_mfma_f32_16x16x32_bf16 a[16:19], v[36:39], a[112:115], a[16:19]
    v_mfma_f32_16x16x32_bf16 a[20:23], v[36:39], a[116:119], a[20:23]
    v_perm_b32 v36, v228, v224, s83
    v_perm_b32 v37, v236, v232, s83
    v_perm_b32 v38, v244, v240, s83
    v_perm_b32 v39, v252, v248, s83
    v_mfma_f32_16x16x32_bf16 a[24:27], v[40:43], a[108:111], a[24:27]
    v_mfma_f32_16x16x32_bf16 a[28:31], v[40:43], a[112:115], a[28:31]
    v_mfma_f32_16x16x32_bf16 a[32:35], v[40:43], a[116:119], a[32:35]
    v_perm_b32 v40, v229, v225, s82
    v_perm_b32 v41, v237, v233, s82
    v_perm_b32 v42, v245, v241, s82
    v_perm_b32 v43, v253, v249, s82
    v_mfma_f32_16x16x32_bf16 a[36:39], v[44:47], a[108:111], a[36:39]
    v_mfma_f32_16x16x32_bf16 a[40:43], v[44:47], a[112:115], a[40:43]
    v_mfma_f32_16x16x32_bf16 a[44:47], v[44:47], a[116:119], a[44:47]
    v_perm_b32 v44, v229, v225, s83
    v_perm_b32 v45, v237, v233, s83
    v_perm_b32 v46, v245, v241, s83
    v_perm_b32 v47, v253, v249, s83
    v_mfma_f32_16x16x32_bf16 a[48:51], v[48:51], a[108:111], a[48:51]
    v_mfma_f32_16x16x32_bf16 a[52:55], v[48:51], a[112:115], a[52:55]
    v_mfma_f32_16x16x32_bf16 a[56:59], v[48:51], a[116:119], a[56:59]
    v_perm_b32 v48, v230, v226, s82
    v_perm_b32 v49, v238, v234, s82
    v_perm_b32 v50, v246, v242, s82
    v_perm_b32 v51, v254, v250, s82
    v_mfma_f32_16x16x32_bf16 a[60:63], v[52:55], a[108:111], a[60:63]
    v_mfma_f32_16x16x32_bf16 a[64:67], v[52:55], a[112:115], a[64:67]
    v_mfma_f32_16x16x32_bf16 a[68:71], v[52:55], a[116:119], a[68:71]
    v_perm_b32 v52, v230, v226, s83
    v_perm_b32 v53, v238, v234, s83
    v_perm_b32 v54, v246, v242, s83
    v_perm_b32 v55, v254, v250, s83
    v_mfma_f32_16x16x32_bf16 a[72:75], v[56:59], a[108:111], a[72:75]
    v_mfma_f32_16x16x32_bf16 a[76:79], v[56:59], a[112:115], a[76:79]
    v_mfma_f32_16x16x32_bf16 a[80:83], v[56:59], a[116:119], a[80:83]
    v_perm_b32 v56, v231, v227, s82
    v_perm_b32 v57, v239, v235, s82
    v_perm_b32 v58, v247, v243, s82
    v_perm_b32 v59, v255, v251, s82
    v_mfma_f32_16x16x32_bf16 a[84:87], v[60:63], a[108:111], a[84:87]
    v_mfma_f32_16x16x32_bf16 a[88:91], v[60:63], a[112:115], a[88:91]
    v_mfma_f32_16x16x32_bf16 a[92:95], v[60:63], a[116:119], a[92:95]
    v_perm_b32 v60, v231, v227, s83
    v_perm_b32 v61, v239, v235, s83
    v_perm_b32 v62, v247, v243, s83
    v_perm_b32 v63, v255, v251, s83
    s_add_u32 s89, s71, 10
    s_and_b32 s89, s89, 15
    s_lshl_b32 s89, s89, 18
    s_add_u32 s77, s88, s89
    buffer_load_dwordx4 v[192:195], v3, s[56:59], s77 offen
    s_add_u32 s77, s77, 0x2000
    buffer_load_dwordx4 v[196:199], v3, s[56:59], s77 offen
    s_add_u32 s77, s77, 0x2000
    buffer_load_dwordx4 v[200:203], v3, s[56:59], s77 offen
    s_add_u32 s77, s77, 0x2000
    buffer_load_dwordx4 v[204:207], v3, s[56:59], s77 offen
    s_add_u32 s77, s77, 0x2000
    buffer_load_dwordx4 v[208:211], v3, s[56:59], s77 offen
    s_add_u32 s77, s77, 0x2000
    buffer_load_dwordx4 v[212:215], v3, s[56:59], s77 offen
    s_add_u32 s77, s77, 0x2000
    buffer_load_dwordx4 v[216:219], v3, s[56:59], s77 offen
    s_add_u32 s77, s77, 0x2000
    buffer_load_dwordx4 v[220:223], v3, s[56:59], s77 offen
    ds_read_b128 a[108:111], v8 offset:21504
    ds_read_b128 a[112:115], v8 offset:22528
    ds_read_b128 a[116:119], v8 offset:23552
    s_waitcnt lgkmcnt(8)
    v_mfma_f32_16x16x32_bf16 a[0:3], v[32:35], a[120:123], a[0:3]
    s_waitcnt lgkmcnt(7)
    v_mfma_f32_16x16x32_bf16 a[4:7], v[32:35], a[124:127], a[4:7]
    s_waitcnt lgkmcnt(6)
    v_mfma_f32_16x16x32_bf16 a[8:11], v[32:35], a[128:131], a[8:11]
    s_waitcnt vmcnt(38)
    v_perm_b32 v32, v68, v64, s82
    s_waitcnt vmcnt(36)
    v_perm_b32 v33, v76, v72, s82
    s_waitcnt vmcnt(34)
    v_perm_b32 v34, v84, v80, s82
    s_waitcnt vmcnt(32)
    v_perm_b32 v35, v92, v88, s82
    v_mfma_f32_16x16x32_bf16 a[12:15], v[36:39], a[120:123], a[12:15]
    v_mfma_f32_16x16x32_bf16 a[16:19], v[36:39], a[124:127], a[16:19]
    v_mfma_f32_16x16x32_bf16 a[20:23], v[36:39], a[128:131], a[20:23]
    v_perm_b32 v36, v68, v64, s83
    v_perm_b32 v37, v76, v72, s83
    v_perm_b32 v38, v84, v80, s83
    v_perm_b32 v39, v92, v88, s83
    v_mfma_f32_16x16x32_bf16 a[24:27], v[40:43], a[120:123], a[24:27]
    v_mfma_f32_16x16x32_bf16 a[28:31], v[40:43], a[124:127], a[28:31]
    v_mfma_f32_16x16x32_bf16 a[32:35], v[40:43], a[128:131], a[32:35]
    v_perm_b32 v40, v69, v65, s82
    v_perm_b32 v41, v77, v73, s82
    v_perm_b32 v42, v85, v81, s82
    v_perm_b32 v43, v93, v89, s82
    v_mfma_f32_16x16x32_bf16 a[36:39], v[44:47], a[120:123], a[36:39]
    v_mfma_f32_16x16x32_bf16 a[40:43], v[44:47], a[124:127], a[40:43]
    v_mfma_f32_16x16x32_bf16 a[44:47], v[44:47], a[128:131], a[44:47]
    v_perm_b32 v44, v69, v65, s83
    v_perm_b32 v45, v77, v73, s83
    v_perm_b32 v46, v85, v81, s83
    v_perm_b32 v47, v93, v89, s83
    v_mfma_f32_16x16x32_bf16 a[48:51], v[48:51], a[120:123], a[48:51]
    v_mfma_f32_16x16x32_bf16 a[52:55], v[48:51], a[124:127], a[52:55]
    v_mfma_f32_16x16x32_bf16 a[56:59], v[48:51], a[128:131], a[56:59]
    v_perm_b32 v48, v70, v66, s82
    v_perm_b32 v49, v78, v74, s82
    v_perm_b32 v50, v86, v82, s82
    v_perm_b32 v51, v94, v90, s82
    v_mfma_f32_16x16x32_bf16 a[60:63], v[52:55], a[120:123], a[60:63]
    v_mfma_f32_16x16x32_bf16 a[64:67], v[52:55], a[124:127], a[64:67]
    v_mfma_f32_16x16x32_bf16 a[68:71], v[52:55], a[128:131], a[68:71]
    v_perm_b32 v52, v70, v66, s83
    v_perm_b32 v53, v78, v74, s83
    v_perm_b32 v54, v86, v82, s83
    v_perm_b32 v55, v94, v90, s83
    v_mfma_f32_16x16x32_bf16 a[72:75], v[56:59], a[120:123], a[72:75]
    v_mfma_f32_16x16x32_bf16 a[76:79], v[56:59], a[124:127], a[76:79]
    v_mfma_f32_16x16x32_bf16 a[80:83], v[56:59], a[128:131], a[80:83]
    v_perm_b32 v56, v71, v67, s82
    v_perm_b32 v57, v79, v75, s82
    v_perm_b32 v58, v87, v83, s82
    v_perm_b32 v59, v95, v91, s82
    v_mfma_f32_16x16x32_bf16 a[84:87], v[60:63], a[120:123], a[84:87]
    v_mfma_f32_16x16x32_bf16 a[88:91], v[60:63], a[124:127], a[88:91]
    v_mfma_f32_16x16x32_bf16 a[92:95], v[60:63], a[128:131], a[92:95]
    v_perm_b32 v60, v71, v67, s83
    v_perm_b32 v61, v79, v75, s83
    v_perm_b32 v62, v87, v83, s83
    v_perm_b32 v63, v95, v91, s83
    s_add_u32 s89, s71, 11
    s_and_b32 s89, s89, 15
    s_lshl_b32 s89, s89, 18
    s_add_u32 s77, s88, s89
    buffer_load_dwordx4 v[224:227], v3, s[56:59], s77 offen
    s_add_u32 s77, s77, 0x2000
    buffer_load_dwordx4 v[228:231], v3, s[56:59], s77 offen
    s_add_u32 s77, s77, 0x2000
    buffer_load_dwordx4 v[232:235], v3, s[56:59], s77 offen
    s_add_u32 s77, s77, 0x2000
    buffer_load_dwordx4 v[236:239], v3, s[56:59], s77 offen
    s_add_u32 s77, s77, 0x2000
    buffer_load_dwordx4 v[240:243], v3, s[56:59], s77 offen
    s_add_u32 s77, s77, 0x2000
    buffer_load_dwordx4 v[244:247], v3, s[56:59], s77 offen
    s_add_u32 s77, s77, 0x2000
    buffer_load_dwordx4 v[248:251], v3, s[56:59], s77 offen
    s_add_u32 s77, s77, 0x2000
    buffer_load_dwordx4 v[252:255], v3, s[56:59], s77 offen
    s_barrier
    ds_read_b128 a[120:123], v8 offset:24576
    ds_read_b128 a[124:127], v8 offset:25600
    ds_read_b128 a[128:131], v8 offset:26624
    s_waitcnt lgkmcnt(8)
    v_mfma_f32_16x16x32_bf16 a[0:3], v[32:35], a[96:99], a[0:3]
    s_waitcnt lgkmcnt(7)
    v_mfma_f32_16x16x32_bf16 a[4:7], v[32:35], a[100:103], a[4:7]
    s_waitcnt lgkmcnt(6)
    v_mfma_f32_16x16x32_bf16 a[8:11], v[32:35], a[104:107], a[8:11]
    s_waitcnt vmcnt(38)
    v_perm_b32 v32, v100, v96, s82
    s_waitcnt vmcnt(36)
    v_perm_b32 v33, v108, v104, s82
    s_waitcnt vmcnt(34)
    v_perm_b32 v34, v116, v112, s82
    s_waitcnt vmcnt(32)
    v_perm_b32 v35, v124, v120, s82
    v_mfma_f32_16x16x32_bf16 a[12:15], v[36:39], a[96:99], a[12:15]
    v_mfma_f32_16x16x32_bf16 a[16:19], v[36:39], a[100:103], a[16:19]
    v_mfma_f32_16x16x32_bf16 a[20:23], v[36:39], a[104:107], a[20:23]
    v_perm_b32 v36, v100, v96, s83
    v_perm_b32 v37, v108, v104, s83
    v_perm_b32 v38, v116, v112, s83
    v_perm_b32 v39, v124, v120, s83
    v_mfma_f32_16x16x32_bf16 a[24:27], v[40:43], a[96:99], a[24:27]
    v_mfma_f32_16x16x32_bf16 a[28:31], v[40:43], a[100:103], a[28:31]
    v_mfma_f32_16x16x32_bf16 a[32:35], v[40:43], a[104:107], a[32:35]
    v_perm_b32 v40, v101, v97, s82
    v_perm_b32 v41, v109, v105, s82
    v_perm_b32 v42, v117, v113, s82
    v_perm_b32 v43, v125, v121, s82
    v_mfma_f32_16x16x32_bf16 a[36:39], v[44:47], a[96:99], a[36:39]
    v_mfma_f32_16x16x32_bf16 a[40:43], v[44:47], a[100:103], a[40:43]
    v_mfma_f32_16x16x32_bf16 a[44:47], v[44:47], a[104:107], a[44:47]
    v_perm_b32 v44, v101, v97, s83
    v_perm_b32 v45, v109, v105, s83
    v_perm_b32 v46, v117, v113, s83
    v_perm_b32 v47, v125, v121, s83
    v_mfma_f32_16x16x32_bf16 a[48:51], v[48:51], a[96:99], a[48:51]
    v_mfma_f32_16x16x32_bf16 a[52:55], v[48:51], a[100:103], a[52:55]
    v_mfma_f32_16x16x32_bf16 a[56:59], v[48:51], a[104:107], a[56:59]
    v_perm_b32 v48, v102, v98, s82
    v_perm_b32 v49, v110, v106, s82
    v_perm_b32 v50, v118, v114, s82
    v_perm_b32 v51, v126, v122, s82
    v_mfma_f32_16x16x32_bf16 a[60:63], v[52:55], a[96:99], a[60:63]
    v_mfma_f32_16x16x32_bf16 a[64:67], v[52:55], a[100:103], a[64:67]
    v_mfma_f32_16x16x32_bf16 a[68:71], v[52:55], a[104:107], a[68:71]
    v_perm_b32 v52, v102, v98, s83
    v_perm_b32 v53, v110, v106, s83
    v_perm_b32 v54, v118, v114, s83
    v_perm_b32 v55, v126, v122, s83
    v_mfma_f32_16x16x32_bf16 a[72:75], v[56:59], a[96:99], a[72:75]
    v_mfma_f32_16x16x32_bf16 a[76:79], v[56:59], a[100:103], a[76:79]
    v_mfma_f32_16x16x32_bf16 a[80:83], v[56:59], a[104:107], a[80:83]
    v_perm_b32 v56, v103, v99, s82
    v_perm_b32 v57, v111, v107, s82
    v_perm_b32 v58, v119, v115, s82
    v_perm_b32 v59, v127, v123, s82
    v_mfma_f32_16x16x32_bf16 a[84:87], v[60:63], a[96:99], a[84:87]
    v_mfma_f32_16x16x32_bf16 a[88:91], v[60:63], a[100:103], a[88:91]
    v_mfma_f32_16x16x32_bf16 a[92:95], v[60:63], a[104:107], a[92:95]
    v_perm_b32 v60, v103, v99, s83
    v_perm_b32 v61, v111, v107, s83
    v_perm_b32 v62, v119, v115, s83
    v_perm_b32 v63, v127, v123, s83
    s_add_u32 s89, s71, 12
    s_and_b32 s89, s89, 15
    s_lshl_b32 s89, s89, 18
    s_add_u32 s77, s88, s89
    buffer_load_dwordx4 v[64:67], v3, s[56:59], s77 offen
    s_add_u32 s77, s77, 0x2000
    buffer_load_dwordx4 v[68:71], v3, s[56:59], s77 offen
    s_add_u32 s77, s77, 0x2000
    buffer_load_dwordx4 v[72:75], v3, s[56:59], s77 offen
    s_add_u32 s77, s77, 0x2000
    buffer_load_dwordx4 v[76:79], v3, s[56:59], s77 offen
    s_add_u32 s77, s77, 0x2000
    buffer_load_dwordx4 v[80:83], v3, s[56:59], s77 offen
    s_add_u32 s77, s77, 0x2000
    buffer_load_dwordx4 v[84:87], v3, s[56:59], s77 offen
    s_add_u32 s77, s77, 0x2000
    buffer_load_dwordx4 v[88:91], v3, s[56:59], s77 offen
    s_add_u32 s77, s77, 0x2000
    buffer_load_dwordx4 v[92:95], v3, s[56:59], s77 offen
    ds_read_b128 a[96:99], v8 offset:27648
    ds_read_b128 a[100:103], v8 offset:28672
    ds_read_b128 a[104:107], v8 offset:29696
    s_waitcnt lgkmcnt(8)
    v_mfma_f32_16x16x32_bf16 a[0:3], v[32:35], a[108:111], a[0:3]
    s_waitcnt lgkmcnt(7)
    v_mfma_f32_16x16x32_bf16 a[4:7], v[32:35], a[112:115], a[4:7]
    s_waitcnt lgkmcnt(6)
    v_mfma_f32_16x16x32_bf16 a[8:11], v[32:35], a[116:119], a[8:11]
    s_waitcnt vmcnt(38)
    v_perm_b32 v32, v132, v128, s82
    s_waitcnt vmcnt(36)
    v_perm_b32 v33, v140, v136, s82
    s_waitcnt vmcnt(34)
    v_perm_b32 v34, v148, v144, s82
    s_waitcnt vmcnt(32)
    v_perm_b32 v35, v156, v152, s82
    v_mfma_f32_16x16x32_bf16 a[12:15], v[36:39], a[108:111], a[12:15]
    v_mfma_f32_16x16x32_bf16 a[16:19], v[36:39], a[112:115], a[16:19]
    v_mfma_f32_16x16x32_bf16 a[20:23], v[36:39], a[116:119], a[20:23]
    v_perm_b32 v36, v132, v128, s83
    v_perm_b32 v37, v140, v136, s83
    v_perm_b32 v38, v148, v144, s83
    v_perm_b32 v39, v156, v152, s83
    v_mfma_f32_16x16x32_bf16 a[24:27], v[40:43], a[108:111], a[24:27]
    v_mfma_f32_16x16x32_bf16 a[28:31], v[40:43], a[112:115], a[28:31]
    v_mfma_f32_16x16x32_bf16 a[32:35], v[40:43], a[116:119], a[32:35]
    v_perm_b32 v40, v133, v129, s82
    v_perm_b32 v41, v141, v137, s82
    v_perm_b32 v42, v149, v145, s82
    v_perm_b32 v43, v157, v153, s82
    v_mfma_f32_16x16x32_bf16 a[36:39], v[44:47], a[108:111], a[36:39]
    v_mfma_f32_16x16x32_bf16 a[40:43], v[44:47], a[112:115], a[40:43]
    v_mfma_f32_16x16x32_bf16 a[44:47], v[44:47], a[116:119], a[44:47]
    v_perm_b32 v44, v133, v129, s83
    v_perm_b32 v45, v141, v137, s83
    v_perm_b32 v46, v149, v145, s83
    v_perm_b32 v47, v157, v153, s83
    v_mfma_f32_16x16x32_bf16 a[48:51], v[48:51], a[108:111], a[48:51]
    v_mfma_f32_16x16x32_bf16 a[52:55], v[48:51], a[112:115], a[52:55]
    v_mfma_f32_16x16x32_bf16 a[56:59], v[48:51], a[116:119], a[56:59]
    v_perm_b32 v48, v134, v130, s82
    v_perm_b32 v49, v142, v138, s82
    v_perm_b32 v50, v150, v146, s82
    v_perm_b32 v51, v158, v154, s82
    v_mfma_f32_16x16x32_bf16 a[60:63], v[52:55], a[108:111], a[60:63]
    v_mfma_f32_16x16x32_bf16 a[64:67], v[52:55], a[112:115], a[64:67]
    v_mfma_f32_16x16x32_bf16 a[68:71], v[52:55], a[116:119], a[68:71]
    v_perm_b32 v52, v134, v130, s83
    v_perm_b32 v53, v142, v138, s83
    v_perm_b32 v54, v150, v146, s83
    v_perm_b32 v55, v158, v154, s83
    v_mfma_f32_16x16x32_bf16 a[72:75], v[56:59], a[108:111], a[72:75]
    v_mfma_f32_16x16x32_bf16 a[76:79], v[56:59], a[112:115], a[76:79]
    v_mfma_f32_16x16x32_bf16 a[80:83], v[56:59], a[116:119], a[80:83]
    v_perm_b32 v56, v135, v131, s82
    v_perm_b32 v57, v143, v139, s82
    v_perm_b32 v58, v151, v147, s82
    v_perm_b32 v59, v159, v155, s82
    v_mfma_f32_16x16x32_bf16 a[84:87], v[60:63], a[108:111], a[84:87]
    v_mfma_f32_16x16x32_bf16 a[88:91], v[60:63], a[112:115], a[88:91]
    v_mfma_f32_16x16x32_bf16 a[92:95], v[60:63], a[116:119], a[92:95]
    v_perm_b32 v60, v135, v131, s83
    v_perm_b32 v61, v143, v139, s83
    v_perm_b32 v62, v151, v147, s83
    v_perm_b32 v63, v159, v155, s83
    s_add_u32 s89, s71, 13
    s_and_b32 s89, s89, 15
    s_lshl_b32 s89, s89, 18
    s_add_u32 s77, s88, s89
    buffer_load_dwordx4 v[96:99], v3, s[56:59], s77 offen
    s_add_u32 s77, s77, 0x2000
    buffer_load_dwordx4 v[100:103], v3, s[56:59], s77 offen
    s_add_u32 s77, s77, 0x2000
    buffer_load_dwordx4 v[104:107], v3, s[56:59], s77 offen
    s_add_u32 s77, s77, 0x2000
    buffer_load_dwordx4 v[108:111], v3, s[56:59], s77 offen
    s_add_u32 s77, s77, 0x2000
    buffer_load_dwordx4 v[112:115], v3, s[56:59], s77 offen
    s_add_u32 s77, s77, 0x2000
    buffer_load_dwordx4 v[116:119], v3, s[56:59], s77 offen
    s_add_u32 s77, s77, 0x2000
    buffer_load_dwordx4 v[120:123], v3, s[56:59], s77 offen
    s_add_u32 s77, s77, 0x2000
    buffer_load_dwordx4 v[124:127], v3, s[56:59], s77 offen
    ds_read_b128 a[108:111], v8 offset:30720
    ds_read_b128 a[112:115], v8 offset:31744
    ds_read_b128 a[116:119], v8 offset:32768
    s_waitcnt lgkmcnt(8)
    v_mfma_f32_16x16x32_bf16 a[0:3], v[32:35], a[120:123], a[0:3]
    s_waitcnt lgkmcnt(7)
    v_mfma_f32_16x16x32_bf16 a[4:7], v[32:35], a[124:127], a[4:7]
    s_waitcnt lgkmcnt(6)
    v_mfma_f32_16x16x32_bf16 a[8:11], v[32:35], a[128:131], a[8:11]
    s_waitcnt vmcnt(38)
    v_perm_b32 v32, v164, v160, s82
    s_waitcnt vmcnt(36)
    v_perm_b32 v33, v172, v168, s82
    s_waitcnt vmcnt(34)
    v_perm_b32 v34, v180, v176, s82
    s_waitcnt vmcnt(32)
    v_perm_b32 v35, v188, v184, s82
    v_mfma_f32_16x16x32_bf16 a[12:15], v[36:39], a[120:123], a[12:15]
    v_mfma_f32_16x16x32_bf16 a[16:19], v[36:39], a[124:127], a[16:19]
    v_mfma_f32_16x16x32_bf16 a[20:23], v[36:39], a[128:131], a[20:23]
    v_perm_b32 v36, v164, v160, s83
    v_perm_b32 v37, v172, v168, s83
    v_perm_b32 v38, v180, v176, s83
    v_perm_b32 v39, v188, v184, s83
    v_mfma_f32_16x16x32_bf16 a[24:27], v[40:43], a[120:123], a[24:27]
    v_mfma_f32_16x16x32_bf16 a[28:31], v[40:43], a[124:127], a[28:31]
    v_mfma_f32_16x16x32_bf16 a[32:35], v[40:43], a[128:131], a[32:35]
    v_perm_b32 v40, v165, v161, s82
    v_perm_b32 v41, v173, v169, s82
    v_perm_b32 v42, v181, v177, s82
    v_perm_b32 v43, v189, v185, s82
    v_mfma_f32_16x16x32_bf16 a[36:39], v[44:47], a[120:123], a[36:39]
    v_mfma_f32_16x16x32_bf16 a[40:43], v[44:47], a[124:127], a[40:43]
    v_mfma_f32_16x16x32_bf16 a[44:47], v[44:47], a[128:131], a[44:47]
    v_perm_b32 v44, v165, v161, s83
    v_perm_b32 v45, v173, v169, s83
    v_perm_b32 v46, v181, v177, s83
    v_perm_b32 v47, v189, v185, s83
    v_mfma_f32_16x16x32_bf16 a[48:51], v[48:51], a[120:123], a[48:51]
    v_mfma_f32_16x16x32_bf16 a[52:55], v[48:51], a[124:127], a[52:55]
    v_mfma_f32_16x16x32_bf16 a[56:59], v[48:51], a[128:131], a[56:59]
    v_perm_b32 v48, v166, v162, s82
    v_perm_b32 v49, v174, v170, s82
    v_perm_b32 v50, v182, v178, s82
    v_perm_b32 v51, v190, v186, s82
    v_mfma_f32_16x16x32_bf16 a[60:63], v[52:55], a[120:123], a[60:63]
    v_mfma_f32_16x16x32_bf16 a[64:67], v[52:55], a[124:127], a[64:67]
    v_mfma_f32_16x16x32_bf16 a[68:71], v[52:55], a[128:131], a[68:71]
    v_perm_b32 v52, v166, v162, s83
    v_perm_b32 v53, v174, v170, s83
    v_perm_b32 v54, v182, v178, s83
    v_perm_b32 v55, v190, v186, s83
    v_mfma_f32_16x16x32_bf16 a[72:75], v[56:59], a[120:123], a[72:75]
    v_mfma_f32_16x16x32_bf16 a[76:79], v[56:59], a[124:127], a[76:79]
    v_mfma_f32_16x16x32_bf16 a[80:83], v[56:59], a[128:131], a[80:83]
    v_perm_b32 v56, v167, v163, s82
    v_perm_b32 v57, v175, v171, s82
    v_perm_b32 v58, v183, v179, s82
    v_perm_b32 v59, v191, v187, s82
    v_mfma_f32_16x16x32_bf16 a[84:87], v[60:63], a[120:123], a[84:87]
    v_mfma_f32_16x16x32_bf16 a[88:91], v[60:63], a[124:127], a[88:91]
    v_mfma_f32_16x16x32_bf16 a[92:95], v[60:63], a[128:131], a[92:95]
    v_perm_b32 v60, v167, v163, s83
    v_perm_b32 v61, v175, v171, s83
    v_perm_b32 v62, v183, v179, s83
    v_perm_b32 v63, v191, v187, s83
    s_add_u32 s89, s71, 14
    s_and_b32 s89, s89, 15
    s_lshl_b32 s89, s89, 18
    s_add_u32 s77, s88, s89
    buffer_load_dwordx4 v[128:131], v3, s[56:59], s77 offen
    s_add_u32 s77, s77, 0x2000
    buffer_load_dwordx4 v[132:135], v3, s[56:59], s77 offen
    s_add_u32 s77, s77, 0x2000
    buffer_load_dwordx4 v[136:139], v3, s[56:59], s77 offen
    s_add_u32 s77, s77, 0x2000
    buffer_load_dwordx4 v[140:143], v3, s[56:59], s77 offen
    s_add_u32 s77, s77, 0x2000
    buffer_load_dwordx4 v[144:147], v3, s[56:59], s77 offen
    s_add_u32 s77, s77, 0x2000
    buffer_load_dwordx4 v[148:151], v3, s[56:59], s77 offen
    s_add_u32 s77, s77, 0x2000
    buffer_load_dwordx4 v[152:155], v3, s[56:59], s77 offen
    s_add_u32 s77, s77, 0x2000
    buffer_load_dwordx4 v[156:159], v3, s[56:59], s77 offen
    ds_read_b128 a[120:123], v8 offset:33792
    ds_read_b128 a[124:127], v8 offset:34816
    ds_read_b128 a[128:131], v8 offset:35840
    s_waitcnt lgkmcnt(8)
    v_mfma_f32_16x16x32_bf16 a[0:3], v[32:35], a[96:99], a[0:3]
    s_waitcnt lgkmcnt(7)
    v_mfma_f32_16x16x32_bf16 a[4:7], v[32:35], a[100:103], a[4:7]
    s_waitcnt lgkmcnt(6)
    v_mfma_f32_16x16x32_bf16 a[8:11], v[32:35], a[104:107], a[8:11]
    s_waitcnt vmcnt(38)
    v_perm_b32 v32, v196, v192, s82
    s_waitcnt vmcnt(36)
    v_perm_b32 v33, v204, v200, s82
    s_waitcnt vmcnt(34)
    v_perm_b32 v34, v212, v208, s82
    s_waitcnt vmcnt(32)
    v_perm_b32 v35, v220, v216, s82
    v_mfma_f32_16x16x32_bf16 a[12:15], v[36:39], a[96:99], a[12:15]
    v_mfma_f32_16x16x32_bf16 a[16:19], v[36:39], a[100:103], a[16:19]
    v_mfma_f32_16x16x32_bf16 a[20:23], v[36:39], a[104:107], a[20:23]
    v_perm_b32 v36, v196, v192, s83
    v_perm_b32 v37, v204, v200, s83
    v_perm_b32 v38, v212, v208, s83
    v_perm_b32 v39, v220, v216, s83
    v_mfma_f32_16x16x32_bf16 a[24:27], v[40:43], a[96:99], a[24:27]
    v_mfma_f32_16x16x32_bf16 a[28:31], v[40:43], a[100:103], a[28:31]
    v_mfma_f32_16x16x32_bf16 a[32:35], v[40:43], a[104:107], a[32:35]
    v_perm_b32 v40, v197, v193, s82
    v_perm_b32 v41, v205, v201, s82
    v_perm_b32 v42, v213, v209, s82
    v_perm_b32 v43, v221, v217, s82
    v_mfma_f32_16x16x32_bf16 a[36:39], v[44:47], a[96:99], a[36:39]
    v_mfma_f32_16x16x32_bf16 a[40:43], v[44:47], a[100:103], a[40:43]
    v_mfma_f32_16x16x32_bf16 a[44:47], v[44:47], a[104:107], a[44:47]
    v_perm_b32 v44, v197, v193, s83
    v_perm_b32 v45, v205, v201, s83
    v_perm_b32 v46, v213, v209, s83
    v_perm_b32 v47, v221, v217, s83
    v_mfma_f32_16x16x32_bf16 a[48:51], v[48:51], a[96:99], a[48:51]
    v_mfma_f32_16x16x32_bf16 a[52:55], v[48:51], a[100:103], a[52:55]
    v_mfma_f32_16x16x32_bf16 a[56:59], v[48:51], a[104:107], a[56:59]
    v_perm_b32 v48, v198, v194, s82
    v_perm_b32 v49, v206, v202, s82
    v_perm_b32 v50, v214, v210, s82
    v_perm_b32 v51, v222, v218, s82
    v_mfma_f32_16x16x32_bf16 a[60:63], v[52:55], a[96:99], a[60:63]
    v_mfma_f32_16x16x32_bf16 a[64:67], v[52:55], a[100:103], a[64:67]
    v_mfma_f32_16x16x32_bf16 a[68:71], v[52:55], a[104:107], a[68:71]
    v_perm_b32 v52, v198, v194, s83
    v_perm_b32 v53, v206, v202, s83
    v_perm_b32 v54, v214, v210, s83
    v_perm_b32 v55, v222, v218, s83
    v_mfma_f32_16x16x32_bf16 a[72:75], v[56:59], a[96:99], a[72:75]
    v_mfma_f32_16x16x32_bf16 a[76:79], v[56:59], a[100:103], a[76:79]
    v_mfma_f32_16x16x32_bf16 a[80:83], v[56:59], a[104:107], a[80:83]
    v_perm_b32 v56, v199, v195, s82
    v_perm_b32 v57, v207, v203, s82
    v_perm_b32 v58, v215, v211, s82
    v_perm_b32 v59, v223, v219, s82
    v_mfma_f32_16x16x32_bf16 a[84:87], v[60:63], a[96:99], a[84:87]
    v_mfma_f32_16x16x32_bf16 a[88:91], v[60:63], a[100:103], a[88:91]
    v_mfma_f32_16x16x32_bf16 a[92:95], v[60:63], a[104:107], a[92:95]
    v_perm_b32 v60, v199, v195, s83
    v_perm_b32 v61, v207, v203, s83
    v_perm_b32 v62, v215, v211, s83
    v_perm_b32 v63, v223, v219, s83
    s_add_u32 s89, s71, 15
    s_and_b32 s89, s89, 15
    s_lshl_b32 s89, s89, 18
    s_add_u32 s77, s88, s89
    buffer_load_dwordx4 v[160:163], v3, s[56:59], s77 offen
    s_add_u32 s77, s77, 0x2000
    buffer_load_dwordx4 v[164:167], v3, s[56:59], s77 offen
    s_add_u32 s77, s77, 0x2000
    buffer_load_dwordx4 v[168:171], v3, s[56:59], s77 offen
    s_add_u32 s77, s77, 0x2000
    buffer_load_dwordx4 v[172:175], v3, s[56:59], s77 offen
    s_add_u32 s77, s77, 0x2000
    buffer_load_dwordx4 v[176:179], v3, s[56:59], s77 offen
    s_add_u32 s77, s77, 0x2000
    buffer_load_dwordx4 v[180:183], v3, s[56:59], s77 offen
    s_add_u32 s77, s77, 0x2000
    buffer_load_dwordx4 v[184:187], v3, s[56:59], s77 offen
    s_add_u32 s77, s77, 0x2000
    buffer_load_dwordx4 v[188:191], v3, s[56:59], s77 offen
    s_add_u32 m0, s84, 0
    s_add_u32 s79, s78, 0
    buffer_load_dwordx4 v12, s[48:51], s79 offen nt lds
    s_add_u32 m0, s84, 0
    s_add_u32 s79, s78, 0
    buffer_load_dwordx4 v13, s[48:51], s79 offen offset:1024 nt lds
    s_add_u32 m0, s84, 0
    s_add_u32 s79, s78, 0
    buffer_load_dwordx4 v14, s[48:51], s79 offen offset:2048 nt lds
    s_add_u32 m0, s84, 0
    s_add_u32 s79, s78, 0
    buffer_load_dwordx4 v15, s[48:51], s79 offen offset:3072 nt lds
    s_barrier
    ds_read_b128 a[96:99], v8 offset:36864
    ds_read_b128 a[100:103], v8 offset:37888
    ds_read_b128 a[104:107], v8 offset:38912
    s_waitcnt lgkmcnt(8)
    v_mfma_f32_16x16x32_bf16 a[0:3], v[32:35], a[108:111], a[0:3]
    s_waitcnt lgkmcnt(7)
    v_mfma_f32_16x16x32_bf16 a[4:7], v[32:35], a[112:115], a[4:7]
    s_waitcnt lgkmcnt(6)
    v_mfma_f32_16x16x32_bf16 a[8:11], v[32:35], a[116:119], a[8:11]
    s_waitcnt vmcnt(42)
    v_perm_b32 v32, v228, v224, s82
    s_waitcnt vmcnt(40)
    v_perm_b32 v33, v236, v232, s82
    s_waitcnt vmcnt(38)
    v_perm_b32 v34, v244, v240, s82
    s_waitcnt vmcnt(36)
    v_perm_b32 v35, v252, v248, s82
    v_mfma_f32_16x16x32_bf16 a[12:15], v[36:39], a[108:111], a[12:15]
    v_mfma_f32_16x16x32_bf16 a[16:19], v[36:39], a[112:115], a[16:19]
    v_mfma_f32_16x16x32_bf16 a[20:23], v[36:39], a[116:119], a[20:23]
    v_perm_b32 v36, v228, v224, s83
    v_perm_b32 v37, v236, v232, s83
    v_perm_b32 v38, v244, v240, s83
    v_perm_b32 v39, v252, v248, s83
    v_mfma_f32_16x16x32_bf16 a[24:27], v[40:43], a[108:111], a[24:27]
    v_mfma_f32_16x16x32_bf16 a[28:31], v[40:43], a[112:115], a[28:31]
    v_mfma_f32_16x16x32_bf16 a[32:35], v[40:43], a[116:119], a[32:35]
    v_perm_b32 v40, v229, v225, s82
    v_perm_b32 v41, v237, v233, s82
    v_perm_b32 v42, v245, v241, s82
    v_perm_b32 v43, v253, v249, s82
    v_mfma_f32_16x16x32_bf16 a[36:39], v[44:47], a[108:111], a[36:39]
    v_mfma_f32_16x16x32_bf16 a[40:43], v[44:47], a[112:115], a[40:43]
    v_mfma_f32_16x16x32_bf16 a[44:47], v[44:47], a[116:119], a[44:47]
    v_perm_b32 v44, v229, v225, s83
    v_perm_b32 v45, v237, v233, s83
    v_perm_b32 v46, v245, v241, s83
    v_perm_b32 v47, v253, v249, s83
    v_mfma_f32_16x16x32_bf16 a[48:51], v[48:51], a[108:111], a[48:51]
    v_mfma_f32_16x16x32_bf16 a[52:55], v[48:51], a[112:115], a[52:55]
    v_mfma_f32_16x16x32_bf16 a[56:59], v[48:51], a[116:119], a[56:59]
    v_perm_b32 v48, v230, v226, s82
    v_perm_b32 v49, v238, v234, s82
    v_perm_b32 v50, v246, v242, s82
    v_perm_b32 v51, v254, v250, s82
    v_mfma_f32_16x16x32_bf16 a[60:63], v[52:55], a[108:111], a[60:63]
    v_mfma_f32_16x16x32_bf16 a[64:67], v[52:55], a[112:115], a[64:67]
    v_mfma_f32_16x16x32_bf16 a[68:71], v[52:55], a[116:119], a[68:71]
    v_perm_b32 v52, v230, v226, s83
    v_perm_b32 v53, v238, v234, s83
    v_perm_b32 v54, v246, v242, s83
    v_perm_b32 v55, v254, v250, s83
    v_mfma_f32_16x16x32_bf16 a[72:75], v[56:59], a[108:111], a[72:75]
    v_mfma_f32_16x16x32_bf16 a[76:79], v[56:59], a[112:115], a[76:79]
    v_mfma_f32_16x16x32_bf16 a[80:83], v[56:59], a[116:119], a[80:83]
    v_perm_b32 v56, v231, v227, s82
    v_perm_b32 v57, v239, v235, s82
    v_perm_b32 v58, v247, v243, s82
    v_perm_b32 v59, v255, v251, s82
    v_mfma_f32_16x16x32_bf16 a[84:87], v[60:63], a[108:111], a[84:87]
    v_mfma_f32_16x16x32_bf16 a[88:91], v[60:63], a[112:115], a[88:91]
    v_mfma_f32_16x16x32_bf16 a[92:95], v[60:63], a[116:119], a[92:95]
    v_perm_b32 v60, v231, v227, s83
    v_perm_b32 v61, v239, v235, s83
    v_perm_b32 v62, v247, v243, s83
    v_perm_b32 v63, v255, v251, s83
    s_add_u32 m0, s84, 0x4000
    s_add_u32 s79, s78, 0
    buffer_load_dwordx4 v16, s[52:55], s79 offen nt lds
    s_add_u32 m0, s84, 0x4000
    s_add_u32 s79, s78, 0
    buffer_load_dwordx4 v17, s[52:55], s79 offen offset:1024 nt lds
    s_add_u32 m0, s84, 0x4000
    s_add_u32 s79, s78, 0
    buffer_load_dwordx4 v16, s[52:55], s79 offen offset:2048 nt lds
    s_add_u32 m0, s84, 0x4000
    s_add_u32 s79, s78, 0
    buffer_load_dwordx4 v17, s[52:55], s79 offen offset:3072 nt lds
    ds_read_b128 a[108:111], v8 offset:39936
    ds_read_b128 a[112:115], v8 offset:40960
    ds_read_b128 a[116:119], v8 offset:41984
    s_waitcnt lgkmcnt(8)
    v_mfma_f32_16x16x32_bf16 a[0:3], v[32:35], a[120:123], a[0:3]
    s_waitcnt lgkmcnt(7)
    v_mfma_f32_16x16x32_bf16 a[4:7], v[32:35], a[124:127], a[4:7]
    s_waitcnt lgkmcnt(6)
    v_mfma_f32_16x16x32_bf16 a[8:11], v[32:35], a[128:131], a[8:11]
    s_waitcnt vmcnt(38)
    v_perm_b32 v32, v68, v64, s82
    s_waitcnt vmcnt(36)
    v_perm_b32 v33, v76, v72, s82
    s_waitcnt vmcnt(34)
    v_perm_b32 v34, v84, v80, s82
    s_waitcnt vmcnt(32)
    v_perm_b32 v35, v92, v88, s82
    v_mfma_f32_16x16x32_bf16 a[12:15], v[36:39], a[120:123], a[12:15]
    v_mfma_f32_16x16x32_bf16 a[16:19], v[36:39], a[124:127], a[16:19]
    v_mfma_f32_16x16x32_bf16 a[20:23], v[36:39], a[128:131], a[20:23]
    v_perm_b32 v36, v68, v64, s83
    v_perm_b32 v37, v76, v72, s83
    v_perm_b32 v38, v84, v80, s83
    v_perm_b32 v39, v92, v88, s83
    v_mfma_f32_16x16x32_bf16 a[24:27], v[40:43], a[120:123], a[24:27]
    v_mfma_f32_16x16x32_bf16 a[28:31], v[40:43], a[124:127], a[28:31]
    v_mfma_f32_16x16x32_bf16 a[32:35], v[40:43], a[128:131], a[32:35]
    v_perm_b32 v40, v69, v65, s82
    v_perm_b32 v41, v77, v73, s82
    v_perm_b32 v42, v85, v81, s82
    v_perm_b32 v43, v93, v89, s82
    v_mfma_f32_16x16x32_bf16 a[36:39], v[44:47], a[120:123], a[36:39]
    v_mfma_f32_16x16x32_bf16 a[40:43], v[44:47], a[124:127], a[40:43]
    v_mfma_f32_16x16x32_bf16 a[44:47], v[44:47], a[128:131], a[44:47]
    v_perm_b32 v44, v69, v65, s83
    v_perm_b32 v45, v77, v73, s83
    v_perm_b32 v46, v85, v81, s83
    v_perm_b32 v47, v93, v89, s83
    v_mfma_f32_16x16x32_bf16 a[48:51], v[48:51], a[120:123], a[48:51]
    v_mfma_f32_16x16x32_bf16 a[52:55], v[48:51], a[124:127], a[52:55]
    v_mfma_f32_16x16x32_bf16 a[56:59], v[48:51], a[128:131], a[56:59]
    v_perm_b32 v48, v70, v66, s82
    v_perm_b32 v49, v78, v74, s82
    v_perm_b32 v50, v86, v82, s82
    v_perm_b32 v51, v94, v90, s82
    v_mfma_f32_16x16x32_bf16 a[60:63], v[52:55], a[120:123], a[60:63]
    v_mfma_f32_16x16x32_bf16 a[64:67], v[52:55], a[124:127], a[64:67]
    v_mfma_f32_16x16x32_bf16 a[68:71], v[52:55], a[128:131], a[68:71]
    v_perm_b32 v52, v70, v66, s83
    v_perm_b32 v53, v78, v74, s83
    v_perm_b32 v54, v86, v82, s83
    v_perm_b32 v55, v94, v90, s83
    v_mfma_f32_16x16x32_bf16 a[72:75], v[56:59], a[120:123], a[72:75]
    v_mfma_f32_16x16x32_bf16 a[76:79], v[56:59], a[124:127], a[76:79]
    v_mfma_f32_16x16x32_bf16 a[80:83], v[56:59], a[128:131], a[80:83]
    v_perm_b32 v56, v71, v67, s82
    v_perm_b32 v57, v79, v75, s82
    v_perm_b32 v58, v87, v83, s82
    v_perm_b32 v59, v95, v91, s82
    v_mfma_f32_16x16x32_bf16 a[84:87], v[60:63], a[120:123], a[84:87]
    v_mfma_f32_16x16x32_bf16 a[88:91], v[60:63], a[124:127], a[88:91]
    v_mfma_f32_16x16x32_bf16 a[92:95], v[60:63], a[128:131], a[92:95]
    v_perm_b32 v60, v71, v67, s83
    v_perm_b32 v61, v79, v75, s83
    v_perm_b32 v62, v87, v83, s83
    v_perm_b32 v63, v95, v91, s83
    s_add_u32 m0, s84, 0x8000
    s_add_u32 s79, s78, 0x4000
    buffer_load_dwordx4 v12, s[48:51], s79 offen nt lds
    s_add_u32 m0, s84, 0x8000
    s_add_u32 s79, s78, 0x4000
    buffer_load_dwordx4 v13, s[48:51], s79 offen offset:1024 nt lds
    s_add_u32 m0, s84, 0x8000
    s_add_u32 s79, s78, 0x4000
    buffer_load_dwordx4 v14, s[48:51], s79 offen offset:2048 nt lds
    s_add_u32 m0, s84, 0x8000
    s_add_u32 s79, s78, 0x4000
    buffer_load_dwordx4 v15, s[48:51], s79 offen offset:3072 nt lds
    ds_read_b128 a[120:123], v8 offset:43008
    ds_read_b128 a[124:127], v8 offset:44032
    ds_read_b128 a[128:131], v8 offset:45056
    s_waitcnt lgkmcnt(8)
    v_mfma_f32_16x16x32_bf16 a[0:3], v[32:35], a[96:99], a[0:3]
    s_waitcnt lgkmcnt(7)
    v_mfma_f32_16x16x32_bf16 a[4:7], v[32:35], a[100:103], a[4:7]
    s_waitcnt lgkmcnt(6)
    v_mfma_f32_16x16x32_bf16 a[8:11], v[32:35], a[104:107], a[8:11]
    s_waitcnt vmcnt(34)
    v_perm_b32 v32, v100, v96, s82
    s_waitcnt vmcnt(32)
    v_perm_b32 v33, v108, v104, s82
    s_waitcnt vmcnt(30)
    v_perm_b32 v34, v116, v112, s82
    s_waitcnt vmcnt(28)
    v_perm_b32 v35, v124, v120, s82
    v_mfma_f32_16x16x32_bf16 a[12:15], v[36:39], a[96:99], a[12:15]
    v_mfma_f32_16x16x32_bf16 a[16:19], v[36:39], a[100:103], a[16:19]
    v_mfma_f32_16x16x32_bf16 a[20:23], v[36:39], a[104:107], a[20:23]
    v_perm_b32 v36, v100, v96, s83
    v_perm_b32 v37, v108, v104, s83
    v_perm_b32 v38, v116, v112, s83
    v_perm_b32 v39, v124, v120, s83
    v_mfma_f32_16x16x32_bf16 a[24:27], v[40:43], a[96:99], a[24:27]
    v_mfma_f32_16x16x32_bf16 a[28:31], v[40:43], a[100:103], a[28:31]
    v_mfma_f32_16x16x32_bf16 a[32:35], v[40:43], a[104:107], a[32:35]
    v_perm_b32 v40, v101, v97, s82
    v_perm_b32 v41, v109, v105, s82
    v_perm_b32 v42, v117, v113, s82
    v_perm_b32 v43, v125, v121, s82
    v_mfma_f32_16x16x32_bf16 a[36:39], v[44:47], a[96:99], a[36:39]
    v_mfma_f32_16x16x32_bf16 a[40:43], v[44:47], a[100:103], a[40:43]
    v_mfma_f32_16x16x32_bf16 a[44:47], v[44:47], a[104:107], a[44:47]
    v_perm_b32 v44, v101, v97, s83
    v_perm_b32 v45, v109, v105, s83
    v_perm_b32 v46, v117, v113, s83
    v_perm_b32 v47, v125, v121, s83
    v_mfma_f32_16x16x32_bf16 a[48:51], v[48:51], a[96:99], a[48:51]
    v_mfma_f32_16x16x32_bf16 a[52:55], v[48:51], a[100:103], a[52:55]
    v_mfma_f32_16x16x32_bf16 a[56:59], v[48:51], a[104:107], a[56:59]
    v_perm_b32 v48, v102, v98, s82
    v_perm_b32 v49, v110, v106, s82
    v_perm_b32 v50, v118, v114, s82
    v_perm_b32 v51, v126, v122, s82
    v_mfma_f32_16x16x32_bf16 a[60:63], v[52:55], a[96:99], a[60:63]
    v_mfma_f32_16x16x32_bf16 a[64:67], v[52:55], a[100:103], a[64:67]
    v_mfma_f32_16x16x32_bf16 a[68:71], v[52:55], a[104:107], a[68:71]
    v_perm_b32 v52, v102, v98, s83
    v_perm_b32 v53, v110, v106, s83
    v_perm_b32 v54, v118, v114, s83
    v_perm_b32 v55, v126, v122, s83
    v_mfma_f32_16x16x32_bf16 a[72:75], v[56:59], a[96:99], a[72:75]
    v_mfma_f32_16x16x32_bf16 a[76:79], v[56:59], a[100:103], a[76:79]
    v_mfma_f32_16x16x32_bf16 a[80:83], v[56:59], a[104:107], a[80:83]
    v_perm_b32 v56, v103, v99, s82
    v_perm_b32 v57, v111, v107, s82
    v_perm_b32 v58, v119, v115, s82
    v_perm_b32 v59, v127, v123, s82
    v_mfma_f32_16x16x32_bf16 a[84:87], v[60:63], a[96:99], a[84:87]
    v_mfma_f32_16x16x32_bf16 a[88:91], v[60:63], a[100:103], a[88:91]
    v_mfma_f32_16x16x32_bf16 a[92:95], v[60:63], a[104:107], a[92:95]
    v_perm_b32 v60, v103, v99, s83
    v_perm_b32 v61, v111, v107, s83
    v_perm_b32 v62, v119, v115, s83
    v_perm_b32 v63, v127, v123, s83
    s_add_u32 m0, s84, 0xc000
    s_add_u32 s79, s78, 0x4000
    buffer_load_dwordx4 v16, s[52:55], s79 offen nt lds
    s_add_u32 m0, s84, 0xc000
    s_add_u32 s79, s78, 0x4000
    buffer_load_dwordx4 v17, s[52:55], s79 offen offset:1024 nt lds
    s_add_u32 m0, s84, 0xc000
    s_add_u32 s79, s78, 0x4000
    buffer_load_dwordx4 v16, s[52:55], s79 offen offset:2048 nt lds
    s_add_u32 m0, s84, 0xc000
    s_add_u32 s79, s78, 0x4000
    buffer_load_dwordx4 v17, s[52:55], s79 offen offset:3072 nt lds
    ds_read_b128 a[96:99], v8 offset:46080
    ds_read_b128 a[100:103], v8 offset:47104
    ds_read_b128 a[104:107], v8 offset:48128
    s_waitcnt lgkmcnt(8)
    v_mfma_f32_16x16x32_bf16 a[0:3], v[32:35], a[108:111], a[0:3]
    s_waitcnt lgkmcnt(7)
    v_mfma_f32_16x16x32_bf16 a[4:7], v[32:35], a[112:115], a[4:7]
    s_waitcnt lgkmcnt(6)
    v_mfma_f32_16x16x32_bf16 a[8:11], v[32:35], a[116:119], a[8:11]
    s_waitcnt vmcnt(30)
    v_perm_b32 v32, v132, v128, s82
    s_waitcnt vmcnt(28)
    v_perm_b32 v33, v140, v136, s82
    s_waitcnt vmcnt(26)
    v_perm_b32 v34, v148, v144, s82
    s_waitcnt vmcnt(24)
    v_perm_b32 v35, v156, v152, s82
    v_mfma_f32_16x16x32_bf16 a[12:15], v[36:39], a[108:111], a[12:15]
    v_mfma_f32_16x16x32_bf16 a[16:19], v[36:39], a[112:115], a[16:19]
    v_mfma_f32_16x16x32_bf16 a[20:23], v[36:39], a[116:119], a[20:23]
    v_perm_b32 v36, v132, v128, s83
    v_perm_b32 v37, v140, v136, s83
    v_perm_b32 v38, v148, v144, s83
    v_perm_b32 v39, v156, v152, s83
    v_mfma_f32_16x16x32_bf16 a[24:27], v[40:43], a[108:111], a[24:27]
    v_mfma_f32_16x16x32_bf16 a[28:31], v[40:43], a[112:115], a[28:31]
    v_mfma_f32_16x16x32_bf16 a[32:35], v[40:43], a[116:119], a[32:35]
    v_perm_b32 v40, v133, v129, s82
    v_perm_b32 v41, v141, v137, s82
    v_perm_b32 v42, v149, v145, s82
    v_perm_b32 v43, v157, v153, s82
    v_mfma_f32_16x16x32_bf16 a[36:39], v[44:47], a[108:111], a[36:39]
    v_mfma_f32_16x16x32_bf16 a[40:43], v[44:47], a[112:115], a[40:43]
    v_mfma_f32_16x16x32_bf16 a[44:47], v[44:47], a[116:119], a[44:47]
    v_perm_b32 v44, v133, v129, s83
    v_perm_b32 v45, v141, v137, s83
    v_perm_b32 v46, v149, v145, s83
    v_perm_b32 v47, v157, v153, s83
    v_mfma_f32_16x16x32_bf16 a[48:51], v[48:51], a[108:111], a[48:51]
    v_mfma_f32_16x16x32_bf16 a[52:55], v[48:51], a[112:115], a[52:55]
    v_mfma_f32_16x16x32_bf16 a[56:59], v[48:51], a[116:119], a[56:59]
    v_perm_b32 v48, v134, v130, s82
    v_perm_b32 v49, v142, v138, s82
    v_perm_b32 v50, v150, v146, s82
    v_perm_b32 v51, v158, v154, s82
    v_mfma_f32_16x16x32_bf16 a[60:63], v[52:55], a[108:111], a[60:63]
    v_mfma_f32_16x16x32_bf16 a[64:67], v[52:55], a[112:115], a[64:67]
    v_mfma_f32_16x16x32_bf16 a[68:71], v[52:55], a[116:119], a[68:71]
    v_perm_b32 v52, v134, v130, s83
    v_perm_b32 v53, v142, v138, s83
    v_perm_b32 v54, v150, v146, s83
    v_perm_b32 v55, v158, v154, s83
    v_mfma_f32_16x16x32_bf16 a[72:75], v[56:59], a[108:111], a[72:75]
    v_mfma_f32_16x16x32_bf16 a[76:79], v[56:59], a[112:115], a[76:79]
    v_mfma_f32_16x16x32_bf16 a[80:83], v[56:59], a[116:119], a[80:83]
    v_perm_b32 v56, v135, v131, s82
    v_perm_b32 v57, v143, v139, s82
    v_perm_b32 v58, v151, v147, s82
    v_perm_b32 v59, v159, v155, s82
    v_mfma_f32_16x16x32_bf16 a[84:87], v[60:63], a[108:111], a[84:87]
    v_mfma_f32_16x16x32_bf16 a[88:91], v[60:63], a[112:115], a[88:91]
    v_mfma_f32_16x16x32_bf16 a[92:95], v[60:63], a[116:119], a[92:95]
    v_perm_b32 v60, v135, v131, s83
    v_perm_b32 v61, v143, v139, s83
    v_perm_b32 v62, v151, v147, s83
    v_perm_b32 v63, v159, v155, s83
    s_add_u32 m0, s84, 0x10000
    s_add_u32 s79, s78, 0x8000
    buffer_load_dwordx4 v12, s[48:51], s79 offen nt lds
    s_add_u32 m0, s84, 0x10000
    s_add_u32 s79, s78, 0x8000
    buffer_load_dwordx4 v13, s[48:51], s79 offen offset:1024 nt lds
    s_add_u32 m0, s84, 0x10000
    s_add_u32 s79, s78, 0x8000
    buffer_load_dwordx4 v14, s[48:51], s79 offen offset:2048 nt lds
    s_add_u32 m0, s84, 0x10000
    s_add_u32 s79, s78, 0x8000
    buffer_load_dwordx4 v15, s[48:51], s79 offen offset:3072 nt lds
    s_waitcnt lgkmcnt(5)
    v_mfma_f32_16x16x32_bf16 a[0:3], v[32:35], a[120:123], a[0:3]
    s_waitcnt lgkmcnt(4)
    v_mfma_f32_16x16x32_bf16 a[4:7], v[32:35], a[124:127], a[4:7]
    s_waitcnt lgkmcnt(3)
    v_mfma_f32_16x16x32_bf16 a[8:11], v[32:35], a[128:131], a[8:11]
    s_waitcnt vmcnt(26)
    v_perm_b32 v32, v164, v160, s82
    s_waitcnt vmcnt(24)
    v_perm_b32 v33, v172, v168, s82
    s_waitcnt vmcnt(22)
    v_perm_b32 v34, v180, v176, s82
    s_waitcnt vmcnt(20)
    v_perm_b32 v35, v188, v184, s82
    v_mfma_f32_16x16x32_bf16 a[12:15], v[36:39], a[120:123], a[12:15]
    v_mfma_f32_16x16x32_bf16 a[16:19], v[36:39], a[124:127], a[16:19]
    v_mfma_f32_16x16x32_bf16 a[20:23], v[36:39], a[128:131], a[20:23]
    v_perm_b32 v36, v164, v160, s83
    v_perm_b32 v37, v172, v168, s83
    v_perm_b32 v38, v180, v176, s83
    v_perm_b32 v39, v188, v184, s83
    v_mfma_f32_16x16x32_bf16 a[24:27], v[40:43], a[120:123], a[24:27]
    v_mfma_f32_16x16x32_bf16 a[28:31], v[40:43], a[124:127], a[28:31]
    v_mfma_f32_16x16x32_bf16 a[32:35], v[40:43], a[128:131], a[32:35]
    v_perm_b32 v40, v165, v161, s82
    v_perm_b32 v41, v173, v169, s82
    v_perm_b32 v42, v181, v177, s82
    v_perm_b32 v43, v189, v185, s82
    v_mfma_f32_16x16x32_bf16 a[36:39], v[44:47], a[120:123], a[36:39]
    v_mfma_f32_16x16x32_bf16 a[40:43], v[44:47], a[124:127], a[40:43]
    v_mfma_f32_16x16x32_bf16 a[44:47], v[44:47], a[128:131], a[44:47]
    v_perm_b32 v44, v165, v161, s83
    v_perm_b32 v45, v173, v169, s83
    v_perm_b32 v46, v181, v177, s83
    v_perm_b32 v47, v189, v185, s83
    v_mfma_f32_16x16x32_bf16 a[48:51], v[48:51], a[120:123], a[48:51]
    v_mfma_f32_16x16x32_bf16 a[52:55], v[48:51], a[124:127], a[52:55]
    v_mfma_f32_16x16x32_bf16 a[56:59], v[48:51], a[128:131], a[56:59]
    v_perm_b32 v48, v166, v162, s82
    v_perm_b32 v49, v174, v170, s82
    v_perm_b32 v50, v182, v178, s82
    v_perm_b32 v51, v190, v186, s82
    v_mfma_f32_16x16x32_bf16 a[60:63], v[52:55], a[120:123], a[60:63]
    v_mfma_f32_16x16x32_bf16 a[64:67], v[52:55], a[124:127], a[64:67]
    v_mfma_f32_16x16x32_bf16 a[68:71], v[52:55], a[128:131], a[68:71]
    v_perm_b32 v52, v166, v162, s83
    v_perm_b32 v53, v174, v170, s83
    v_perm_b32 v54, v182, v178, s83
    v_perm_b32 v55, v190, v186, s83
    v_mfma_f32_16x16x32_bf16 a[72:75], v[56:59], a[120:123], a[72:75]
    v_mfma_f32_16x16x32_bf16 a[76:79], v[56:59], a[124:127], a[76:79]
    v_mfma_f32_16x16x32_bf16 a[80:83], v[56:59], a[128:131], a[80:83]
    v_perm_b32 v56, v167, v163, s82
    v_perm_b32 v57, v175, v171, s82
    v_perm_b32 v58, v183, v179, s82
    v_perm_b32 v59, v191, v187, s82
    v_mfma_f32_16x16x32_bf16 a[84:87], v[60:63], a[120:123], a[84:87]
    v_mfma_f32_16x16x32_bf16 a[88:91], v[60:63], a[124:127], a[88:91]
    v_mfma_f32_16x16x32_bf16 a[92:95], v[60:63], a[128:131], a[92:95]
    v_perm_b32 v60, v167, v163, s83
    v_perm_b32 v61, v175, v171, s83
    v_perm_b32 v62, v183, v179, s83
    v_perm_b32 v63, v191, v187, s83
    s_add_u32 m0, s84, 0x14000
    s_add_u32 s79, s78, 0x8000
    buffer_load_dwordx4 v16, s[52:55], s79 offen nt lds
    s_add_u32 m0, s84, 0x14000
    s_add_u32 s79, s78, 0x8000
    buffer_load_dwordx4 v17, s[52:55], s79 offen offset:1024 nt lds
    s_add_u32 m0, s84, 0x14000
    s_add_u32 s79, s78, 0x8000
    buffer_load_dwordx4 v16, s[52:55], s79 offen offset:2048 nt lds
    s_add_u32 m0, s84, 0x14000
    s_add_u32 s79, s78, 0x8000
    buffer_load_dwordx4 v17, s[52:55], s79 offen offset:3072 nt lds
    s_waitcnt lgkmcnt(2)
    v_mfma_f32_16x16x32_bf16 a[0:3], v[32:35], a[96:99], a[0:3]
    s_waitcnt lgkmcnt(1)
    v_mfma_f32_16x16x32_bf16 a[4:7], v[32:35], a[100:103], a[4:7]
    s_waitcnt lgkmcnt(0)
    v_mfma_f32_16x16x32_bf16 a[8:11], v[32:35], a[104:107], a[8:11]
    v_mfma_f32_16x16x32_bf16 a[12:15], v[36:39], a[96:99], a[12:15]
    v_mfma_f32_16x16x32_bf16 a[16:19], v[36:39], a[100:103], a[16:19]
    v_mfma_f32_16x16x32_bf16 a[20:23], v[36:39], a[104:107], a[20:23]
    v_mfma_f32_16x16x32_bf16 a[24:27], v[40:43], a[96:99], a[24:27]
    v_mfma_f32_16x16x32_bf16 a[28:31], v[40:43], a[100:103], a[28:31]
    v_mfma_f32_16x16x32_bf16 a[32:35], v[40:43], a[104:107], a[32:35]
    v_mfma_f32_16x16x32_bf16 a[36:39], v[44:47], a[96:99], a[36:39]
    v_mfma_f32_16x16x32_bf16 a[40:43], v[44:47], a[100:103], a[40:43]
    v_mfma_f32_16x16x32_bf16 a[44:47], v[44:47], a[104:107], a[44:47]
    v_mfma_f32_16x16x32_bf16 a[48:51], v[48:51], a[96:99], a[48:51]
    v_mfma_f32_16x16x32_bf16 a[52:55], v[48:51], a[100:103], a[52:55]
    v_mfma_f32_16x16x32_bf16 a[56:59], v[48:51], a[104:107], a[56:59]
    v_mfma_f32_16x16x32_bf16 a[60:63], v[52:55], a[96:99], a[60:63]
    v_mfma_f32_16x16x32_bf16 a[64:67], v[52:55], a[100:103], a[64:67]
    v_mfma_f32_16x16x32_bf16 a[68:71], v[52:55], a[104:107], a[68:71]
    v_mfma_f32_16x16x32_bf16 a[72:75], v[56:59], a[96:99], a[72:75]
    v_mfma_f32_16x16x32_bf16 a[76:79], v[56:59], a[100:103], a[76:79]
    v_mfma_f32_16x16x32_bf16 a[80:83], v[56:59], a[104:107], a[80:83]
    v_mfma_f32_16x16x32_bf16 a[84:87], v[60:63], a[96:99], a[84:87]
    v_mfma_f32_16x16x32_bf16 a[88:91], v[60:63], a[100:103], a[88:91]
    v_mfma_f32_16x16x32_bf16 a[92:95], v[60:63], a[104:107], a[92:95]
    s_add_u32 m0, s84, 0x18000
    s_add_u32 s79, s78, 0xc000
    buffer_load_dwordx4 v12, s[48:51], s79 offen nt lds
    s_add_u32 m0, s84, 0x18000
    s_add_u32 s79, s78, 0xc000
    buffer_load_dwordx4 v13, s[48:51], s79 offen offset:1024 nt lds
    s_add_u32 m0, s84, 0x18000
    s_add_u32 s79, s78, 0xc000
    buffer_load_dwordx4 v14, s[48:51], s79 offen offset:2048 nt lds
    s_add_u32 m0, s84, 0x18000
    s_add_u32 s79, s78, 0xc000
    buffer_load_dwordx4 v15, s[48:51], s79 offen offset:3072 nt lds
    v_accvgpr_read_b32 v208, a0
    v_accvgpr_read_b32 v209, a12
    v_mul_f32 v208, s86, v208
    v_mul_f32 v209, s86, v209
    v_cvt_pk_bf16_f32 v160, v208, v209
    v_accvgpr_read_b32 v210, a24
    v_accvgpr_read_b32 v211, a36
    v_mul_f32 v210, s86, v210
    v_mul_f32 v211, s86, v211
    v_cvt_pk_bf16_f32 v161, v210, v211
    v_accvgpr_read_b32 v212, a48
    v_accvgpr_read_b32 v213, a60
    v_mul_f32 v212, s86, v212
    v_mul_f32 v213, s86, v213
    v_cvt_pk_bf16_f32 v162, v212, v213
    v_accvgpr_read_b32 v214, a72
    v_accvgpr_read_b32 v215, a84
    v_mul_f32 v214, s86, v214
    v_mul_f32 v215, s86, v215
    v_cvt_pk_bf16_f32 v163, v214, v215
    v_accvgpr_read_b32 v216, a1
    v_accvgpr_read_b32 v217, a13
    v_mul_f32 v216, s86, v216
    v_mul_f32 v217, s86, v217
    v_cvt_pk_bf16_f32 v164, v216, v217
    v_accvgpr_read_b32 v218, a25
    v_accvgpr_read_b32 v219, a37
    v_mul_f32 v218, s86, v218
    v_mul_f32 v219, s86, v219
    v_cvt_pk_bf16_f32 v165, v218, v219
    v_accvgpr_read_b32 v220, a49
    v_accvgpr_read_b32 v221, a61
    v_mul_f32 v220, s86, v220
    v_mul_f32 v221, s86, v221
    v_cvt_pk_bf16_f32 v166, v220, v221
    v_accvgpr_read_b32 v222, a73
    v_accvgpr_read_b32 v223, a85
    v_mul_f32 v222, s86, v222
    v_mul_f32 v223, s86, v223
    v_cvt_pk_bf16_f32 v167, v222, v223
    v_accvgpr_read_b32 v208, a2
    v_accvgpr_read_b32 v209, a14
    v_mul_f32 v208, s86, v208
    v_mul_f32 v209, s86, v209
    v_cvt_pk_bf16_f32 v168, v208, v209
    v_accvgpr_read_b32 v210, a26
    v_accvgpr_read_b32 v211, a38
    v_mul_f32 v210, s86, v210
    v_mul_f32 v211, s86, v211
    v_cvt_pk_bf16_f32 v169, v210, v211
    v_accvgpr_read_b32 v212, a50
    v_accvgpr_read_b32 v213, a62
    v_mul_f32 v212, s86, v212
    v_mul_f32 v213, s86, v213
    v_cvt_pk_bf16_f32 v170, v212, v213
    v_accvgpr_read_b32 v214, a74
    v_accvgpr_read_b32 v215, a86
    v_mul_f32 v214, s86, v214
    v_mul_f32 v215, s86, v215
    v_cvt_pk_bf16_f32 v171, v214, v215
    v_accvgpr_read_b32 v216, a3
    v_accvgpr_read_b32 v217, a15
    v_mul_f32 v216, s86, v216
    v_mul_f32 v217, s86, v217
    v_cvt_pk_bf16_f32 v172, v216, v217
    v_accvgpr_read_b32 v218, a27
    v_accvgpr_read_b32 v219, a39
    v_mul_f32 v218, s86, v218
    v_mul_f32 v219, s86, v219
    v_cvt_pk_bf16_f32 v173, v218, v219
    v_accvgpr_read_b32 v220, a51
    v_accvgpr_read_b32 v221, a63
    v_mul_f32 v220, s86, v220
    v_mul_f32 v221, s86, v221
    v_cvt_pk_bf16_f32 v174, v220, v221
    v_accvgpr_read_b32 v222, a75
    v_accvgpr_read_b32 v223, a87
    v_mul_f32 v222, s86, v222
    v_mul_f32 v223, s86, v223
    v_cvt_pk_bf16_f32 v175, v222, v223
    v_accvgpr_read_b32 v208, a4
    v_accvgpr_read_b32 v209, a16
    v_mul_f32 v208, s86, v208
    v_mul_f32 v209, s86, v209
    v_cvt_pk_bf16_f32 v176, v208, v209
    v_accvgpr_read_b32 v210, a28
    v_accvgpr_read_b32 v211, a40
    v_mul_f32 v210, s86, v210
    v_mul_f32 v211, s86, v211
    v_cvt_pk_bf16_f32 v177, v210, v211
    v_accvgpr_read_b32 v212, a52
    v_accvgpr_read_b32 v213, a64
    v_mul_f32 v212, s86, v212
    v_mul_f32 v213, s86, v213
    v_cvt_pk_bf16_f32 v178, v212, v213
    v_accvgpr_read_b32 v214, a76
    v_accvgpr_read_b32 v215, a88
    v_mul_f32 v214, s86, v214
    v_mul_f32 v215, s86, v215
    v_cvt_pk_bf16_f32 v179, v214, v215
    v_accvgpr_read_b32 v216, a5
    v_accvgpr_read_b32 v217, a17
    v_mul_f32 v216, s86, v216
    v_mul_f32 v217, s86, v217
    v_cvt_pk_bf16_f32 v180, v216, v217
    v_accvgpr_read_b32 v218, a29
    v_accvgpr_read_b32 v219, a41
    v_mul_f32 v218, s86, v218
    v_mul_f32 v219, s86, v219
    v_cvt_pk_bf16_f32 v181, v218, v219
    v_accvgpr_read_b32 v220, a53
    v_accvgpr_read_b32 v221, a65
    v_mul_f32 v220, s86, v220
    v_mul_f32 v221, s86, v221
    v_cvt_pk_bf16_f32 v182, v220, v221
    v_accvgpr_read_b32 v222, a77
    v_accvgpr_read_b32 v223, a89
    v_mul_f32 v222, s86, v222
    v_mul_f32 v223, s86, v223
    v_cvt_pk_bf16_f32 v183, v222, v223
    v_accvgpr_read_b32 v208, a6
    v_accvgpr_read_b32 v209, a18
    v_mul_f32 v208, s86, v208
    v_mul_f32 v209, s86, v209
    v_cvt_pk_bf16_f32 v184, v208, v209
    v_accvgpr_read_b32 v210, a30
    v_accvgpr_read_b32 v211, a42
    v_mul_f32 v210, s86, v210
    v_mul_f32 v211, s86, v211
    v_cvt_pk_bf16_f32 v185, v210, v211
    v_accvgpr_read_b32 v212, a54
    v_accvgpr_read_b32 v213, a66
    v_mul_f32 v212, s86, v212
    v_mul_f32 v213, s86, v213
    v_cvt_pk_bf16_f32 v186, v212, v213
    v_accvgpr_read_b32 v214, a78
    v_accvgpr_read_b32 v215, a90
    v_mul_f32 v214, s86, v214
    v_mul_f32 v215, s86, v215
    v_cvt_pk_bf16_f32 v187, v214, v215
    v_accvgpr_read_b32 v216, a7
    v_accvgpr_read_b32 v217, a19
    v_mul_f32 v216, s86, v216
    v_mul_f32 v217, s86, v217
    v_cvt_pk_bf16_f32 v188, v216, v217
    v_accvgpr_read_b32 v218, a31
    v_accvgpr_read_b32 v219, a43
    v_mul_f32 v218, s86, v218
    v_mul_f32 v219, s86, v219
    v_cvt_pk_bf16_f32 v189, v218, v219
    v_accvgpr_read_b32 v220, a55
    v_accvgpr_read_b32 v221, a67
    v_mul_f32 v220, s86, v220
    v_mul_f32 v221, s86, v221
    v_cvt_pk_bf16_f32 v190, v220, v221
    v_accvgpr_read_b32 v222, a79
    v_accvgpr_read_b32 v223, a91
    v_mul_f32 v222, s86, v222
    v_mul_f32 v223, s86, v223
    v_cvt_pk_bf16_f32 v191, v222, v223
    v_accvgpr_read_b32 v208, a8
    v_accvgpr_read_b32 v209, a20
    v_mul_f32 v208, s86, v208
    v_mul_f32 v209, s86, v209
    v_cvt_pk_bf16_f32 v192, v208, v209
    v_accvgpr_read_b32 v210, a32
    v_accvgpr_read_b32 v211, a44
    v_mul_f32 v210, s86, v210
    v_mul_f32 v211, s86, v211
    v_cvt_pk_bf16_f32 v193, v210, v211
    v_accvgpr_read_b32 v212, a56
    v_accvgpr_read_b32 v213, a68
    v_mul_f32 v212, s86, v212
    v_mul_f32 v213, s86, v213
    v_cvt_pk_bf16_f32 v194, v212, v213
    v_accvgpr_read_b32 v214, a80
    v_accvgpr_read_b32 v215, a92
    v_mul_f32 v214, s86, v214
    v_mul_f32 v215, s86, v215
    v_cvt_pk_bf16_f32 v195, v214, v215
    v_accvgpr_read_b32 v216, a9
    v_accvgpr_read_b32 v217, a21
    v_mul_f32 v216, s86, v216
    v_mul_f32 v217, s86, v217
    v_cvt_pk_bf16_f32 v196, v216, v217
    v_accvgpr_read_b32 v218, a33
    v_accvgpr_read_b32 v219, a45
    v_mul_f32 v218, s86, v218
    v_mul_f32 v219, s86, v219
    v_cvt_pk_bf16_f32 v197, v218, v219
    v_accvgpr_read_b32 v220, a57
    v_accvgpr_read_b32 v221, a69
    v_mul_f32 v220, s86, v220
    v_mul_f32 v221, s86, v221
    v_cvt_pk_bf16_f32 v198, v220, v221
    v_accvgpr_read_b32 v222, a81
    v_accvgpr_read_b32 v223, a93
    v_mul_f32 v222, s86, v222
    v_mul_f32 v223, s86, v223
    v_cvt_pk_bf16_f32 v199, v222, v223
    v_accvgpr_read_b32 v208, a10
    v_accvgpr_read_b32 v209, a22
    v_mul_f32 v208, s86, v208
    v_mul_f32 v209, s86, v209
    v_cvt_pk_bf16_f32 v200, v208, v209
    v_accvgpr_read_b32 v210, a34
    v_accvgpr_read_b32 v211, a46
    v_mul_f32 v210, s86, v210
    v_mul_f32 v211, s86, v211
    v_cvt_pk_bf16_f32 v201, v210, v211
    v_accvgpr_read_b32 v212, a58
    v_accvgpr_read_b32 v213, a70
    v_mul_f32 v212, s86, v212
    v_mul_f32 v213, s86, v213
    v_cvt_pk_bf16_f32 v202, v212, v213
    v_accvgpr_read_b32 v214, a82
    v_accvgpr_read_b32 v215, a94
    v_mul_f32 v214, s86, v214
    v_mul_f32 v215, s86, v215
    v_cvt_pk_bf16_f32 v203, v214, v215
    v_accvgpr_read_b32 v216, a11
    v_accvgpr_read_b32 v217, a23
    v_mul_f32 v216, s86, v216
    v_mul_f32 v217, s86, v217
    v_cvt_pk_bf16_f32 v204, v216, v217
    v_accvgpr_read_b32 v218, a35
    v_accvgpr_read_b32 v219, a47
    v_mul_f32 v218, s86, v218
    v_mul_f32 v219, s86, v219
    v_cvt_pk_bf16_f32 v205, v218, v219
    v_accvgpr_read_b32 v220, a59
    v_accvgpr_read_b32 v221, a71
    v_mul_f32 v220, s86, v220
    v_mul_f32 v221, s86, v221
    v_cvt_pk_bf16_f32 v206, v220, v221
    v_accvgpr_read_b32 v222, a83
    v_accvgpr_read_b32 v223, a95
    v_mul_f32 v222, s86, v222
    v_mul_f32 v223, s86, v223
    v_cvt_pk_bf16_f32 v207, v222, v223
    v_mov_b32 v44, 0x3f803f80
    v_mov_b32 v45, 0x3f803f80
    v_mov_b32 v46, 0x3f803f80
    v_mov_b32 v47, 0x3f803f80
    v_add_u32 v48, 0, v18
    v_add_u32 v49, 0, v19
    v_add_u32 v50, 0, v20
    v_add_u32 v51, 0, v21
    s_waitcnt vmcnt(24)
    s_waitcnt lgkmcnt(0)
    s_barrier
    ds_read_b128 a[128:131], v48
    ds_read_b128 a[132:135], v49
    ds_read_b128 a[136:139], v50
    ds_read_b128 a[140:143], v51
    ds_read_b128 a[144:147], v48 offset:4096
    ds_read_b128 a[148:151], v49 offset:4096
    ds_read_b128 a[152:155], v50 offset:4096
    ds_read_b128 a[156:159], v51 offset:4096
    ds_read_b128 a[160:163], v48 offset:8192
    ds_read_b128 a[164:167], v49 offset:8192
    ds_read_b128 a[168:171], v50 offset:8192
    ds_read_b128 a[172:175], v51 offset:8192
    ds_read_b128 a[176:179], v48 offset:12288
    ds_read_b128 a[180:183], v49 offset:12288
    ds_read_b128 a[184:187], v50 offset:12288
    ds_read_b128 a[188:191], v51 offset:12288
    s_waitcnt lgkmcnt(15)
    v_mfma_f32_16x16x32_bf16 v[64:67], a[128:131], v[160:163], 0
    v_mfma_f32_16x16x32_bf16 v[68:71], a[128:131], v[176:179], 0
    v_mfma_f32_16x16x32_bf16 v[72:75], a[128:131], v[192:195], 0
    s_waitcnt lgkmcnt(14)
    v_mfma_f32_16x16x32_bf16 v[64:67], a[132:135], v[164:167], v[64:67]
    v_mfma_f32_16x16x32_bf16 v[68:71], a[132:135], v[180:183], v[68:71]
    v_mfma_f32_16x16x32_bf16 v[72:75], a[132:135], v[196:199], v[72:75]
    s_waitcnt lgkmcnt(13)
    v_mfma_f32_16x16x32_bf16 v[64:67], a[136:139], v[168:171], v[64:67]
    v_mfma_f32_16x16x32_bf16 v[68:71], a[136:139], v[184:187], v[68:71]
    s_add_u32 m0, s84, 0x1c000
    s_add_u32 s79, s78, 0xc000
    buffer_load_dwordx4 v16, s[52:55], s79 offen nt lds
    v_mfma_f32_16x16x32_bf16 v[72:75], a[136:139], v[200:203], v[72:75]
    s_waitcnt lgkmcnt(12)
    v_mfma_f32_16x16x32_bf16 v[64:67], a[140:143], v[172:175], v[64:67]
    v_mfma_f32_16x16x32_bf16 v[68:71], a[140:143], v[188:191], v[68:71]
    v_mfma_f32_16x16x32_bf16 v[72:75], a[140:143], v[204:207], v[72:75]
    s_waitcnt lgkmcnt(11)
    v_mfma_f32_16x16x32_bf16 v[76:79], a[144:147], v[160:163], 0
    v_mfma_f32_16x16x32_bf16 v[80:83], a[144:147], v[176:179], 0
    v_mfma_f32_16x16x32_bf16 v[84:87], a[144:147], v[192:195], 0
    s_waitcnt lgkmcnt(10)
    v_mfma_f32_16x16x32_bf16 v[76:79], a[148:151], v[164:167], v[76:79]
    s_add_u32 m0, s84, 0x1c000
    s_add_u32 s79, s78, 0xc000
    buffer_load_dwordx4 v17, s[52:55], s79 offen offset:1024 nt lds
    v_mfma_f32_16x16x32_bf16 v[80:83], a[148:151], v[180:183], v[80:83]
    v_mfma_f32_16x16x32_bf16 v[84:87], a[148:151], v[196:199], v[84:87]
    s_waitcnt lgkmcnt(9)
    v_mfma_f32_16x16x32_bf16 v[76:79], a[152:155], v[168:171], v[76:79]
    v_mfma_f32_16x16x32_bf16 v[80:83], a[152:155], v[184:187], v[80:83]
    v_mfma_f32_16x16x32_bf16 v[84:87], a[152:155], v[200:203], v[84:87]
    s_waitcnt lgkmcnt(8)
    v_mfma_f32_16x16x32_bf16 v[76:79], a[156:159], v[172:175], v[76:79]
    v_mfma_f32_16x16x32_bf16 v[80:83], a[156:159], v[188:191], v[80:83]
    v_mfma_f32_16x16x32_bf16 v[84:87], a[156:159], v[204:207], v[84:87]
    s_add_u32 m0, s84, 0x1c000
    s_add_u32 s79, s78, 0xc000
    buffer_load_dwordx4 v16, s[52:55], s79 offen offset:2048 nt lds
    s_waitcnt lgkmcnt(7)
    v_mfma_f32_16x16x32_bf16 v[88:91], a[160:163], v[160:163], 0
    v_mfma_f32_16x16x32_bf16 v[92:95], a[160:163], v[176:179], 0
    v_mfma_f32_16x16x32_bf16 v[96:99], a[160:163], v[192:195], 0
    s_waitcnt lgkmcnt(6)
    v_mfma_f32_16x16x32_bf16 v[88:91], a[164:167], v[164:167], v[88:91]
    v_mfma_f32_16x16x32_bf16 v[92:95], a[164:167], v[180:183], v[92:95]
    v_mfma_f32_16x16x32_bf16 v[96:99], a[164:167], v[196:199], v[96:99]
    s_waitcnt lgkmcnt(5)
    v_mfma_f32_16x16x32_bf16 v[88:91], a[168:171], v[168:171], v[88:91]
    v_mfma_f32_16x16x32_bf16 v[92:95], a[168:171], v[184:187], v[92:95]
    s_add_u32 m0, s84, 0x1c000
    s_add_u32 s79, s78, 0xc000
    buffer_load_dwordx4 v17, s[52:55], s79 offen offset:3072 nt lds
    v_mfma_f32_16x16x32_bf16 v[96:99], a[168:171], v[200:203], v[96:99]
    s_waitcnt lgkmcnt(4)
    v_mfma_f32_16x16x32_bf16 v[88:91], a[172:175], v[172:175], v[88:91]
    v_mfma_f32_16x16x32_bf16 v[92:95], a[172:175], v[188:191], v[92:95]
    v_mfma_f32_16x16x32_bf16 v[96:99], a[172:175], v[204:207], v[96:99]
    s_waitcnt lgkmcnt(3)
    v_mfma_f32_16x16x32_bf16 v[100:103], a[176:179], v[160:163], 0
    v_mfma_f32_16x16x32_bf16 v[104:107], a[176:179], v[176:179], 0
    v_mfma_f32_16x16x32_bf16 v[108:111], a[176:179], v[192:195], 0
    s_waitcnt lgkmcnt(2)
    v_mfma_f32_16x16x32_bf16 v[100:103], a[180:183], v[164:167], v[100:103]
    s_add_u32 m0, s84, 0x20000
    s_add_u32 s79, s78, 0x10000
    buffer_load_dwordx4 v12, s[48:51], s79 offen nt lds
    v_mfma_f32_16x16x32_bf16 v[104:107], a[180:183], v[180:183], v[104:107]
    v_mfma_f32_16x16x32_bf16 v[108:111], a[180:183], v[196:199], v[108:111]
    s_waitcnt lgkmcnt(1)
    v_mfma_f32_16x16x32_bf16 v[100:103], a[184:187], v[168:171], v[100:103]
    v_mfma_f32_16x16x32_bf16 v[104:107], a[184:187], v[184:187], v[104:107]
    v_mfma_f32_16x16x32_bf16 v[108:111], a[184:187], v[200:203], v[108:111]
    s_waitcnt lgkmcnt(0)
    v_mfma_f32_16x16x32_bf16 v[100:103], a[188:191], v[172:175], v[100:103]
    v_mfma_f32_16x16x32_bf16 v[104:107], a[188:191], v[188:191], v[104:107]
    v_mfma_f32_16x16x32_bf16 v[108:111], a[188:191], v[204:207], v[108:111]
    s_add_u32 m0, s84, 0x20000
    s_add_u32 s79, s78, 0x10000
    buffer_load_dwordx4 v13, s[48:51], s79 offen offset:1024 nt lds
    v_and_b32 v254, 63, v0
    v_xor_b32 v252, 16, v254
    v_lshlrev_b32 v252, 2, v252
    v_xor_b32 v253, 32, v254
    v_lshlrev_b32 v253, 2, v253
    v_max3_f32 v248, v64, v65, v66
    v_max3_f32 v248, v248, v67, v76
    v_max3_f32 v248, v248, v77, v78
    v_max3_f32 v248, v248, v79, v88
    v_max3_f32 v248, v248, v89, v90
    v_max3_f32 v248, v248, v91, v100
    v_max3_f32 v248, v248, v101, v102
    v_max_f32 v248, v248, v103
    ds_bpermute_b32 v255, v252, v248
    s_waitcnt lgkmcnt(0)
    v_max_f32 v248, v248, v255
    ds_bpermute_b32 v255, v253, v248
    s_waitcnt lgkmcnt(0)
    v_max_f32 v248, v248, v255
    v_sub_f32 v64, v64, v248
    v_sub_f32 v65, v65, v248
    v_sub_f32 v66, v66, v248
    v_sub_f32 v67, v67, v248
    v_sub_f32 v76, v76, v248
    v_sub_f32 v77, v77, v248
    v_sub_f32 v78, v78, v248
    v_sub_f32 v79, v79, v248
    v_sub_f32 v88, v88, v248
    v_sub_f32 v89, v89, v248
    v_sub_f32 v90, v90, v248
    v_sub_f32 v91, v91, v248
    v_sub_f32 v100, v100, v248
    v_sub_f32 v101, v101, v248
    v_sub_f32 v102, v102, v248
    v_sub_f32 v103, v103, v248
    v_sub_f32 v32, 0, v248
    v_sub_f32 v33, 0, v248
    v_sub_f32 v34, 0, v248
    v_sub_f32 v35, 0, v248
    v_max3_f32 v249, v68, v69, v70
    v_max3_f32 v249, v249, v71, v80
    v_max3_f32 v249, v249, v81, v82
    v_max3_f32 v249, v249, v83, v92
    v_max3_f32 v249, v249, v93, v94
    v_max3_f32 v249, v249, v95, v104
    v_max3_f32 v249, v249, v105, v106
    v_max_f32 v249, v249, v107
    ds_bpermute_b32 v255, v252, v249
    s_waitcnt lgkmcnt(0)
    v_max_f32 v249, v249, v255
    ds_bpermute_b32 v255, v253, v249
    s_waitcnt lgkmcnt(0)
    v_max_f32 v249, v249, v255
    v_sub_f32 v68, v68, v249
    v_sub_f32 v69, v69, v249
    v_sub_f32 v70, v70, v249
    v_sub_f32 v71, v71, v249
    v_sub_f32 v80, v80, v249
    v_sub_f32 v81, v81, v249
    v_sub_f32 v82, v82, v249
    v_sub_f32 v83, v83, v249
    v_sub_f32 v92, v92, v249
    v_sub_f32 v93, v93, v249
    v_sub_f32 v94, v94, v249
    v_sub_f32 v95, v95, v249
    v_sub_f32 v104, v104, v249
    v_sub_f32 v105, v105, v249
    v_sub_f32 v106, v106, v249
    v_sub_f32 v107, v107, v249
    v_sub_f32 v36, 0, v249
    v_sub_f32 v37, 0, v249
    v_sub_f32 v38, 0, v249
    v_sub_f32 v39, 0, v249
    v_max3_f32 v250, v72, v73, v74
    v_max3_f32 v250, v250, v75, v84
    v_max3_f32 v250, v250, v85, v86
    v_max3_f32 v250, v250, v87, v96
    v_max3_f32 v250, v250, v97, v98
    v_max3_f32 v250, v250, v99, v108
    v_max3_f32 v250, v250, v109, v110
    v_max_f32 v250, v250, v111
    ds_bpermute_b32 v255, v252, v250
    s_waitcnt lgkmcnt(0)
    v_max_f32 v250, v250, v255
    ds_bpermute_b32 v255, v253, v250
    s_waitcnt lgkmcnt(0)
    v_max_f32 v250, v250, v255
    v_sub_f32 v72, v72, v250
    v_sub_f32 v73, v73, v250
    v_sub_f32 v74, v74, v250
    v_sub_f32 v75, v75, v250
    v_sub_f32 v84, v84, v250
    v_sub_f32 v85, v85, v250
    v_sub_f32 v86, v86, v250
    v_sub_f32 v87, v87, v250
    v_sub_f32 v96, v96, v250
    v_sub_f32 v97, v97, v250
    v_sub_f32 v98, v98, v250
    v_sub_f32 v99, v99, v250
    v_sub_f32 v108, v108, v250
    v_sub_f32 v109, v109, v250
    v_sub_f32 v110, v110, v250
    v_sub_f32 v111, v111, v250
    v_sub_f32 v40, 0, v250
    v_sub_f32 v41, 0, v250
    v_sub_f32 v42, 0, v250
    v_sub_f32 v43, 0, v250
    v_add_u32 v48, 0x8000, v18
    v_add_u32 v49, 0x8000, v19
    v_add_u32 v50, 0x8000, v20
    v_add_u32 v51, 0x8000, v21
    s_waitcnt vmcnt(22)
    v_add_u32 v52, 0x4000, v22
    v_add_u32 v53, 0x4000, v23
    v_add_u32 v54, 0x4000, v24
    v_add_u32 v55, 0x4000, v25
    v_add_u32 v56, 0x4000, v26
    v_add_u32 v57, 0x4000, v27
    v_add_u32 v58, 0x4000, v28
    v_add_u32 v59, 0x4000, v29
    s_waitcnt lgkmcnt(0)
    s_barrier
    ds_read_b128 a[128:131], v48
    ds_read_b128 a[132:135], v49
    ds_read_b128 a[136:139], v50
    ds_read_b128 a[140:143], v51
    ds_read_b128 a[144:147], v48 offset:4096
    ds_read_b128 a[148:151], v49 offset:4096
    s_waitcnt lgkmcnt(5)
    v_mfma_f32_16x16x32_bf16 v[112:115], a[128:131], v[160:163], v[32:35]
    ds_read_b128 a[152:155], v50 offset:4096
    ds_read_b128 a[156:159], v51 offset:4096
    ds_read_b128 a[160:163], v48 offset:8192
    v_mfma_f32_16x16x32_bf16 v[116:119], a[128:131], v[176:179], v[36:39]
    ds_read_b128 a[164:167], v49 offset:8192
    ds_read_b128 a[168:171], v50 offset:8192
    ds_read_b128 a[172:175], v51 offset:8192
    v_mfma_f32_16x16x32_bf16 v[120:123], a[128:131], v[192:195], v[40:43]
    ds_read_b128 a[176:179], v48 offset:12288
    ds_read_b128 a[180:183], v49 offset:12288
    s_waitcnt lgkmcnt(12)
    v_mfma_f32_16x16x32_bf16 v[112:115], a[132:135], v[164:167], v[112:115]
    ds_read_b128 a[184:187], v50 offset:12288
    ds_read_b128 a[188:191], v51 offset:12288
    v_exp_f32 v64, v64
    v_mfma_f32_16x16x32_bf16 v[116:119], a[132:135], v[180:183], v[116:119]
    ds_read_b64_tr_b16 a[192:193], v52
    v_exp_f32 v65, v65
    v_mfma_f32_16x16x32_bf16 v[120:123], a[132:135], v[196:199], v[120:123]
    v_exp_f32 v66, v66
    ds_read_b64_tr_b16 a[194:195], v52 offset:4096
    v_exp_f32 v67, v67
    s_waitcnt lgkmcnt(15)
    v_mfma_f32_16x16x32_bf16 v[112:115], a[136:139], v[168:171], v[112:115]
    v_cvt_pk_bf16_f32 v224, v64, v65
    ds_read_b64_tr_b16 a[200:201], v53
    v_cvt_pk_bf16_f32 v225, v66, v67
    v_mfma_f32_16x16x32_bf16 v[116:119], a[136:139], v[184:187], v[116:119]
    v_exp_f32 v68, v68
    ds_read_b64_tr_b16 a[202:203], v53 offset:4096
    v_mfma_f32_16x16x32_bf16 v[120:123], a[136:139], v[200:203], v[120:123]
    v_exp_f32 v69, v69
    v_exp_f32 v70, v70
    v_exp_f32 v71, v71
    s_waitcnt lgkmcnt(15)
    v_mfma_f32_16x16x32_bf16 v[112:115], a[140:143], v[172:175], v[112:115]
    ds_read_b64_tr_b16 a[208:209], v54
    v_cvt_pk_bf16_f32 v228, v68, v69
    v_mfma_f32_16x16x32_bf16 v[116:119], a[140:143], v[188:191], v[116:119]
    s_add_u32 m0, s84, 0x20000
    s_add_u32 s79, s78, 0x10000
    buffer_load_dwordx4 v14, s[48:51], s79 offen offset:2048 nt lds
    v_cvt_pk_bf16_f32 v229, v70, v71
    ds_read_b64_tr_b16 a[210:211], v54 offset:4096
    v_exp_f32 v72, v72
    v_mfma_f32_16x16x32_bf16 v[120:123], a[140:143], v[204:207], v[120:123]
    v_exp_f32 v73, v73
    ds_read_b64_tr_b16 a[216:217], v55
    v_mfma_f32_16x16x32_bf16 v[124:127], a[144:147], v[160:163], v[32:35]
    v_exp_f32 v74, v74
    v_exp_f32 v75, v75
    ds_read_b64_tr_b16 a[218:219], v55 offset:4096
    v_mfma_f32_16x16x32_bf16 v[128:131], a[144:147], v[176:179], v[36:39]
    v_cvt_pk_bf16_f32 v232, v72, v73
    v_cvt_pk_bf16_f32 v233, v74, v75
    v_exp_f32 v76, v76
    v_mfma_f32_16x16x32_bf16 v[132:135], a[144:147], v[192:195], v[40:43]
    ds_read_b64_tr_b16 a[224:225], v56
    v_exp_f32 v77, v77
    s_waitcnt lgkmcnt(15)
    v_mfma_f32_16x16x32_bf16 v[124:127], a[148:151], v[164:167], v[124:127]
    v_exp_f32 v78, v78
    ds_read_b64_tr_b16 a[226:227], v56 offset:4096
    v_exp_f32 v79, v79
    v_mfma_f32_16x16x32_bf16 v[128:131], a[148:151], v[180:183], v[128:131]
    v_cvt_pk_bf16_f32 v226, v76, v77
    ds_read_b64_tr_b16 a[232:233], v57
    v_mfma_f32_16x16x32_bf16 v[132:135], a[148:151], v[196:199], v[132:135]
    v_cvt_pk_bf16_f32 v227, v78, v79
    v_exp_f32 v80, v80
    ds_read_b64_tr_b16 a[234:235], v57 offset:4096
    v_mfma_f32_16x16x32_bf16 v[124:127], a[152:155], v[168:171], v[124:127]
    v_exp_f32 v81, v81
    v_exp_f32 v82, v82
    v_exp_f32 v83, v83
    v_mfma_f32_16x16x32_bf16 v[128:131], a[152:155], v[184:187], v[128:131]
    ds_read_b64_tr_b16 a[240:241], v58
    v_cvt_pk_bf16_f32 v230, v80, v81
    v_mfma_f32_16x16x32_bf16 v[132:135], a[152:155], v[200:203], v[132:135]
    v_cvt_pk_bf16_f32 v231, v82, v83
    ds_read_b64_tr_b16 a[242:243], v58 offset:4096
    v_exp_f32 v84, v84
    v_mfma_f32_16x16x32_bf16 v[124:127], a[156:159], v[172:175], v[124:127]
    s_add_u32 m0, s84, 0x20000
    s_add_u32 s79, s78, 0x10000
    buffer_load_dwordx4 v15, s[48:51], s79 offen offset:3072 nt lds
    v_exp_f32 v85, v85
    ds_read_b64_tr_b16 a[248:249], v59
    v_mfma_f32_16x16x32_bf16 v[128:131], a[156:159], v[188:191], v[128:131]
    v_exp_f32 v86, v86
    v_exp_f32 v87, v87
    ds_read_b64_tr_b16 a[250:251], v59 offset:4096
    v_mfma_f32_16x16x32_bf16 v[132:135], a[156:159], v[204:207], v[132:135]
    v_cvt_pk_bf16_f32 v234, v84, v85
    v_cvt_pk_bf16_f32 v235, v86, v87
    s_waitcnt lgkmcnt(14)
    v_mfma_f32_16x16x32_bf16 a[0:3], a[192:195], v[224:227], 0
    v_exp_f32 v88, v88
    v_exp_f32 v89, v89
    v_mfma_f32_16x16x32_bf16 a[4:7], a[192:195], v[228:231], 0
    v_exp_f32 v90, v90
    v_mfma_f32_16x16x32_bf16 a[8:11], a[192:195], v[232:235], 0
    v_exp_f32 v91, v91
    s_waitcnt lgkmcnt(12)
    v_mfma_f32_16x16x32_bf16 a[12:15], a[200:203], v[224:227], 0
    v_cvt_pk_bf16_f32 v236, v88, v89
    v_cvt_pk_bf16_f32 v237, v90, v91
    v_mfma_f32_16x16x32_bf16 a[16:19], a[200:203], v[228:231], 0
    v_exp_f32 v92, v92
    v_mfma_f32_16x16x32_bf16 a[20:23], a[200:203], v[232:235], 0
    v_exp_f32 v93, v93
    s_waitcnt lgkmcnt(10)
    v_mfma_f32_16x16x32_bf16 a[24:27], a[208:211], v[224:227], 0
    v_exp_f32 v94, v94
    v_exp_f32 v95, v95
    v_mfma_f32_16x16x32_bf16 a[28:31], a[208:211], v[228:231], 0
    v_cvt_pk_bf16_f32 v240, v92, v93
    v_mfma_f32_16x16x32_bf16 a[32:35], a[208:211], v[232:235], 0
    s_add_u32 m0, s84, 0x24000
    s_add_u32 s79, s78, 0x10000
    buffer_load_dwordx4 v16, s[52:55], s79 offen nt lds
    v_cvt_pk_bf16_f32 v241, v94, v95
    s_waitcnt lgkmcnt(8)
    v_mfma_f32_16x16x32_bf16 a[36:39], a[216:219], v[224:227], 0
    v_exp_f32 v96, v96
    v_exp_f32 v97, v97
    v_mfma_f32_16x16x32_bf16 a[40:43], a[216:219], v[228:231], 0
    v_exp_f32 v98, v98
    v_mfma_f32_16x16x32_bf16 a[44:47], a[216:219], v[232:235], 0
    v_exp_f32 v99, v99
    s_waitcnt lgkmcnt(6)
    v_mfma_f32_16x16x32_bf16 a[48:51], a[224:227], v[224:227], 0
    v_cvt_pk_bf16_f32 v244, v96, v97
    v_cvt_pk_bf16_f32 v245, v98, v99
    v_mfma_f32_16x16x32_bf16 a[52:55], a[224:227], v[228:231], 0
    v_exp_f32 v100, v100
    v_mfma_f32_16x16x32_bf16 a[56:59], a[224:227], v[232:235], 0
    v_exp_f32 v101, v101
    s_waitcnt lgkmcnt(4)
    v_mfma_f32_16x16x32_bf16 a[60:63], a[232:235], v[224:227], 0
    v_exp_f32 v102, v102
    v_exp_f32 v103, v103
    v_mfma_f32_16x16x32_bf16 a[64:67], a[232:235], v[228:231], 0
    v_cvt_pk_bf16_f32 v238, v100, v101
    v_mfma_f32_16x16x32_bf16 a[68:71], a[232:235], v[232:235], 0
    v_cvt_pk_bf16_f32 v239, v102, v103
    s_waitcnt lgkmcnt(2)
    v_mfma_f32_16x16x32_bf16 a[72:75], a[240:243], v[224:227], 0
    v_exp_f32 v104, v104
    v_exp_f32 v105, v105
    v_mfma_f32_16x16x32_bf16 a[76:79], a[240:243], v[228:231], 0
    s_add_u32 m0, s84, 0x24000
    s_add_u32 s79, s78, 0x10000
    buffer_load_dwordx4 v17, s[52:55], s79 offen offset:1024 nt lds
    v_exp_f32 v106, v106
    v_mfma_f32_16x16x32_bf16 a[80:83], a[240:243], v[232:235], 0
    v_exp_f32 v107, v107
    s_waitcnt lgkmcnt(0)
    v_mfma_f32_16x16x32_bf16 a[84:87], a[248:251], v[224:227], 0
    v_cvt_pk_bf16_f32 v242, v104, v105
    v_cvt_pk_bf16_f32 v243, v106, v107
    v_mfma_f32_16x16x32_bf16 a[88:91], a[248:251], v[228:231], 0
    v_exp_f32 v108, v108
    v_mfma_f32_16x16x32_bf16 a[92:95], a[248:251], v[232:235], 0
    v_exp_f32 v109, v109
    v_mfma_f32_16x16x32_bf16 a[96:99], v[44:47], v[224:227], 0
    v_exp_f32 v110, v110
    v_exp_f32 v111, v111
    v_mfma_f32_16x16x32_bf16 a[100:103], v[44:47], v[228:231], 0
    v_cvt_pk_bf16_f32 v246, v108, v109
    v_mfma_f32_16x16x32_bf16 a[104:107], v[44:47], v[232:235], 0
    v_cvt_pk_bf16_f32 v247, v110, v111
    v_mfma_f32_16x16x32_bf16 v[136:139], a[160:163], v[160:163], v[32:35]
    ds_read_b64_tr_b16 a[196:197], v52 offset:8192
    v_max3_f32 v60, v112, v113, v114
    v_mfma_f32_16x16x32_bf16 v[140:143], a[160:163], v[176:179], v[36:39]
    ds_read_b64_tr_b16 a[198:199], v52 offset:12288
    v_mfma_f32_16x16x32_bf16 v[144:147], a[160:163], v[192:195], v[40:43]
    v_max3_f32 v60, v60, v115, v116
    v_mfma_f32_16x16x32_bf16 v[136:139], a[164:167], v[164:167], v[136:139]
    s_add_u32 m0, s84, 0x24000
    s_add_u32 s79, s78, 0x10000
    buffer_load_dwordx4 v16, s[52:55], s79 offen offset:2048 nt lds
    ds_read_b64_tr_b16 a[204:205], v53 offset:8192
    v_mfma_f32_16x16x32_bf16 v[140:143], a[164:167], v[180:183], v[140:143]
    v_max3_f32 v60, v60, v117, v118
    v_mfma_f32_16x16x32_bf16 v[144:147], a[164:167], v[196:199], v[144:147]
    ds_read_b64_tr_b16 a[206:207], v53 offset:12288
    v_mfma_f32_16x16x32_bf16 v[136:139], a[168:171], v[168:171], v[136:139]
    ds_read_b64_tr_b16 a[212:213], v54 offset:8192
    v_mfma_f32_16x16x32_bf16 v[140:143], a[168:171], v[184:187], v[140:143]
    v_max3_f32 v60, v60, v119, v120
    v_mfma_f32_16x16x32_bf16 v[144:147], a[168:171], v[200:203], v[144:147]
    ds_read_b64_tr_b16 a[214:215], v54 offset:12288
    v_max3_f32 v60, v60, v121, v122
    v_mfma_f32_16x16x32_bf16 v[136:139], a[172:175], v[172:175], v[136:139]
    ds_read_b64_tr_b16 a[220:221], v55 offset:8192
    v_mfma_f32_16x16x32_bf16 v[140:143], a[172:175], v[188:191], v[140:143]
    ds_read_b64_tr_b16 a[222:223], v55 offset:12288
    v_mfma_f32_16x16x32_bf16 v[144:147], a[172:175], v[204:207], v[144:147]
    v_max3_f32 v60, v60, v123, v124
    v_mfma_f32_16x16x32_bf16 v[148:151], a[176:179], v[160:163], v[32:35]
    ds_read_b64_tr_b16 a[228:229], v56 offset:8192
    v_mfma_f32_16x16x32_bf16 v[152:155], a[176:179], v[176:179], v[36:39]
    v_max3_f32 v60, v60, v125, v126
    v_mfma_f32_16x16x32_bf16 v[156:159], a[176:179], v[192:195], v[40:43]
    s_add_u32 m0, s84, 0x24000
    s_add_u32 s79, s78, 0x10000
    buffer_load_dwordx4 v17, s[52:55], s79 offen offset:3072 nt lds
    ds_read_b64_tr_b16 a[230:231], v56 offset:12288
    v_mfma_f32_16x16x32_bf16 v[148:151], a[180:183], v[164:167], v[148:151]
    ds_read_b64_tr_b16 a[236:237], v57 offset:8192
    v_mfma_f32_16x16x32_bf16 v[152:155], a[180:183], v[180:183], v[152:155]
    v_max3_f32 v60, v60, v127, v128
    ds_read_b64_tr_b16 a[238:239], v57 offset:12288
    v_mfma_f32_16x16x32_bf16 v[156:159], a[180:183], v[196:199], v[156:159]
    v_max3_f32 v60, v60, v129, v130
    v_mfma_f32_16x16x32_bf16 v[148:151], a[184:187], v[168:171], v[148:151]
    ds_read_b64_tr_b16 a[244:245], v58 offset:8192
    v_mfma_f32_16x16x32_bf16 v[152:155], a[184:187], v[184:187], v[152:155]
    ds_read_b64_tr_b16 a[246:247], v58 offset:12288
    v_mfma_f32_16x16x32_bf16 v[156:159], a[184:187], v[200:203], v[156:159]
    v_max3_f32 v60, v60, v131, v132
    v_mfma_f32_16x16x32_bf16 v[148:151], a[188:191], v[172:175], v[148:151]
    ds_read_b64_tr_b16 a[252:253], v59 offset:8192
    v_mfma_f32_16x16x32_bf16 v[152:155], a[188:191], v[188:191], v[152:155]
    v_max3_f32 v60, v60, v133, v134
    v_mfma_f32_16x16x32_bf16 v[156:159], a[188:191], v[204:207], v[156:159]
    ds_read_b64_tr_b16 a[254:255], v59 offset:12288
    s_waitcnt lgkmcnt(14)
    v_mfma_f32_16x16x32_bf16 a[0:3], a[196:199], v[236:239], a[0:3]
    v_mfma_f32_16x16x32_bf16 a[4:7], a[196:199], v[240:243], a[4:7]
    v_mfma_f32_16x16x32_bf16 a[8:11], a[196:199], v[244:247], a[8:11]
    s_waitcnt lgkmcnt(12)
    v_mfma_f32_16x16x32_bf16 a[12:15], a[204:207], v[236:239], a[12:15]
    v_mfma_f32_16x16x32_bf16 a[16:19], a[204:207], v[240:243], a[16:19]
    v_mfma_f32_16x16x32_bf16 a[20:23], a[204:207], v[244:247], a[20:23]
    s_waitcnt lgkmcnt(10)
    v_mfma_f32_16x16x32_bf16 a[24:27], a[212:215], v[236:239], a[24:27]
    v_max3_f32 v60, v60, v135, v136
    v_mfma_f32_16x16x32_bf16 a[28:31], a[212:215], v[240:243], a[28:31]
    v_max3_f32 v60, v60, v137, v138
    v_mfma_f32_16x16x32_bf16 a[32:35], a[212:215], v[244:247], a[32:35]
    s_waitcnt lgkmcnt(8)
    v_mfma_f32_16x16x32_bf16 a[36:39], a[220:223], v[236:239], a[36:39]
    v_max3_f32 v60, v60, v139, v140
    v_mfma_f32_16x16x32_bf16 a[40:43], a[220:223], v[240:243], a[40:43]
    v_max3_f32 v60, v60, v141, v142
    v_mfma_f32_16x16x32_bf16 a[44:47], a[220:223], v[244:247], a[44:47]
    s_waitcnt lgkmcnt(6)
    v_mfma_f32_16x16x32_bf16 a[48:51], a[228:231], v[236:239], a[48:51]
    v_max3_f32 v60, v60, v143, v144
    v_mfma_f32_16x16x32_bf16 a[52:55], a[228:231], v[240:243], a[52:55]
    v_mfma_f32_16x16x32_bf16 a[56:59], a[228:231], v[244:247], a[56:59]
    v_max3_f32 v60, v60, v145, v146
    s_waitcnt lgkmcnt(4)
    v_mfma_f32_16x16x32_bf16 a[60:63], a[236:239], v[236:239], a[60:63]
    v_max3_f32 v60, v60, v147, v148
    v_mfma_f32_16x16x32_bf16 a[64:67], a[236:239], v[240:243], a[64:67]
    v_mfma_f32_16x16x32_bf16 a[68:71], a[236:239], v[244:247], a[68:71]
    v_max3_f32 v60, v60, v149, v150
    s_waitcnt lgkmcnt(2)
    v_mfma_f32_16x16x32_bf16 a[72:75], a[244:247], v[236:239], a[72:75]
    v_max3_f32 v60, v60, v151, v152
    v_mfma_f32_16x16x32_bf16 a[76:79], a[244:247], v[240:243], a[76:79]
    v_mfma_f32_16x16x32_bf16 a[80:83], a[244:247], v[244:247], a[80:83]
    v_max3_f32 v60, v60, v153, v154
    s_waitcnt lgkmcnt(0)
    v_mfma_f32_16x16x32_bf16 a[84:87], a[252:255], v[236:239], a[84:87]
    v_mfma_f32_16x16x32_bf16 a[88:91], a[252:255], v[240:243], a[88:91]
    v_max3_f32 v60, v60, v155, v156
    v_mfma_f32_16x16x32_bf16 a[92:95], a[252:255], v[244:247], a[92:95]
    v_max3_f32 v60, v60, v157, v158
    v_mfma_f32_16x16x32_bf16 a[96:99], v[44:47], v[236:239], a[96:99]
    v_mfma_f32_16x16x32_bf16 a[100:103], v[44:47], v[240:243], a[100:103]
    v_max_f32 v60, v60, v159
    v_mfma_f32_16x16x32_bf16 a[104:107], v[44:47], v[244:247], a[104:107]
    v_cmp_lt_f32 vcc, s87, v60
    s_nop 3
    s_cbranch_vccnz L_slow0
L_back0:
    v_add_u32 v48, 0x10000, v18
    v_add_u32 v49, 0x10000, v19
    v_add_u32 v50, 0x10000, v20
    v_add_u32 v51, 0x10000, v21
    s_waitcnt vmcnt(20)
    v_add_u32 v52, 0xc000, v22
    v_add_u32 v53, 0xc000, v23
    v_add_u32 v54, 0xc000, v24
    v_add_u32 v55, 0xc000, v25
    v_add_u32 v56, 0xc000, v26
    v_add_u32 v57, 0xc000, v27
    v_add_u32 v58, 0xc000, v28
    v_add_u32 v59, 0xc000, v29
    s_waitcnt lgkmcnt(0)
    s_barrier
    ds_read_b128 a[128:131], v48
    ds_read_b128 a[132:135], v49
    ds_read_b128 a[136:139], v50
    ds_read_b128 a[140:143], v51
    ds_read_b128 a[144:147], v48 offset:4096
    ds_read_b128 a[148:151], v49 offset:4096
    s_waitcnt lgkmcnt(5)
    v_mfma_f32_16x16x32_bf16 v[64:67], a[128:131], v[160:163], v[32:35]
    ds_read_b128 a[152:155], v50 offset:4096
    ds_read_b128 a[156:159], v51 offset:4096
    ds_read_b128 a[160:163], v48 offset:8192
    v_mfma_f32_16x16x32_bf16 v[68:71], a[128:131], v[176:179], v[36:39]
    ds_read_b128 a[164:167], v49 offset:8192
    ds_read_b128 a[168:171], v50 offset:8192
    ds_read_b128 a[172:175], v51 offset:8192
    v_mfma_f32_16x16x32_bf16 v[72:75], a[128:131], v[192:195], v[40:43]
    ds_read_b128 a[176:179], v48 offset:12288
    ds_read_b128 a[180:183], v49 offset:12288
    s_waitcnt lgkmcnt(12)
    v_mfma_f32_16x16x32_bf16 v[64:67], a[132:135], v[164:167], v[64:67]
    ds_read_b128 a[184:187], v50 offset:12288
    ds_read_b128 a[188:191], v51 offset:12288
    v_exp_f32 v112, v112
    v_mfma_f32_16x16x32_bf16 v[68:71], a[132:135], v[180:183], v[68:71]
    ds_read_b64_tr_b16 a[192:193], v52
    v_exp_f32 v113, v113
    v_mfma_f32_16x16x32_bf16 v[72:75], a[132:135], v[196:199], v[72:75]
    v_exp_f32 v114, v114
    ds_read_b64_tr_b16 a[194:195], v52 offset:4096
    v_exp_f32 v115, v115
    s_waitcnt lgkmcnt(15)
    v_mfma_f32_16x16x32_bf16 v[64:67], a[136:139], v[168:171], v[64:67]
    v_cvt_pk_bf16_f32 v224, v112, v113
    ds_read_b64_tr_b16 a[200:201], v53
    v_cvt_pk_bf16_f32 v225, v114, v115
    v_mfma_f32_16x16x32_bf16 v[68:71], a[136:139], v[184:187], v[68:71]
    v_exp_f32 v116, v116
    ds_read_b64_tr_b16 a[202:203], v53 offset:4096
    v_mfma_f32_16x16x32_bf16 v[72:75], a[136:139], v[200:203], v[72:75]
    v_exp_f32 v117, v117
    v_exp_f32 v118, v118
    v_exp_f32 v119, v119
    s_waitcnt lgkmcnt(15)
    v_mfma_f32_16x16x32_bf16 v[64:67], a[140:143], v[172:175], v[64:67]
    ds_read_b64_tr_b16 a[208:209], v54
    v_cvt_pk_bf16_f32 v228, v116, v117
    v_mfma_f32_16x16x32_bf16 v[68:71], a[140:143], v[188:191], v[68:71]
    s_add_u32 m0, s84, 0
    s_add_u32 s79, s78, 0x14000
    buffer_load_dwordx4 v12, s[48:51], s79 offen nt lds
    v_cvt_pk_bf16_f32 v229, v118, v119
    ds_read_b64_tr_b16 a[210:211], v54 offset:4096
    v_exp_f32 v120, v120
    v_mfma_f32_16x16x32_bf16 v[72:75], a[140:143], v[204:207], v[72:75]
    v_exp_f32 v121, v121
    ds_read_b64_tr_b16 a[216:217], v55
    v_mfma_f32_16x16x32_bf16 v[76:79], a[144:147], v[160:163], v[32:35]
    v_exp_f32 v122, v122
    v_exp_f32 v123, v123
    ds_read_b64_tr_b16 a[218:219], v55 offset:4096
    v_mfma_f32_16x16x32_bf16 v[80:83], a[144:147], v[176:179], v[36:39]
    v_cvt_pk_bf16_f32 v232, v120, v121
    v_cvt_pk_bf16_f32 v233, v122, v123
    v_exp_f32 v124, v124
    v_mfma_f32_16x16x32_bf16 v[84:87], a[144:147], v[192:195], v[40:43]
    ds_read_b64_tr_b16 a[224:225], v56
    v_exp_f32 v125, v125
    s_waitcnt lgkmcnt(15)
    v_mfma_f32_16x16x32_bf16 v[76:79], a[148:151], v[164:167], v[76:79]
    v_exp_f32 v126, v126
    ds_read_b64_tr_b16 a[226:227], v56 offset:4096
    v_exp_f32 v127, v127
    v_mfma_f32_16x16x32_bf16 v[80:83], a[148:151], v[180:183], v[80:83]
    v_cvt_pk_bf16_f32 v226, v124, v125
    ds_read_b64_tr_b16 a[232:233], v57
    v_mfma_f32_16x16x32_bf16 v[84:87], a[148:151], v[196:199], v[84:87]
    v_cvt_pk_bf16_f32 v227, v126, v127
    v_exp_f32 v128, v128
    ds_read_b64_tr_b16 a[234:235], v57 offset:4096
    v_mfma_f32_16x16x32_bf16 v[76:79], a[152:155], v[168:171], v[76:79]
    v_exp_f32 v129, v129
    v_exp_f32 v130, v130
    v_exp_f32 v131, v131
    v_mfma_f32_16x16x32_bf16 v[80:83], a[152:155], v[184:187], v[80:83]
    ds_read_b64_tr_b16 a[240:241], v58
    v_cvt_pk_bf16_f32 v230, v128, v129
    v_mfma_f32_16x16x32_bf16 v[84:87], a[152:155], v[200:203], v[84:87]
    v_cvt_pk_bf16_f32 v231, v130, v131
    ds_read_b64_tr_b16 a[242:243], v58 offset:4096
    v_exp_f32 v132, v132
    v_mfma_f32_16x16x32_bf16 v[76:79], a[156:159], v[172:175], v[76:79]
    s_add_u32 m0, s84, 0
    s_add_u32 s79, s78, 0x14000
    buffer_load_dwordx4 v13, s[48:51], s79 offen offset:1024 nt lds
    v_exp_f32 v133, v133
    ds_read_b64_tr_b16 a[248:249], v59
    v_mfma_f32_16x16x32_bf16 v[80:83], a[156:159], v[188:191], v[80:83]
    v_exp_f32 v134, v134
    v_exp_f32 v135, v135
    ds_read_b64_tr_b16 a[250:251], v59 offset:4096
    v_mfma_f32_16x16x32_bf16 v[84:87], a[156:159], v[204:207], v[84:87]
    v_cvt_pk_bf16_f32 v234, v132, v133
    v_cvt_pk_bf16_f32 v235, v134, v135
    s_waitcnt lgkmcnt(14)
    v_mfma_f32_16x16x32_bf16 a[0:3], a[192:195], v[224:227], a[0:3]
    v_exp_f32 v136, v136
    v_exp_f32 v137, v137
    v_mfma_f32_16x16x32_bf16 a[4:7], a[192:195], v[228:231], a[4:7]
    v_exp_f32 v138, v138
    v_mfma_f32_16x16x32_bf16 a[8:11], a[192:195], v[232:235], a[8:11]
    v_exp_f32 v139, v139
    s_waitcnt lgkmcnt(12)
    v_mfma_f32_16x16x32_bf16 a[12:15], a[200:203], v[224:227], a[12:15]
    v_cvt_pk_bf16_f32 v236, v136, v137
    v_cvt_pk_bf16_f32 v237, v138, v139
    v_mfma_f32_16x16x32_bf16 a[16:19], a[200:203], v[228:231], a[16:19]
    v_exp_f32 v140, v140
    v_mfma_f32_16x16x32_bf16 a[20:23], a[200:203], v[232:235], a[20:23]
    v_exp_f32 v141, v141
    s_waitcnt lgkmcnt(10)
    v_mfma_f32_16x16x32_bf16 a[24:27], a[208:211], v[224:227], a[24:27]
    v_exp_f32 v142, v142
    v_exp_f32 v143, v143
    v_mfma_f32_16x16x32_bf16 a[28:31], a[208:211], v[228:231], a[28:31]
    v_cvt_pk_bf16_f32 v240, v140, v141
    v_mfma_f32_16x16x32_bf16 a[32:35], a[208:211], v[232:235], a[32:35]
    s_add_u32 m0, s84, 0
    s_add_u32 s79, s78, 0x14000
    buffer_load_dwordx4 v14, s[48:51], s79 offen offset:2048 nt lds
    v_cvt_pk_bf16_f32 v241, v142, v143
    s_waitcnt lgkmcnt(8)
    v_mfma_f32_16x16x32_bf16 a[36:39], a[216:219], v[224:227], a[36:39]
    v_exp_f32 v144, v144
    v_exp_f32 v145, v145
    v_mfma_f32_16x16x32_bf16 a[40:43], a[216:219], v[228:231], a[40:43]
    v_exp_f32 v146, v146
    v_mfma_f32_16x16x32_bf16 a[44:47], a[216:219], v[232:235], a[44:47]
    v_exp_f32 v147, v147
    s_waitcnt lgkmcnt(6)
    v_mfma_f32_16x16x32_bf16 a[48:51], a[224:227], v[224:227], a[48:51]
    v_cvt_pk_bf16_f32 v244, v144, v145
    v_cvt_pk_bf16_f32 v245, v146, v147
    v_mfma_f32_16x16x32_bf16 a[52:55], a[224:227], v[228:231], a[52:55]
    v_exp_f32 v148, v148
    v_mfma_f32_16x16x32_bf16 a[56:59], a[224:227], v[232:235], a[56:59]
    v_exp_f32 v149, v149
    s_waitcnt lgkmcnt(4)
    v_mfma_f32_16x16x32_bf16 a[60:63], a[232:235], v[224:227], a[60:63]
    v_exp_f32 v150, v150
    v_exp_f32 v151, v151
    v_mfma_f32_16x16x32_bf16 a[64:67], a[232:235], v[228:231], a[64:67]
    v_cvt_pk_bf16_f32 v238, v148, v149
    v_mfma_f32_16x16x32_bf16 a[68:71], a[232:235], v[232:235], a[68:71]
    v_cvt_pk_bf16_f32 v239, v150, v151
    s_waitcnt lgkmcnt(2)
    v_mfma_f32_16x16x32_bf16 a[72:75], a[240:243], v[224:227], a[72:75]
    v_exp_f32 v152, v152
    v_exp_f32 v153, v153
    v_mfma_f32_16x16x32_bf16 a[76:79], a[240:243], v[228:231], a[76:79]
    s_add_u32 m0, s84, 0
    s_add_u32 s79, s78, 0x14000
    buffer_load_dwordx4 v15, s[48:51], s79 offen offset:3072 nt lds
    v_exp_f32 v154, v154
    v_mfma_f32_16x16x32_bf16 a[80:83], a[240:243], v[232:235], a[80:83]
    v_exp_f32 v155, v155
    s_waitcnt lgkmcnt(0)
    v_mfma_f32_16x16x32_bf16 a[84:87], a[248:251], v[224:227], a[84:87]
    v_cvt_pk_bf16_f32 v242, v152, v153
    v_cvt_pk_bf16_f32 v243, v154, v155
    v_mfma_f32_16x16x32_bf16 a[88:91], a[248:251], v[228:231], a[88:91]
    v_exp_f32 v156, v156
    v_mfma_f32_16x16x32_bf16 a[92:95], a[248:251], v[232:235], a[92:95]
    v_exp_f32 v157, v157
    v_mfma_f32_16x16x32_bf16 a[96:99], v[44:47], v[224:227], a[96:99]
    v_exp_f32 v158, v158
    v_exp_f32 v159, v159
    v_mfma_f32_16x16x32_bf16 a[100:103], v[44:47], v[228:231], a[100:103]
    v_cvt_pk_bf16_f32 v246, v156, v157
    v_mfma_f32_16x16x32_bf16 a[104:107], v[44:47], v[232:235], a[104:107]
    v_cvt_pk_bf16_f32 v247, v158, v159
    v_mfma_f32_16x16x32_bf16 v[88:91], a[160:163], v[160:163], v[32:35]
    ds_read_b64_tr_b16 a[196:197], v52 offset:8192
    v_max3_f32 v60, v64, v65, v66
    v_mfma_f32_16x16x32_bf16 v[92:95], a[160:163], v[176:179], v[36:39]
    ds_read_b64_tr_b16 a[198:199], v52 offset:12288
    v_mfma_f32_16x16x32_bf16 v[96:99], a[160:163], v[192:195], v[40:43]
    v_max3_f32 v60, v60, v67, v68
    v_mfma_f32_16x16x32_bf16 v[88:91], a[164:167], v[164:167], v[88:91]
    s_add_u32 m0, s84, 0x4000
    s_add_u32 s79, s78, 0x14000
    buffer_load_dwordx4 v16, s[52:55], s79 offen nt lds
    ds_read_b64_tr_b16 a[204:205], v53 offset:8192
    v_mfma_f32_16x16x32_bf16 v[92:95], a[164:167], v[180:183], v[92:95]
    v_max3_f32 v60, v60, v69, v70
    v_mfma_f32_16x16x32_bf16 v[96:99], a[164:167], v[196:199], v[96:99]
    ds_read_b64_tr_b16 a[206:207], v53 offset:12288
    v_mfma_f32_16x16x32_bf16 v[88:91], a[168:171], v[168:171], v[88:91]
    ds_read_b64_tr_b16 a[212:213], v54 offset:8192
    v_mfma_f32_16x16x32_bf16 v[92:95], a[168:171], v[184:187], v[92:95]
    v_max3_f32 v60, v60, v71, v72
    v_mfma_f32_16x16x32_bf16 v[96:99], a[168:171], v[200:203], v[96:99]
    ds_read_b64_tr_b16 a[214:215], v54 offset:12288
    v_max3_f32 v60, v60, v73, v74
    v_mfma_f32_16x16x32_bf16 v[88:91], a[172:175], v[172:175], v[88:91]
    ds_read_b64_tr_b16 a[220:221], v55 offset:8192
    v_mfma_f32_16x16x32_bf16 v[92:95], a[172:175], v[188:191], v[92:95]
    ds_read_b64_tr_b16 a[222:223], v55 offset:12288
    v_mfma_f32_16x16x32_bf16 v[96:99], a[172:175], v[204:207], v[96:99]
    v_max3_f32 v60, v60, v75, v76
    v_mfma_f32_16x16x32_bf16 v[100:103], a[176:179], v[160:163], v[32:35]
    ds_read_b64_tr_b16 a[228:229], v56 offset:8192
    v_mfma_f32_16x16x32_bf16 v[104:107], a[176:179], v[176:179], v[36:39]
    v_max3_f32 v60, v60, v77, v78
    v_mfma_f32_16x16x32_bf16 v[108:111], a[176:179], v[192:195], v[40:43]
    s_add_u32 m0, s84, 0x4000
    s_add_u32 s79, s78, 0x14000
    buffer_load_dwordx4 v17, s[52:55], s79 offen offset:1024 nt lds
    ds_read_b64_tr_b16 a[230:231], v56 offset:12288
    v_mfma_f32_16x16x32_bf16 v[100:103], a[180:183], v[164:167], v[100:103]
    ds_read_b64_tr_b16 a[236:237], v57 offset:8192
    v_mfma_f32_16x16x32_bf16 v[104:107], a[180:183], v[180:183], v[104:107]
    v_max3_f32 v60, v60, v79, v80
    ds_read_b64_tr_b16 a[238:239], v57 offset:12288
    v_mfma_f32_16x16x32_bf16 v[108:111], a[180:183], v[196:199], v[108:111]
    v_max3_f32 v60, v60, v81, v82
    v_mfma_f32_16x16x32_bf16 v[100:103], a[184:187], v[168:171], v[100:103]
    ds_read_b64_tr_b16 a[244:245], v58 offset:8192
    v_mfma_f32_16x16x32_bf16 v[104:107], a[184:187], v[184:187], v[104:107]
    ds_read_b64_tr_b16 a[246:247], v58 offset:12288
    v_mfma_f32_16x16x32_bf16 v[108:111], a[184:187], v[200:203], v[108:111]
    v_max3_f32 v60, v60, v83, v84
    v_mfma_f32_16x16x32_bf16 v[100:103], a[188:191], v[172:175], v[100:103]
    ds_read_b64_tr_b16 a[252:253], v59 offset:8192
    v_mfma_f32_16x16x32_bf16 v[104:107], a[188:191], v[188:191], v[104:107]
    v_max3_f32 v60, v60, v85, v86
    v_mfma_f32_16x16x32_bf16 v[108:111], a[188:191], v[204:207], v[108:111]
    ds_read_b64_tr_b16 a[254:255], v59 offset:12288
    s_waitcnt lgkmcnt(14)
    v_mfma_f32_16x16x32_bf16 a[0:3], a[196:199], v[236:239], a[0:3]
    v_mfma_f32_16x16x32_bf16 a[4:7], a[196:199], v[240:243], a[4:7]
    s_add_u32 m0, s84, 0x4000
    s_add_u32 s79, s78, 0x14000
    buffer_load_dwordx4 v16, s[52:55], s79 offen offset:2048 nt lds
    v_mfma_f32_16x16x32_bf16 a[8:11], a[196:199], v[244:247], a[8:11]
    s_waitcnt lgkmcnt(12)
    v_mfma_f32_16x16x32_bf16 a[12:15], a[204:207], v[236:239], a[12:15]
    v_mfma_f32_16x16x32_bf16 a[16:19], a[204:207], v[240:243], a[16:19]
    v_mfma_f32_16x16x32_bf16 a[20:23], a[204:207], v[244:247], a[20:23]
    s_waitcnt lgkmcnt(10)
    v_mfma_f32_16x16x32_bf16 a[24:27], a[212:215], v[236:239], a[24:27]
    v_max3_f32 v60, v60, v87, v88
    v_mfma_f32_16x16x32_bf16 a[28:31], a[212:215], v[240:243], a[28:31]
    v_max3_f32 v60, v60, v89, v90
    v_mfma_f32_16x16x32_bf16 a[32:35], a[212:215], v[244:247], a[32:35]
    s_waitcnt lgkmcnt(8)
    v_mfma_f32_16x16x32_bf16 a[36:39], a[220:223], v[236:239], a[36:39]
    v_max3_f32 v60, v60, v91, v92
    v_mfma_f32_16x16x32_bf16 a[40:43], a[220:223], v[240:243], a[40:43]
    v_max3_f32 v60, v60, v93, v94
    v_mfma_f32_16x16x32_bf16 a[44:47], a[220:223], v[244:247], a[44:47]
    s_waitcnt lgkmcnt(6)
    v_mfma_f32_16x16x32_bf16 a[48:51], a[228:231], v[236:239], a[48:51]
    s_add_u32 m0, s84, 0x4000
    s_add_u32 s79, s78, 0x14000
    buffer_load_dwordx4 v17, s[52:55], s79 offen offset:3072 nt lds
    v_max3_f32 v60, v60, v95, v96
    v_mfma_f32_16x16x32_bf16 a[52:55], a[228:231], v[240:243], a[52:55]
    v_mfma_f32_16x16x32_bf16 a[56:59], a[228:231], v[244:247], a[56:59]
    v_max3_f32 v60, v60, v97, v98
    s_waitcnt lgkmcnt(4)
    v_mfma_f32_16x16x32_bf16 a[60:63], a[236:239], v[236:239], a[60:63]
    v_max3_f32 v60, v60, v99, v100
    v_mfma_f32_16x16x32_bf16 a[64:67], a[236:239], v[240:243], a[64:67]
    v_mfma_f32_16x16x32_bf16 a[68:71], a[236:239], v[244:247], a[68:71]
    v_max3_f32 v60, v60, v101, v102
    s_waitcnt lgkmcnt(2)
    v_mfma_f32_16x16x32_bf16 a[72:75], a[244:247], v[236:239], a[72:75]
    v_max3_f32 v60, v60, v103, v104
    v_mfma_f32_16x16x32_bf16 a[76:79], a[244:247], v[240:243], a[76:79]
    v_mfma_f32_16x16x32_bf16 a[80:83], a[244:247], v[244:247], a[80:83]
    v_max3_f32 v60, v60, v105, v106
    s_waitcnt lgkmcnt(0)
    v_mfma_f32_16x16x32_bf16 a[84:87], a[252:255], v[236:239], a[84:87]
    v_mfma_f32_16x16x32_bf16 a[88:91], a[252:255], v[240:243], a[88:91]
    v_max3_f32 v60, v60, v107, v108
    v_mfma_f32_16x16x32_bf16 a[92:95], a[252:255], v[244:247], a[92:95]
    v_max3_f32 v60, v60, v109, v110
    v_mfma_f32_16x16x32_bf16 a[96:99], v[44:47], v[236:239], a[96:99]
    v_mfma_f32_16x16x32_bf16 a[100:103], v[44:47], v[240:243], a[100:103]
    v_max_f32 v60, v60, v111
    v_mfma_f32_16x16x32_bf16 a[104:107], v[44:47], v[244:247], a[104:107]
    v_cmp_lt_f32 vcc, s87, v60
    s_nop 3
    s_cbranch_vccnz L_slow1
L_back1:
    v_add_u32 v48, 0x18000, v18
    v_add_u32 v49, 0x18000, v19
    v_add_u32 v50, 0x18000, v20
    v_add_u32 v51, 0x18000, v21
    s_waitcnt vmcnt(20)
    v_add_u32 v52, 0x14000, v22
    v_add_u32 v53, 0x14000, v23
    v_add_u32 v54, 0x14000, v24
    v_add_u32 v55, 0x14000, v25
    v_add_u32 v56, 0x14000, v26
    v_add_u32 v57, 0x14000, v27
    v_add_u32 v58, 0x14000, v28
    v_add_u32 v59, 0x14000, v29
    s_waitcnt lgkmcnt(0)
    s_barrier
    ds_read_b128 a[128:131], v48
    ds_read_b128 a[132:135], v49
    ds_read_b128 a[136:139], v50
    ds_read_b128 a[140:143], v51
    ds_read_b128 a[144:147], v48 offset:4096
    ds_read_b128 a[148:151], v49 offset:4096
    s_waitcnt lgkmcnt(5)
    v_mfma_f32_16x16x32_bf16 v[112:115], a[128:131], v[160:163], v[32:35]
    ds_read_b128 a[152:155], v50 offset:4096
    ds_read_b128 a[156:159], v51 offset:4096
    ds_read_b128 a[160:163], v48 offset:8192
    v_mfma_f32_16x16x32_bf16 v[116:119], a[128:131], v[176:179], v[36:39]
    ds_read_b128 a[164:167], v49 offset:8192
    ds_read_b128 a[168:171], v50 offset:8192
    ds_read_b128 a[172:175], v51 offset:8192
    v_mfma_f32_16x16x32_bf16 v[120:123], a[128:131], v[192:195], v[40:43]
    ds_read_b128 a[176:179], v48 offset:12288
    ds_read_b128 a[180:183], v49 offset:12288
    s_waitcnt lgkmcnt(12)
    v_mfma_f32_16x16x32_bf16 v[112:115], a[132:135], v[164:167], v[112:115]
    ds_read_b128 a[184:187], v50 offset:12288
    ds_read_b128 a[188:191], v51 offset:12288
    v_exp_f32 v64, v64
    v_mfma_f32_16x16x32_bf16 v[116:119], a[132:135], v[180:183], v[116:119]
    ds_read_b64_tr_b16 a[192:193], v52
    v_exp_f32 v65, v65
    v_mfma_f32_16x16x32_bf16 v[120:123], a[132:135], v[196:199], v[120:123]
    v_exp_f32 v66, v66
    ds_read_b64_tr_b16 a[194:195], v52 offset:4096
    v_exp_f32 v67, v67
    s_waitcnt lgkmcnt(15)
    v_mfma_f32_16x16x32_bf16 v[112:115], a[136:139], v[168:171], v[112:115]
    v_cvt_pk_bf16_f32 v224, v64, v65
    ds_read_b64_tr_b16 a[200:201], v53
    v_cvt_pk_bf16_f32 v225, v66, v67
    v_mfma_f32_16x16x32_bf16 v[116:119], a[136:139], v[184:187], v[116:119]
    v_exp_f32 v68, v68
    ds_read_b64_tr_b16 a[202:203], v53 offset:4096
    v_mfma_f32_16x16x32_bf16 v[120:123], a[136:139], v[200:203], v[120:123]
    v_exp_f32 v69, v69
    v_exp_f32 v70, v70
    v_exp_f32 v71, v71
    s_waitcnt lgkmcnt(15)
    v_mfma_f32_16x16x32_bf16 v[112:115], a[140:143], v[172:175], v[112:115]
    ds_read_b64_tr_b16 a[208:209], v54
    v_cvt_pk_bf16_f32 v228, v68, v69
    v_mfma_f32_16x16x32_bf16 v[116:119], a[140:143], v[188:191], v[116:119]
    s_add_u32 m0, s84, 0x8000
    s_add_u32 s79, s78, 0x18000
    buffer_load_dwordx4 v12, s[48:51], s79 offen nt lds
    v_cvt_pk_bf16_f32 v229, v70, v71
    ds_read_b64_tr_b16 a[210:211], v54 offset:4096
    v_exp_f32 v72, v72
    v_mfma_f32_16x16x32_bf16 v[120:123], a[140:143], v[204:207], v[120:123]
    v_exp_f32 v73, v73
    ds_read_b64_tr_b16 a[216:217], v55
    v_mfma_f32_16x16x32_bf16 v[124:127], a[144:147], v[160:163], v[32:35]
    v_exp_f32 v74, v74
    v_exp_f32 v75, v75
    ds_read_b64_tr_b16 a[218:219], v55 offset:4096
    v_mfma_f32_16x16x32_bf16 v[128:131], a[144:147], v[176:179], v[36:39]
    v_cvt_pk_bf16_f32 v232, v72, v73
    v_cvt_pk_bf16_f32 v233, v74, v75
    v_exp_f32 v76, v76
    v_mfma_f32_16x16x32_bf16 v[132:135], a[144:147], v[192:195], v[40:43]
    ds_read_b64_tr_b16 a[224:225], v56
    v_exp_f32 v77, v77
    s_waitcnt lgkmcnt(15)
    v_mfma_f32_16x16x32_bf16 v[124:127], a[148:151], v[164:167], v[124:127]
    v_exp_f32 v78, v78
    ds_read_b64_tr_b16 a[226:227], v56 offset:4096
    v_exp_f32 v79, v79
    v_mfma_f32_16x16x32_bf16 v[128:131], a[148:151], v[180:183], v[128:131]
    v_cvt_pk_bf16_f32 v226, v76, v77
    ds_read_b64_tr_b16 a[232:233], v57
    v_mfma_f32_16x16x32_bf16 v[132:135], a[148:151], v[196:199], v[132:135]
    v_cvt_pk_bf16_f32 v227, v78, v79
    v_exp_f32 v80, v80
    ds_read_b64_tr_b16 a[234:235], v57 offset:4096
    v_mfma_f32_16x16x32_bf16 v[124:127], a[152:155], v[168:171], v[124:127]
    v_exp_f32 v81, v81
    v_exp_f32 v82, v82
    v_exp_f32 v83, v83
    v_mfma_f32_16x16x32_bf16 v[128:131], a[152:155], v[184:187], v[128:131]
    ds_read_b64_tr_b16 a[240:241], v58
    v_cvt_pk_bf16_f32 v230, v80, v81
    v_mfma_f32_16x16x32_bf16 v[132:135], a[152:155], v[200:203], v[132:135]
    v_cvt_pk_bf16_f32 v231, v82, v83
    ds_read_b64_tr_b16 a[242:243], v58 offset:4096
    v_exp_f32 v84, v84
    v_mfma_f32_16x16x32_bf16 v[124:127], a[156:159], v[172:175], v[124:127]
    s_add_u32 m0, s84, 0x8000
    s_add_u32 s79, s78, 0x18000
    buffer_load_dwordx4 v13, s[48:51], s79 offen offset:1024 nt lds
    v_exp_f32 v85, v85
    ds_read_b64_tr_b16 a[248:249], v59
    v_mfma_f32_16x16x32_bf16 v[128:131], a[156:159], v[188:191], v[128:131]
    v_exp_f32 v86, v86
    v_exp_f32 v87, v87
    ds_read_b64_tr_b16 a[250:251], v59 offset:4096
    v_mfma_f32_16x16x32_bf16 v[132:135], a[156:159], v[204:207], v[132:135]
    v_cvt_pk_bf16_f32 v234, v84, v85
    v_cvt_pk_bf16_f32 v235, v86, v87
    s_waitcnt lgkmcnt(14)
    v_mfma_f32_16x16x32_bf16 a[0:3], a[192:195], v[224:227], a[0:3]
    v_exp_f32 v88, v88
    v_exp_f32 v89, v89
    v_mfma_f32_16x16x32_bf16 a[4:7], a[192:195], v[228:231], a[4:7]
    v_exp_f32 v90, v90
    v_mfma_f32_16x16x32_bf16 a[8:11], a[192:195], v[232:235], a[8:11]
    v_exp_f32 v91, v91
    s_waitcnt lgkmcnt(12)
    v_mfma_f32_16x16x32_bf16 a[12:15], a[200:203], v[224:227], a[12:15]
    v_cvt_pk_bf16_f32 v236, v88, v89
    v_cvt_pk_bf16_f32 v237, v90, v91
    v_mfma_f32_16x16x32_bf16 a[16:19], a[200:203], v[228:231], a[16:19]
    v_exp_f32 v92, v92
    v_mfma_f32_16x16x32_bf16 a[20:23], a[200:203], v[232:235], a[20:23]
    v_exp_f32 v93, v93
    s_waitcnt lgkmcnt(10)
    v_mfma_f32_16x16x32_bf16 a[24:27], a[208:211], v[224:227], a[24:27]
    v_exp_f32 v94, v94
    v_exp_f32 v95, v95
    v_mfma_f32_16x16x32_bf16 a[28:31], a[208:211], v[228:231], a[28:31]
    v_cvt_pk_bf16_f32 v240, v92, v93
    v_mfma_f32_16x16x32_bf16 a[32:35], a[208:211], v[232:235], a[32:35]
    s_add_u32 m0, s84, 0x8000
    s_add_u32 s79, s78, 0x18000
    buffer_load_dwordx4 v14, s[48:51], s79 offen offset:2048 nt lds
    v_cvt_pk_bf16_f32 v241, v94, v95
    s_waitcnt lgkmcnt(8)
    v_mfma_f32_16x16x32_bf16 a[36:39], a[216:219], v[224:227], a[36:39]
    v_exp_f32 v96, v96
    v_exp_f32 v97, v97
    v_mfma_f32_16x16x32_bf16 a[40:43], a[216:219], v[228:231], a[40:43]
    v_exp_f32 v98, v98
    v_mfma_f32_16x16x32_bf16 a[44:47], a[216:219], v[232:235], a[44:47]
    v_exp_f32 v99, v99
    s_waitcnt lgkmcnt(6)
    v_mfma_f32_16x16x32_bf16 a[48:51], a[224:227], v[224:227], a[48:51]
    v_cvt_pk_bf16_f32 v244, v96, v97
    v_cvt_pk_bf16_f32 v245, v98, v99
    v_mfma_f32_16x16x32_bf16 a[52:55], a[224:227], v[228:231], a[52:55]
    v_exp_f32 v100, v100
    v_mfma_f32_16x16x32_bf16 a[56:59], a[224:227], v[232:235], a[56:59]
    v_exp_f32 v101, v101
    s_waitcnt lgkmcnt(4)
    v_mfma_f32_16x16x32_bf16 a[60:63], a[232:235], v[224:227], a[60:63]
    v_exp_f32 v102, v102
    v_exp_f32 v103, v103
    v_mfma_f32_16x16x32_bf16 a[64:67], a[232:235], v[228:231], a[64:67]
    v_cvt_pk_bf16_f32 v238, v100, v101
    v_mfma_f32_16x16x32_bf16 a[68:71], a[232:235], v[232:235], a[68:71]
    v_cvt_pk_bf16_f32 v239, v102, v103
    s_waitcnt lgkmcnt(2)
    v_mfma_f32_16x16x32_bf16 a[72:75], a[240:243], v[224:227], a[72:75]
    v_exp_f32 v104, v104
    v_exp_f32 v105, v105
    v_mfma_f32_16x16x32_bf16 a[76:79], a[240:243], v[228:231], a[76:79]
    s_add_u32 m0, s84, 0x8000
    s_add_u32 s79, s78, 0x18000
    buffer_load_dwordx4 v15, s[48:51], s79 offen offset:3072 nt lds
    v_exp_f32 v106, v106
    v_mfma_f32_16x16x32_bf16 a[80:83], a[240:243], v[232:235], a[80:83]
    v_exp_f32 v107, v107
    s_waitcnt lgkmcnt(0)
    v_mfma_f32_16x16x32_bf16 a[84:87], a[248:251], v[224:227], a[84:87]
    v_cvt_pk_bf16_f32 v242, v104, v105
    v_cvt_pk_bf16_f32 v243, v106, v107
    v_mfma_f32_16x16x32_bf16 a[88:91], a[248:251], v[228:231], a[88:91]
    v_exp_f32 v108, v108
    v_mfma_f32_16x16x32_bf16 a[92:95], a[248:251], v[232:235], a[92:95]
    v_exp_f32 v109, v109
    v_mfma_f32_16x16x32_bf16 a[96:99], v[44:47], v[224:227], a[96:99]
    v_exp_f32 v110, v110
    v_exp_f32 v111, v111
    v_mfma_f32_16x16x32_bf16 a[100:103], v[44:47], v[228:231], a[100:103]
    v_cvt_pk_bf16_f32 v246, v108, v109
    v_mfma_f32_16x16x32_bf16 a[104:107], v[44:47], v[232:235], a[104:107]
    v_cvt_pk_bf16_f32 v247, v110, v111
    v_mfma_f32_16x16x32_bf16 v[136:139], a[160:163], v[160:163], v[32:35]
    ds_read_b64_tr_b16 a[196:197], v52 offset:8192
    v_max3_f32 v60, v112, v113, v114
    v_mfma_f32_16x16x32_bf16 v[140:143], a[160:163], v[176:179], v[36:39]
    ds_read_b64_tr_b16 a[198:199], v52 offset:12288
    v_mfma_f32_16x16x32_bf16 v[144:147], a[160:163], v[192:195], v[40:43]
    v_max3_f32 v60, v60, v115, v116
    v_mfma_f32_16x16x32_bf16 v[136:139], a[164:167], v[164:167], v[136:139]
    s_add_u32 m0, s84, 0xc000
    s_add_u32 s79, s78, 0x18000
    buffer_load_dwordx4 v16, s[52:55], s79 offen nt lds
    ds_read_b64_tr_b16 a[204:205], v53 offset:8192
    v_mfma_f32_16x16x32_bf16 v[140:143], a[164:167], v[180:183], v[140:143]
    v_max3_f32 v60, v60, v117, v118
    v_mfma_f32_16x16x32_bf16 v[144:147], a[164:167], v[196:199], v[144:147]
    ds_read_b64_tr_b16 a[206:207], v53 offset:12288
    v_mfma_f32_16x16x32_bf16 v[136:139], a[168:171], v[168:171], v[136:139]
    ds_read_b64_tr_b16 a[212:213], v54 offset:8192
    v_mfma_f32_16x16x32_bf16 v[140:143], a[168:171], v[184:187], v[140:143]
    v_max3_f32 v60, v60, v119, v120
    v_mfma_f32_16x16x32_bf16 v[144:147], a[168:171], v[200:203], v[144:147]
    ds_read_b64_tr_b16 a[214:215], v54 offset:12288
    v_max3_f32 v60, v60, v121, v122
    v_mfma_f32_16x16x32_bf16 v[136:139], a[172:175], v[172:175], v[136:139]
    ds_read_b64_tr_b16 a[220:221], v55 offset:8192
    v_mfma_f32_16x16x32_bf16 v[140:143], a[172:175], v[188:191], v[140:143]
    ds_read_b64_tr_b16 a[222:223], v55 offset:12288
    v_mfma_f32_16x16x32_bf16 v[144:147], a[172:175], v[204:207], v[144:147]
    v_max3_f32 v60, v60, v123, v124
    v_mfma_f32_16x16x32_bf16 v[148:151], a[176:179], v[160:163], v[32:35]
    ds_read_b64_tr_b16 a[228:229], v56 offset:8192
    v_mfma_f32_16x16x32_bf16 v[152:155], a[176:179], v[176:179], v[36:39]
    v_max3_f32 v60, v60, v125, v126
    v_mfma_f32_16x16x32_bf16 v[156:159], a[176:179], v[192:195], v[40:43]
    s_add_u32 m0, s84, 0xc000
    s_add_u32 s79, s78, 0x18000
    buffer_load_dwordx4 v17, s[52:55], s79 offen offset:1024 nt lds
    ds_read_b64_tr_b16 a[230:231], v56 offset:12288
    v_mfma_f32_16x16x32_bf16 v[148:151], a[180:183], v[164:167], v[148:151]
    ds_read_b64_tr_b16 a[236:237], v57 offset:8192
    v_mfma_f32_16x16x32_bf16 v[152:155], a[180:183], v[180:183], v[152:155]
    v_max3_f32 v60, v60, v127, v128
    ds_read_b64_tr_b16 a[238:239], v57 offset:12288
    v_mfma_f32_16x16x32_bf16 v[156:159], a[180:183], v[196:199], v[156:159]
    v_max3_f32 v60, v60, v129, v130
    v_mfma_f32_16x16x32_bf16 v[148:151], a[184:187], v[168:171], v[148:151]
    ds_read_b64_tr_b16 a[244:245], v58 offset:8192
    v_mfma_f32_16x16x32_bf16 v[152:155], a[184:187], v[184:187], v[152:155]
    ds_read_b64_tr_b16 a[246:247], v58 offset:12288
    v_mfma_f32_16x16x32_bf16 v[156:159], a[184:187], v[200:203], v[156:159]
    v_max3_f32 v60, v60, v131, v132
    v_mfma_f32_16x16x32_bf16 v[148:151], a[188:191], v[172:175], v[148:151]
    ds_read_b64_tr_b16 a[252:253], v59 offset:8192
    v_mfma_f32_16x16x32_bf16 v[152:155], a[188:191], v[188:191], v[152:155]
    v_max3_f32 v60, v60, v133, v134
    v_mfma_f32_16x16x32_bf16 v[156:159], a[188:191], v[204:207], v[156:159]
    ds_read_b64_tr_b16 a[254:255], v59 offset:12288
    s_waitcnt lgkmcnt(14)
    v_mfma_f32_16x16x32_bf16 a[0:3], a[196:199], v[236:239], a[0:3]
    v_mfma_f32_16x16x32_bf16 a[4:7], a[196:199], v[240:243], a[4:7]
    s_add_u32 m0, s84, 0xc000
    s_add_u32 s79, s78, 0x18000
    buffer_load_dwordx4 v16, s[52:55], s79 offen offset:2048 nt lds
    v_mfma_f32_16x16x32_bf16 a[8:11], a[196:199], v[244:247], a[8:11]
    s_waitcnt lgkmcnt(12)
    v_mfma_f32_16x16x32_bf16 a[12:15], a[204:207], v[236:239], a[12:15]
    v_mfma_f32_16x16x32_bf16 a[16:19], a[204:207], v[240:243], a[16:19]
    v_mfma_f32_16x16x32_bf16 a[20:23], a[204:207], v[244:247], a[20:23]
    s_waitcnt lgkmcnt(10)
    v_mfma_f32_16x16x32_bf16 a[24:27], a[212:215], v[236:239], a[24:27]
    v_max3_f32 v60, v60, v135, v136
    v_mfma_f32_16x16x32_bf16 a[28:31], a[212:215], v[240:243], a[28:31]
    v_max3_f32 v60, v60, v137, v138
    v_mfma_f32_16x16x32_bf16 a[32:35], a[212:215], v[244:247], a[32:35]
    s_waitcnt lgkmcnt(8)
    v_mfma_f32_16x16x32_bf16 a[36:39], a[220:223], v[236:239], a[36:39]
    v_max3_f32 v60, v60, v139, v140
    v_mfma_f32_16x16x32_bf16 a[40:43], a[220:223], v[240:243], a[40:43]
    v_max3_f32 v60, v60, v141, v142
    v_mfma_f32_16x16x32_bf16 a[44:47], a[220:223], v[244:247], a[44:47]
    s_waitcnt lgkmcnt(6)
    v_mfma_f32_16x16x32_bf16 a[48:51], a[228:231], v[236:239], a[48:51]
    s_add_u32 m0, s84, 0xc000
    s_add_u32 s79, s78, 0x18000
    buffer_load_dwordx4 v17, s[52:55], s79 offen offset:3072 nt lds
    v_max3_f32 v60, v60, v143, v144
    v_mfma_f32_16x16x32_bf16 a[52:55], a[228:231], v[240:243], a[52:55]
    v_mfma_f32_16x16x32_bf16 a[56:59], a[228:231], v[244:247], a[56:59]
    v_max3_f32 v60, v60, v145, v146
    s_waitcnt lgkmcnt(4)
    v_mfma_f32_16x16x32_bf16 a[60:63], a[236:239], v[236:239], a[60:63]
    v_max3_f32 v60, v60, v147, v148
    v_mfma_f32_16x16x32_bf16 a[64:67], a[236:239], v[240:243], a[64:67]
    v_mfma_f32_16x16x32_bf16 a[68:71], a[236:239], v[244:247], a[68:71]
    v_max3_f32 v60, v60, v149, v150
    s_waitcnt lgkmcnt(2)
    v_mfma_f32_16x16x32_bf16 a[72:75], a[244:247], v[236:239], a[72:75]
    v_max3_f32 v60, v60, v151, v152
    v_mfma_f32_16x16x32_bf16 a[76:79], a[244:247], v[240:243], a[76:79]
    v_mfma_f32_16x16x32_bf16 a[80:83], a[244:247], v[244:247], a[80:83]
    v_max3_f32 v60, v60, v153, v154
    s_waitcnt lgkmcnt(0)
    v_mfma_f32_16x16x32_bf16 a[84:87], a[252:255], v[236:239], a[84:87]
    v_mfma_f32_16x16x32_bf16 a[88:91], a[252:255], v[240:243], a[88:91]
    v_max3_f32 v60, v60, v155, v156
    v_mfma_f32_16x16x32_bf16 a[92:95], a[252:255], v[244:247], a[92:95]
    v_max3_f32 v60, v60, v157, v158
    v_mfma_f32_16x16x32_bf16 a[96:99], v[44:47], v[236:239], a[96:99]
    v_mfma_f32_16x16x32_bf16 a[100:103], v[44:47], v[240:243], a[100:103]
    v_max_f32 v60, v60, v159
    v_mfma_f32_16x16x32_bf16 a[104:107], v[44:47], v[244:247], a[104:107]
    v_cmp_lt_f32 vcc, s87, v60
    s_nop 3
    s_cbranch_vccnz L_slow2
L_back2:
    v_add_u32 v48, 0x20000, v18
    v_add_u32 v49, 0x20000, v19
    v_add_u32 v50, 0x20000, v20
    v_add_u32 v51, 0x20000, v21
    s_waitcnt vmcnt(20)
    v_add_u32 v52, 0x1c000, v22
    v_add_u32 v53, 0x1c000, v23
    v_add_u32 v54, 0x1c000, v24
    v_add_u32 v55, 0x1c000, v25
    v_add_u32 v56, 0x1c000, v26
    v_add_u32 v57, 0x1c000, v27
    v_add_u32 v58, 0x1c000, v28
    v_add_u32 v59, 0x1c000, v29
    s_waitcnt lgkmcnt(0)
    s_barrier
    ds_read_b128 a[128:131], v48
    ds_read_b128 a[132:135], v49
    ds_read_b128 a[136:139], v50
    ds_read_b128 a[140:143], v51
    ds_read_b128 a[144:147], v48 offset:4096
    ds_read_b128 a[148:151], v49 offset:4096
    s_waitcnt lgkmcnt(5)
    v_mfma_f32_16x16x32_bf16 v[64:67], a[128:131], v[160:163], v[32:35]
    ds_read_b128 a[152:155], v50 offset:4096
    ds_read_b128 a[156:159], v51 offset:4096
    ds_read_b128 a[160:163], v48 offset:8192
    v_mfma_f32_16x16x32_bf16 v[68:71], a[128:131], v[176:179], v[36:39]
    ds_read_b128 a[164:167], v49 offset:8192
    ds_read_b128 a[168:171], v50 offset:8192
    ds_read_b128 a[172:175], v51 offset:8192
    v_mfma_f32_16x16x32_bf16 v[72:75], a[128:131], v[192:195], v[40:43]
    ds_read_b128 a[176:179], v48 offset:12288
    ds_read_b128 a[180:183], v49 offset:12288
    s_waitcnt lgkmcnt(12)
    v_mfma_f32_16x16x32_bf16 v[64:67], a[132:135], v[164:167], v[64:67]
    ds_read_b128 a[184:187], v50 offset:12288
    ds_read_b128 a[188:191], v51 offset:12288
    v_exp_f32 v112, v112
    v_mfma_f32_16x16x32_bf16 v[68:71], a[132:135], v[180:183], v[68:71]
    ds_read_b64_tr_b16 a[192:193], v52
    v_exp_f32 v113, v113
    v_mfma_f32_16x16x32_bf16 v[72:75], a[132:135], v[196:199], v[72:75]
    v_exp_f32 v114, v114
    ds_read_b64_tr_b16 a[194:195], v52 offset:4096
    v_exp_f32 v115, v115
    s_waitcnt lgkmcnt(15)
    v_mfma_f32_16x16x32_bf16 v[64:67], a[136:139], v[168:171], v[64:67]
    v_cvt_pk_bf16_f32 v224, v112, v113
    ds_read_b64_tr_b16 a[200:201], v53
    v_cvt_pk_bf16_f32 v225, v114, v115
    v_mfma_f32_16x16x32_bf16 v[68:71], a[136:139], v[184:187], v[68:71]
    v_exp_f32 v116, v116
    ds_read_b64_tr_b16 a[202:203], v53 offset:4096
    v_mfma_f32_16x16x32_bf16 v[72:75], a[136:139], v[200:203], v[72:75]
    v_exp_f32 v117, v117
    v_exp_f32 v118, v118
    v_exp_f32 v119, v119
    s_waitcnt lgkmcnt(15)
    v_mfma_f32_16x16x32_bf16 v[64:67], a[140:143], v[172:175], v[64:67]
    ds_read_b64_tr_b16 a[208:209], v54
    v_cvt_pk_bf16_f32 v228, v116, v117
    v_mfma_f32_16x16x32_bf16 v[68:71], a[140:143], v[188:191], v[68:71]
    s_add_u32 m0, s84, 0x10000
    s_add_u32 s79, s78, 0x1c000
    buffer_load_dwordx4 v12, s[48:51], s79 offen nt lds
    v_cvt_pk_bf16_f32 v229, v118, v119
    ds_read_b64_tr_b16 a[210:211], v54 offset:4096
    v_exp_f32 v120, v120
    v_mfma_f32_16x16x32_bf16 v[72:75], a[140:143], v[204:207], v[72:75]
    v_exp_f32 v121, v121
    ds_read_b64_tr_b16 a[216:217], v55
    v_mfma_f32_16x16x32_bf16 v[76:79], a[144:147], v[160:163], v[32:35]
    v_exp_f32 v122, v122
    v_exp_f32 v123, v123
    ds_read_b64_tr_b16 a[218:219], v55 offset:4096
    v_mfma_f32_16x16x32_bf16 v[80:83], a[144:147], v[176:179], v[36:39]
    v_cvt_pk_bf16_f32 v232, v120, v121
    v_cvt_pk_bf16_f32 v233, v122, v123
    v_exp_f32 v124, v124
    v_mfma_f32_16x16x32_bf16 v[84:87], a[144:147], v[192:195], v[40:43]
    ds_read_b64_tr_b16 a[224:225], v56
    v_exp_f32 v125, v125
    s_waitcnt lgkmcnt(15)
    v_mfma_f32_16x16x32_bf16 v[76:79], a[148:151], v[164:167], v[76:79]
    v_exp_f32 v126, v126
    ds_read_b64_tr_b16 a[226:227], v56 offset:4096
    v_exp_f32 v127, v127
    v_mfma_f32_16x16x32_bf16 v[80:83], a[148:151], v[180:183], v[80:83]
    v_cvt_pk_bf16_f32 v226, v124, v125
    ds_read_b64_tr_b16 a[232:233], v57
    v_mfma_f32_16x16x32_bf16 v[84:87], a[148:151], v[196:199], v[84:87]
    v_cvt_pk_bf16_f32 v227, v126, v127
    v_exp_f32 v128, v128
    ds_read_b64_tr_b16 a[234:235], v57 offset:4096
    v_mfma_f32_16x16x32_bf16 v[76:79], a[152:155], v[168:171], v[76:79]
    v_exp_f32 v129, v129
    v_exp_f32 v130, v130
    v_exp_f32 v131, v131
    v_mfma_f32_16x16x32_bf16 v[80:83], a[152:155], v[184:187], v[80:83]
    ds_read_b64_tr_b16 a[240:241], v58
    v_cvt_pk_bf16_f32 v230, v128, v129
    v_mfma_f32_16x16x32_bf16 v[84:87], a[152:155], v[200:203], v[84:87]
    v_cvt_pk_bf16_f32 v231, v130, v131
    ds_read_b64_tr_b16 a[242:243], v58 offset:4096
    v_exp_f32 v132, v132
    v_mfma_f32_16x16x32_bf16 v[76:79], a[156:159], v[172:175], v[76:79]
    s_add_u32 m0, s84, 0x10000
    s_add_u32 s79, s78, 0x1c000
    buffer_load_dwordx4 v13, s[48:51], s79 offen offset:1024 nt lds
    v_exp_f32 v133, v133
    ds_read_b64_tr_b16 a[248:249], v59
    v_mfma_f32_16x16x32_bf16 v[80:83], a[156:159], v[188:191], v[80:83]
    v_exp_f32 v134, v134
    v_exp_f32 v135, v135
    ds_read_b64_tr_b16 a[250:251], v59 offset:4096
    v_mfma_f32_16x16x32_bf16 v[84:87], a[156:159], v[204:207], v[84:87]
    v_cvt_pk_bf16_f32 v234, v132, v133
    v_cvt_pk_bf16_f32 v235, v134, v135
    s_waitcnt lgkmcnt(14)
    v_mfma_f32_16x16x32_bf16 a[0:3], a[192:195], v[224:227], a[0:3]
    v_exp_f32 v136, v136
    v_exp_f32 v137, v137
    v_mfma_f32_16x16x32_bf16 a[4:7], a[192:195], v[228:231], a[4:7]
    v_exp_f32 v138, v138
    v_mfma_f32_16x16x32_bf16 a[8:11], a[192:195], v[232:235], a[8:11]
    v_exp_f32 v139, v139
    s_waitcnt lgkmcnt(12)
    v_mfma_f32_16x16x32_bf16 a[12:15], a[200:203], v[224:227], a[12:15]
    v_cvt_pk_bf16_f32 v236, v136, v137
    v_cvt_pk_bf16_f32 v237, v138, v139
    v_mfma_f32_16x16x32_bf16 a[16:19], a[200:203], v[228:231], a[16:19]
    v_exp_f32 v140, v140
    v_mfma_f32_16x16x32_bf16 a[20:23], a[200:203], v[232:235], a[20:23]
    v_exp_f32 v141, v141
    s_waitcnt lgkmcnt(10)
    v_mfma_f32_16x16x32_bf16 a[24:27], a[208:211], v[224:227], a[24:27]
    v_exp_f32 v142, v142
    v_exp_f32 v143, v143
    v_mfma_f32_16x16x32_bf16 a[28:31], a[208:211], v[228:231], a[28:31]
    v_cvt_pk_bf16_f32 v240, v140, v141
    v_mfma_f32_16x16x32_bf16 a[32:35], a[208:211], v[232:235], a[32:35]
    s_add_u32 m0, s84, 0x10000
    s_add_u32 s79, s78, 0x1c000
    buffer_load_dwordx4 v14, s[48:51], s79 offen offset:2048 nt lds
    v_cvt_pk_bf16_f32 v241, v142, v143
    s_waitcnt lgkmcnt(8)
    v_mfma_f32_16x16x32_bf16 a[36:39], a[216:219], v[224:227], a[36:39]
    v_exp_f32 v144, v144
    v_exp_f32 v145, v145
    v_mfma_f32_16x16x32_bf16 a[40:43], a[216:219], v[228:231], a[40:43]
    v_exp_f32 v146, v146
    v_mfma_f32_16x16x32_bf16 a[44:47], a[216:219], v[232:235], a[44:47]
    v_exp_f32 v147, v147
    s_waitcnt lgkmcnt(6)
    v_mfma_f32_16x16x32_bf16 a[48:51], a[224:227], v[224:227], a[48:51]
    v_cvt_pk_bf16_f32 v244, v144, v145
    v_cvt_pk_bf16_f32 v245, v146, v147
    v_mfma_f32_16x16x32_bf16 a[52:55], a[224:227], v[228:231], a[52:55]
    v_exp_f32 v148, v148
    v_mfma_f32_16x16x32_bf16 a[56:59], a[224:227], v[232:235], a[56:59]
    v_exp_f32 v149, v149
    s_waitcnt lgkmcnt(4)
    v_mfma_f32_16x16x32_bf16 a[60:63], a[232:235], v[224:227], a[60:63]
    v_exp_f32 v150, v150
    v_exp_f32 v151, v151
    v_mfma_f32_16x16x32_bf16 a[64:67], a[232:235], v[228:231], a[64:67]
    v_cvt_pk_bf16_f32 v238, v148, v149
    v_mfma_f32_16x16x32_bf16 a[68:71], a[232:235], v[232:235], a[68:71]
    v_cvt_pk_bf16_f32 v239, v150, v151
    s_waitcnt lgkmcnt(2)
    v_mfma_f32_16x16x32_bf16 a[72:75], a[240:243], v[224:227], a[72:75]
    v_exp_f32 v152, v152
    v_exp_f32 v153, v153
    v_mfma_f32_16x16x32_bf16 a[76:79], a[240:243], v[228:231], a[76:79]
    s_add_u32 m0, s84, 0x10000
    s_add_u32 s79, s78, 0x1c000
    buffer_load_dwordx4 v15, s[48:51], s79 offen offset:3072 nt lds
    v_exp_f32 v154, v154
    v_mfma_f32_16x16x32_bf16 a[80:83], a[240:243], v[232:235], a[80:83]
    v_exp_f32 v155, v155
    s_waitcnt lgkmcnt(0)
    v_mfma_f32_16x16x32_bf16 a[84:87], a[248:251], v[224:227], a[84:87]
    v_cvt_pk_bf16_f32 v242, v152, v153
    v_cvt_pk_bf16_f32 v243, v154, v155
    v_mfma_f32_16x16x32_bf16 a[88:91], a[248:251], v[228:231], a[88:91]
    v_exp_f32 v156, v156
    v_mfma_f32_16x16x32_bf16 a[92:95], a[248:251], v[232:235], a[92:95]
    v_exp_f32 v157, v157
    v_mfma_f32_16x16x32_bf16 a[96:99], v[44:47], v[224:227], a[96:99]
    v_exp_f32 v158, v158
    v_exp_f32 v159, v159
    v_mfma_f32_16x16x32_bf16 a[100:103], v[44:47], v[228:231], a[100:103]
    v_cvt_pk_bf16_f32 v246, v156, v157
    v_mfma_f32_16x16x32_bf16 a[104:107], v[44:47], v[232:235], a[104:107]
    v_cvt_pk_bf16_f32 v247, v158, v159
    v_mfma_f32_16x16x32_bf16 v[88:91], a[160:163], v[160:163], v[32:35]
    ds_read_b64_tr_b16 a[196:197], v52 offset:8192
    v_max3_f32 v60, v64, v65, v66
    v_mfma_f32_16x16x32_bf16 v[92:95], a[160:163], v[176:179], v[36:39]
    ds_read_b64_tr_b16 a[198:199], v52 offset:12288
    v_mfma_f32_16x16x32_bf16 v[96:99], a[160:163], v[192:195], v[40:43]
    v_max3_f32 v60, v60, v67, v68
    v_mfma_f32_16x16x32_bf16 v[88:91], a[164:167], v[164:167], v[88:91]
    s_add_u32 m0, s84, 0x14000
    s_add_u32 s79, s78, 0x1c000
    buffer_load_dwordx4 v16, s[52:55], s79 offen nt lds
    ds_read_b64_tr_b16 a[204:205], v53 offset:8192
    v_mfma_f32_16x16x32_bf16 v[92:95], a[164:167], v[180:183], v[92:95]
    v_max3_f32 v60, v60, v69, v70
    v_mfma_f32_16x16x32_bf16 v[96:99], a[164:167], v[196:199], v[96:99]
    ds_read_b64_tr_b16 a[206:207], v53 offset:12288
    v_mfma_f32_16x16x32_bf16 v[88:91], a[168:171], v[168:171], v[88:91]
    ds_read_b64_tr_b16 a[212:213], v54 offset:8192
    v_mfma_f32_16x16x32_bf16 v[92:95], a[168:171], v[184:187], v[92:95]
    v_max3_f32 v60, v60, v71, v72
    v_mfma_f32_16x16x32_bf16 v[96:99], a[168:171], v[200:203], v[96:99]
    ds_read_b64_tr_b16 a[214:215], v54 offset:12288
    v_max3_f32 v60, v60, v73, v74
    v_mfma_f32_16x16x32_bf16 v[88:91], a[172:175], v[172:175], v[88:91]
    ds_read_b64_tr_b16 a[220:221], v55 offset:8192
    v_mfma_f32_16x16x32_bf16 v[92:95], a[172:175], v[188:191], v[92:95]
    ds_read_b64_tr_b16 a[222:223], v55 offset:12288
    v_mfma_f32_16x16x32_bf16 v[96:99], a[172:175], v[204:207], v[96:99]
    v_max3_f32 v60, v60, v75, v76
    v_mfma_f32_16x16x32_bf16 v[100:103], a[176:179], v[160:163], v[32:35]
    ds_read_b64_tr_b16 a[228:229], v56 offset:8192
    v_mfma_f32_16x16x32_bf16 v[104:107], a[176:179], v[176:179], v[36:39]
    v_max3_f32 v60, v60, v77, v78
    v_mfma_f32_16x16x32_bf16 v[108:111], a[176:179], v[192:195], v[40:43]
    s_add_u32 m0, s84, 0x14000
    s_add_u32 s79, s78, 0x1c000
    buffer_load_dwordx4 v17, s[52:55], s79 offen offset:1024 nt lds
    ds_read_b64_tr_b16 a[230:231], v56 offset:12288
    v_mfma_f32_16x16x32_bf16 v[100:103], a[180:183], v[164:167], v[100:103]
    ds_read_b64_tr_b16 a[236:237], v57 offset:8192
    v_mfma_f32_16x16x32_bf16 v[104:107], a[180:183], v[180:183], v[104:107]
    v_max3_f32 v60, v60, v79, v80
    ds_read_b64_tr_b16 a[238:239], v57 offset:12288
    v_mfma_f32_16x16x32_bf16 v[108:111], a[180:183], v[196:199], v[108:111]
    v_max3_f32 v60, v60, v81, v82
    v_mfma_f32_16x16x32_bf16 v[100:103], a[184:187], v[168:171], v[100:103]
    ds_read_b64_tr_b16 a[244:245], v58 offset:8192
    v_mfma_f32_16x16x32_bf16 v[104:107], a[184:187], v[184:187], v[104:107]
    ds_read_b64_tr_b16 a[246:247], v58 offset:12288
    v_mfma_f32_16x16x32_bf16 v[108:111], a[184:187], v[200:203], v[108:111]
    v_max3_f32 v60, v60, v83, v84
    v_mfma_f32_16x16x32_bf16 v[100:103], a[188:191], v[172:175], v[100:103]
    ds_read_b64_tr_b16 a[252:253], v59 offset:8192
    v_mfma_f32_16x16x32_bf16 v[104:107], a[188:191], v[188:191], v[104:107]
    v_max3_f32 v60, v60, v85, v86
    v_mfma_f32_16x16x32_bf16 v[108:111], a[188:191], v[204:207], v[108:111]
    ds_read_b64_tr_b16 a[254:255], v59 offset:12288
    s_waitcnt lgkmcnt(14)
    v_mfma_f32_16x16x32_bf16 a[0:3], a[196:199], v[236:239], a[0:3]
    v_mfma_f32_16x16x32_bf16 a[4:7], a[196:199], v[240:243], a[4:7]
    s_add_u32 m0, s84, 0x14000
    s_add_u32 s79, s78, 0x1c000
    buffer_load_dwordx4 v16, s[52:55], s79 offen offset:2048 nt lds
    v_mfma_f32_16x16x32_bf16 a[8:11], a[196:199], v[244:247], a[8:11]
    s_waitcnt lgkmcnt(12)
    v_mfma_f32_16x16x32_bf16 a[12:15], a[204:207], v[236:239], a[12:15]
    v_mfma_f32_16x16x32_bf16 a[16:19], a[204:207], v[240:243], a[16:19]
    v_mfma_f32_16x16x32_bf16 a[20:23], a[204:207], v[244:247], a[20:23]
    s_waitcnt lgkmcnt(10)
    v_mfma_f32_16x16x32_bf16 a[24:27], a[212:215], v[236:239], a[24:27]
    v_max3_f32 v60, v60, v87, v88
    v_mfma_f32_16x16x32_bf16 a[28:31], a[212:215], v[240:243], a[28:31]
    v_max3_f32 v60, v60, v89, v90
    v_mfma_f32_16x16x32_bf16 a[32:35], a[212:215], v[244:247], a[32:35]
    s_waitcnt lgkmcnt(8)
    v_mfma_f32_16x16x32_bf16 a[36:39], a[220:223], v[236:239], a[36:39]
    v_max3_f32 v60, v60, v91, v92
    v_mfma_f32_16x16x32_bf16 a[40:43], a[220:223], v[240:243], a[40:43]
    v_max3_f32 v60, v60, v93, v94
    v_mfma_f32_16x16x32_bf16 a[44:47], a[220:223], v[244:247], a[44:47]
    s_waitcnt lgkmcnt(6)
    v_mfma_f32_16x16x32_bf16 a[48:51], a[228:231], v[236:239], a[48:51]
    s_add_u32 m0, s84, 0x14000
    s_add_u32 s79, s78, 0x1c000
    buffer_load_dwordx4 v17, s[52:55], s79 offen offset:3072 nt lds
    v_max3_f32 v60, v60, v95, v96
    v_mfma_f32_16x16x32_bf16 a[52:55], a[228:231], v[240:243], a[52:55]
    v_mfma_f32_16x16x32_bf16 a[56:59], a[228:231], v[244:247], a[56:59]
    v_max3_f32 v60, v60, v97, v98
    s_waitcnt lgkmcnt(4)
    v_mfma_f32_16x16x32_bf16 a[60:63], a[236:239], v[236:239], a[60:63]
    v_max3_f32 v60, v60, v99, v100
    v_mfma_f32_16x16x32_bf16 a[64:67], a[236:239], v[240:243], a[64:67]
    v_mfma_f32_16x16x32_bf16 a[68:71], a[236:239], v[244:247], a[68:71]
    v_max3_f32 v60, v60, v101, v102
    s_waitcnt lgkmcnt(2)
    v_mfma_f32_16x16x32_bf16 a[72:75], a[244:247], v[236:239], a[72:75]
    v_max3_f32 v60, v60, v103, v104
    v_mfma_f32_16x16x32_bf16 a[76:79], a[244:247], v[240:243], a[76:79]
    v_mfma_f32_16x16x32_bf16 a[80:83], a[244:247], v[244:247], a[80:83]
    v_max3_f32 v60, v60, v105, v106
    s_waitcnt lgkmcnt(0)
    v_mfma_f32_16x16x32_bf16 a[84:87], a[252:255], v[236:239], a[84:87]
    v_mfma_f32_16x16x32_bf16 a[88:91], a[252:255], v[240:243], a[88:91]
    v_max3_f32 v60, v60, v107, v108
    v_mfma_f32_16x16x32_bf16 a[92:95], a[252:255], v[244:247], a[92:95]
    v_max3_f32 v60, v60, v109, v110
    v_mfma_f32_16x16x32_bf16 a[96:99], v[44:47], v[236:239], a[96:99]
    v_mfma_f32_16x16x32_bf16 a[100:103], v[44:47], v[240:243], a[100:103]
    v_max_f32 v60, v60, v111
    v_mfma_f32_16x16x32_bf16 a[104:107], v[44:47], v[244:247], a[104:107]
    v_cmp_lt_f32 vcc, s87, v60
    s_nop 3
    s_cbranch_vccnz L_slow3
L_back3:
    v_add_u32 v48, 0, v18
    v_add_u32 v49, 0, v19
    v_add_u32 v50, 0, v20
    v_add_u32 v51, 0, v21
    s_waitcnt vmcnt(20)
    v_add_u32 v52, 0x24000, v22
    v_add_u32 v53, 0x24000, v23
    v_add_u32 v54, 0x24000, v24
    v_add_u32 v55, 0x24000, v25
    v_add_u32 v56, 0x24000, v26
    v_add_u32 v57, 0x24000, v27
    v_add_u32 v58, 0x24000, v28
    v_add_u32 v59, 0x24000, v29
    s_waitcnt lgkmcnt(0)
    s_barrier
    ds_read_b128 a[128:131], v48
    ds_read_b128 a[132:135], v49
    ds_read_b128 a[136:139], v50
    ds_read_b128 a[140:143], v51
    ds_read_b128 a[144:147], v48 offset:4096
    ds_read_b128 a[148:151], v49 offset:4096
    s_waitcnt lgkmcnt(5)
    v_mfma_f32_16x16x32_bf16 v[112:115], a[128:131], v[160:163], v[32:35]
    ds_read_b128 a[152:155], v50 offset:4096
    ds_read_b128 a[156:159], v51 offset:4096
    ds_read_b128 a[160:163], v48 offset:8192
    v_mfma_f32_16x16x32_bf16 v[116:119], a[128:131], v[176:179], v[36:39]
    ds_read_b128 a[164:167], v49 offset:8192
    ds_read_b128 a[168:171], v50 offset:8192
    ds_read_b128 a[172:175], v51 offset:8192
    v_mfma_f32_16x16x32_bf16 v[120:123], a[128:131], v[192:195], v[40:43]
    ds_read_b128 a[176:179], v48 offset:12288
    ds_read_b128 a[180:183], v49 offset:12288
    s_waitcnt lgkmcnt(12)
    v_mfma_f32_16x16x32_bf16 v[112:115], a[132:135], v[164:167], v[112:115]
    ds_read_b128 a[184:187], v50 offset:12288
    ds_read_b128 a[188:191], v51 offset:12288
    v_exp_f32 v64, v64
    v_mfma_f32_16x16x32_bf16 v[116:119], a[132:135], v[180:183], v[116:119]
    ds_read_b64_tr_b16 a[192:193], v52
    v_exp_f32 v65, v65
    v_mfma_f32_16x16x32_bf16 v[120:123], a[132:135], v[196:199], v[120:123]
    v_exp_f32 v66, v66
    ds_read_b64_tr_b16 a[194:195], v52 offset:4096
    v_exp_f32 v67, v67
    s_waitcnt lgkmcnt(15)
    v_mfma_f32_16x16x32_bf16 v[112:115], a[136:139], v[168:171], v[112:115]
    v_cvt_pk_bf16_f32 v224, v64, v65
    ds_read_b64_tr_b16 a[200:201], v53
    v_cvt_pk_bf16_f32 v225, v66, v67
    v_mfma_f32_16x16x32_bf16 v[116:119], a[136:139], v[184:187], v[116:119]
    v_exp_f32 v68, v68
    ds_read_b64_tr_b16 a[202:203], v53 offset:4096
    v_mfma_f32_16x16x32_bf16 v[120:123], a[136:139], v[200:203], v[120:123]
    v_exp_f32 v69, v69
    v_exp_f32 v70, v70
    v_exp_f32 v71, v71
    s_waitcnt lgkmcnt(15)
    v_mfma_f32_16x16x32_bf16 v[112:115], a[140:143], v[172:175], v[112:115]
    ds_read_b64_tr_b16 a[208:209], v54
    v_cvt_pk_bf16_f32 v228, v68, v69
    v_mfma_f32_16x16x32_bf16 v[116:119], a[140:143], v[188:191], v[116:119]
    v_cvt_pk_bf16_f32 v229, v70, v71
    ds_read_b64_tr_b16 a[210:211], v54 offset:4096
    v_exp_f32 v72, v72
    v_mfma_f32_16x16x32_bf16 v[120:123], a[140:143], v[204:207], v[120:123]
    v_exp_f32 v73, v73
    ds_read_b64_tr_b16 a[216:217], v55
    v_mfma_f32_16x16x32_bf16 v[124:127], a[144:147], v[160:163], v[32:35]
    v_exp_f32 v74, v74
    v_exp_f32 v75, v75
    ds_read_b64_tr_b16 a[218:219], v55 offset:4096
    v_mfma_f32_16x16x32_bf16 v[128:131], a[144:147], v[176:179], v[36:39]
    v_cvt_pk_bf16_f32 v232, v72, v73
    v_cvt_pk_bf16_f32 v233, v74, v75
    v_exp_f32 v76, v76
    v_mfma_f32_16x16x32_bf16 v[132:135], a[144:147], v[192:195], v[40:43]
    ds_read_b64_tr_b16 a[224:225], v56
    v_exp_f32 v77, v77
    s_waitcnt lgkmcnt(15)
    v_mfma_f32_16x16x32_bf16 v[124:127], a[148:151], v[164:167], v[124:127]
    v_exp_f32 v78, v78
    ds_read_b64_tr_b16 a[226:227], v56 offset:4096
    v_exp_f32 v79, v79
    v_mfma_f32_16x16x32_bf16 v[128:131], a[148:151], v[180:183], v[128:131]
    v_cvt_pk_bf16_f32 v226, v76, v77
    ds_read_b64_tr_b16 a[232:233], v57
    v_mfma_f32_16x16x32_bf16 v[132:135], a[148:151], v[196:199], v[132:135]
    v_cvt_pk_bf16_f32 v227, v78, v79
    v_exp_f32 v80, v80
    ds_read_b64_tr_b16 a[234:235], v57 offset:4096
    v_mfma_f32_16x16x32_bf16 v[124:127], a[152:155], v[168:171], v[124:127]
    v_exp_f32 v81, v81
    v_exp_f32 v82, v82
    v_exp_f32 v83, v83
    v_mfma_f32_16x16x32_bf16 v[128:131], a[152:155], v[184:187], v[128:131]
    ds_read_b64_tr_b16 a[240:241], v58
    v_cvt_pk_bf16_f32 v230, v80, v81
    v_mfma_f32_16x16x32_bf16 v[132:135], a[152:155], v[200:203], v[132:135]
    v_cvt_pk_bf16_f32 v231, v82, v83
    ds_read_b64_tr_b16 a[242:243], v58 offset:4096
    v_exp_f32 v84, v84
    v_mfma_f32_16x16x32_bf16 v[124:127], a[156:159], v[172:175], v[124:127]
    v_exp_f32 v85, v85
    ds_read_b64_tr_b16 a[248:249], v59
    v_mfma_f32_16x16x32_bf16 v[128:131], a[156:159], v[188:191], v[128:131]
    v_exp_f32 v86, v86
    v_exp_f32 v87, v87
    ds_read_b64_tr_b16 a[250:251], v59 offset:4096
    v_mfma_f32_16x16x32_bf16 v[132:135], a[156:159], v[204:207], v[132:135]
    v_cvt_pk_bf16_f32 v234, v84, v85
    v_cvt_pk_bf16_f32 v235, v86, v87
    s_waitcnt lgkmcnt(14)
    v_mfma_f32_16x16x32_bf16 a[0:3], a[192:195], v[224:227], a[0:3]
    v_exp_f32 v88, v88
    v_exp_f32 v89, v89
    v_mfma_f32_16x16x32_bf16 a[4:7], a[192:195], v[228:231], a[4:7]
    v_exp_f32 v90, v90
    v_mfma_f32_16x16x32_bf16 a[8:11], a[192:195], v[232:235], a[8:11]
    v_exp_f32 v91, v91
    s_waitcnt lgkmcnt(12)
    v_mfma_f32_16x16x32_bf16 a[12:15], a[200:203], v[224:227], a[12:15]
    v_cvt_pk_bf16_f32 v236, v88, v89
    v_cvt_pk_bf16_f32 v237, v90, v91
    v_mfma_f32_16x16x32_bf16 a[16:19], a[200:203], v[228:231], a[16:19]
    v_exp_f32 v92, v92
    v_mfma_f32_16x16x32_bf16 a[20:23], a[200:203], v[232:235], a[20:23]
    v_exp_f32 v93, v93
    s_waitcnt lgkmcnt(10)
    v_mfma_f32_16x16x32_bf16 a[24:27], a[208:211], v[224:227], a[24:27]
    v_exp_f32 v94, v94
    v_exp_f32 v95, v95
    v_mfma_f32_16x16x32_bf16 a[28:31], a[208:211], v[228:231], a[28:31]
    v_cvt_pk_bf16_f32 v240, v92, v93
    v_mfma_f32_16x16x32_bf16 a[32:35], a[208:211], v[232:235], a[32:35]
    v_cvt_pk_bf16_f32 v241, v94, v95
    s_waitcnt lgkmcnt(8)
    v_mfma_f32_16x16x32_bf16 a[36:39], a[216:219], v[224:227], a[36:39]
    v_exp_f32 v96, v96
    v_exp_f32 v97, v97
    v_mfma_f32_16x16x32_bf16 a[40:43], a[216:219], v[228:231], a[40:43]
    v_exp_f32 v98, v98
    v_mfma_f32_16x16x32_bf16 a[44:47], a[216:219], v[232:235], a[44:47]
    v_exp_f32 v99, v99
    s_waitcnt lgkmcnt(6)
    v_mfma_f32_16x16x32_bf16 a[48:51], a[224:227], v[224:227], a[48:51]
    v_cvt_pk_bf16_f32 v244, v96, v97
    v_cvt_pk_bf16_f32 v245, v98, v99
    v_mfma_f32_16x16x32_bf16 a[52:55], a[224:227], v[228:231], a[52:55]
    v_exp_f32 v100, v100
    v_mfma_f32_16x16x32_bf16 a[56:59], a[224:227], v[232:235], a[56:59]
    v_exp_f32 v101, v101
    s_waitcnt lgkmcnt(4)
    v_mfma_f32_16x16x32_bf16 a[60:63], a[232:235], v[224:227], a[60:63]
    v_exp_f32 v102, v102
    v_exp_f32 v103, v103
    v_mfma_f32_16x16x32_bf16 a[64:67], a[232:235], v[228:231], a[64:67]
    v_cvt_pk_bf16_f32 v238, v100, v101
    v_mfma_f32_16x16x32_bf16 a[68:71], a[232:235], v[232:235], a[68:71]
    v_cvt_pk_bf16_f32 v239, v102, v103
    s_waitcnt lgkmcnt(2)
    v_mfma_f32_16x16x32_bf16 a[72:75], a[240:243], v[224:227], a[72:75]
    v_exp_f32 v104, v104
    v_exp_f32 v105, v105
    v_mfma_f32_16x16x32_bf16 a[76:79], a[240:243], v[228:231], a[76:79]
    v_exp_f32 v106, v106
    v_mfma_f32_16x16x32_bf16 a[80:83], a[240:243], v[232:235], a[80:83]
    v_exp_f32 v107, v107
    s_waitcnt lgkmcnt(0)
    v_mfma_f32_16x16x32_bf16 a[84:87], a[248:251], v[224:227], a[84:87]
    v_cvt_pk_bf16_f32 v242, v104, v105
    v_cvt_pk_bf16_f32 v243, v106, v107
    v_mfma_f32_16x16x32_bf16 a[88:91], a[248:251], v[228:231], a[88:91]
    v_exp_f32 v108, v108
    v_mfma_f32_16x16x32_bf16 a[92:95], a[248:251], v[232:235], a[92:95]
    v_exp_f32 v109, v109
    v_mfma_f32_16x16x32_bf16 a[96:99], v[44:47], v[224:227], a[96:99]
    v_exp_f32 v110, v110
    v_exp_f32 v111, v111
    v_mfma_f32_16x16x32_bf16 a[100:103], v[44:47], v[228:231], a[100:103]
    v_cvt_pk_bf16_f32 v246, v108, v109
    v_mfma_f32_16x16x32_bf16 a[104:107], v[44:47], v[232:235], a[104:107]
    v_cvt_pk_bf16_f32 v247, v110, v111
    v_mfma_f32_16x16x32_bf16 v[136:139], a[160:163], v[160:163], v[32:35]
    ds_read_b64_tr_b16 a[196:197], v52 offset:8192
    v_max3_f32 v60, v112, v113, v114
    v_mfma_f32_16x16x32_bf16 v[140:143], a[160:163], v[176:179], v[36:39]
    ds_read_b64_tr_b16 a[198:199], v52 offset:12288
    v_mfma_f32_16x16x32_bf16 v[144:147], a[160:163], v[192:195], v[40:43]
    v_max3_f32 v60, v60, v115, v116
    v_mfma_f32_16x16x32_bf16 v[136:139], a[164:167], v[164:167], v[136:139]
    ds_read_b64_tr_b16 a[204:205], v53 offset:8192
    v_mfma_f32_16x16x32_bf16 v[140:143], a[164:167], v[180:183], v[140:143]
    v_max3_f32 v60, v60, v117, v118
    v_mfma_f32_16x16x32_bf16 v[144:147], a[164:167], v[196:199], v[144:147]
    ds_read_b64_tr_b16 a[206:207], v53 offset:12288
    v_mfma_f32_16x16x32_bf16 v[136:139], a[168:171], v[168:171], v[136:139]
    ds_read_b64_tr_b16 a[212:213], v54 offset:8192
    v_mfma_f32_16x16x32_bf16 v[140:143], a[168:171], v[184:187], v[140:143]
    v_max3_f32 v60, v60, v119, v120
    v_mfma_f32_16x16x32_bf16 v[144:147], a[168:171], v[200:203], v[144:147]
    ds_read_b64_tr_b16 a[214:215], v54 offset:12288
    v_max3_f32 v60, v60, v121, v122
    v_mfma_f32_16x16x32_bf16 v[136:139], a[172:175], v[172:175], v[136:139]
    ds_read_b64_tr_b16 a[220:221], v55 offset:8192
    v_mfma_f32_16x16x32_bf16 v[140:143], a[172:175], v[188:191], v[140:143]
    ds_read_b64_tr_b16 a[222:223], v55 offset:12288
    v_mfma_f32_16x16x32_bf16 v[144:147], a[172:175], v[204:207], v[144:147]
    v_max3_f32 v60, v60, v123, v124
    v_mfma_f32_16x16x32_bf16 v[148:151], a[176:179], v[160:163], v[32:35]
    ds_read_b64_tr_b16 a[228:229], v56 offset:8192
    v_mfma_f32_16x16x32_bf16 v[152:155], a[176:179], v[176:179], v[36:39]
    v_max3_f32 v60, v60, v125, v126
    v_mfma_f32_16x16x32_bf16 v[156:159], a[176:179], v[192:195], v[40:43]
    ds_read_b64_tr_b16 a[230:231], v56 offset:12288
    v_mfma_f32_16x16x32_bf16 v[148:151], a[180:183], v[164:167], v[148:151]
    ds_read_b64_tr_b16 a[236:237], v57 offset:8192
    v_mfma_f32_16x16x32_bf16 v[152:155], a[180:183], v[180:183], v[152:155]
    v_max3_f32 v60, v60, v127, v128
    ds_read_b64_tr_b16 a[238:239], v57 offset:12288
    v_mfma_f32_16x16x32_bf16 v[156:159], a[180:183], v[196:199], v[156:159]
    v_max3_f32 v60, v60, v129, v130
    v_mfma_f32_16x16x32_bf16 v[148:151], a[184:187], v[168:171], v[148:151]
    ds_read_b64_tr_b16 a[244:245], v58 offset:8192
    v_mfma_f32_16x16x32_bf16 v[152:155], a[184:187], v[184:187], v[152:155]
    ds_read_b64_tr_b16 a[246:247], v58 offset:12288
    v_mfma_f32_16x16x32_bf16 v[156:159], a[184:187], v[200:203], v[156:159]
    v_max3_f32 v60, v60, v131, v132
    v_mfma_f32_16x16x32_bf16 v[148:151], a[188:191], v[172:175], v[148:151]
    ds_read_b64_tr_b16 a[252:253], v59 offset:8192
    v_mfma_f32_16x16x32_bf16 v[152:155], a[188:191], v[188:191], v[152:155]
    v_max3_f32 v60, v60, v133, v134
    v_mfma_f32_16x16x32_bf16 v[156:159], a[188:191], v[204:207], v[156:159]
    ds_read_b64_tr_b16 a[254:255], v59 offset:12288
    s_waitcnt lgkmcnt(14)
    v_mfma_f32_16x16x32_bf16 a[0:3], a[196:199], v[236:239], a[0:3]
    v_mfma_f32_16x16x32_bf16 a[4:7], a[196:199], v[240:243], a[4:7]
    v_mfma_f32_16x16x32_bf16 a[8:11], a[196:199], v[244:247], a[8:11]
    s_waitcnt lgkmcnt(12)
    v_mfma_f32_16x16x32_bf16 a[12:15], a[204:207], v[236:239], a[12:15]
    v_mfma_f32_16x16x32_bf16 a[16:19], a[204:207], v[240:243], a[16:19]
    v_mfma_f32_16x16x32_bf16 a[20:23], a[204:207], v[244:247], a[20:23]
    s_waitcnt lgkmcnt(10)
    v_mfma_f32_16x16x32_bf16 a[24:27], a[212:215], v[236:239], a[24:27]
    v_max3_f32 v60, v60, v135, v136
    v_mfma_f32_16x16x32_bf16 a[28:31], a[212:215], v[240:243], a[28:31]
    v_max3_f32 v60, v60, v137, v138
    v_mfma_f32_16x16x32_bf16 a[32:35], a[212:215], v[244:247], a[32:35]
    s_waitcnt lgkmcnt(8)
    v_mfma_f32_16x16x32_bf16 a[36:39], a[220:223], v[236:239], a[36:39]
    v_max3_f32 v60, v60, v139, v140
    v_mfma_f32_16x16x32_bf16 a[40:43], a[220:223], v[240:243], a[40:43]
    v_max3_f32 v60, v60, v141, v142
    v_mfma_f32_16x16x32_bf16 a[44:47], a[220:223], v[244:247], a[44:47]
    s_waitcnt lgkmcnt(6)
    v_mfma_f32_16x16x32_bf16 a[48:51], a[228:231], v[236:239], a[48:51]
    v_max3_f32 v60, v60, v143, v144
    v_mfma_f32_16x16x32_bf16 a[52:55], a[228:231], v[240:243], a[52:55]
    v_mfma_f32_16x16x32_bf16 a[56:59], a[228:231], v[244:247], a[56:59]
    v_max3_f32 v60, v60, v145, v146
    s_waitcnt lgkmcnt(4)
    v_mfma_f32_16x16x32_bf16 a[60:63], a[236:239], v[236:239], a[60:63]
    v_max3_f32 v60, v60, v147, v148
    v_mfma_f32_16x16x32_bf16 a[64:67], a[236:239], v[240:243], a[64:67]
    v_mfma_f32_16x16x32_bf16 a[68:71], a[236:239], v[244:247], a[68:71]
    v_max3_f32 v60, v60, v149, v150
    s_waitcnt lgkmcnt(2)
    v_mfma_f32_16x16x32_bf16 a[72:75], a[244:247], v[236:239], a[72:75]
    v_max3_f32 v60, v60, v151, v152
    v_mfma_f32_16x16x32_bf16 a[76:79], a[244:247], v[240:243], a[76:79]
    v_mfma_f32_16x16x32_bf16 a[80:83], a[244:247], v[244:247], a[80:83]
    v_max3_f32 v60, v60, v153, v154
    s_waitcnt lgkmcnt(0)
    v_mfma_f32_16x16x32_bf16 a[84:87], a[252:255], v[236:239], a[84:87]
    v_mfma_f32_16x16x32_bf16 a[88:91], a[252:255], v[240:243], a[88:91]
    v_max3_f32 v60, v60, v155, v156
    v_mfma_f32_16x16x32_bf16 a[92:95], a[252:255], v[244:247], a[92:95]
    v_max3_f32 v60, v60, v157, v158
    v_mfma_f32_16x16x32_bf16 a[96:99], v[44:47], v[236:239], a[96:99]
    v_mfma_f32_16x16x32_bf16 a[100:103], v[44:47], v[240:243], a[100:103]
    v_max_f32 v60, v60, v159
    v_mfma_f32_16x16x32_bf16 a[104:107], v[44:47], v[244:247], a[104:107]
    v_cmp_lt_f32 vcc, s87, v60
    s_nop 3
    s_cbranch_vccnz L_slow4
L_back4:
    v_add_u32 v48, 0x8000, v18
    v_add_u32 v49, 0x8000, v19
    v_add_u32 v50, 0x8000, v20
    v_add_u32 v51, 0x8000, v21
    s_waitcnt vmcnt(12)
    v_add_u32 v52, 0x4000, v22
    v_add_u32 v53, 0x4000, v23
    v_add_u32 v54, 0x4000, v24
    v_add_u32 v55, 0x4000, v25
    v_add_u32 v56, 0x4000, v26
    v_add_u32 v57, 0x4000, v27
    v_add_u32 v58, 0x4000, v28
    v_add_u32 v59, 0x4000, v29
    s_waitcnt lgkmcnt(0)
    s_barrier
    ds_read_b128 a[128:131], v48
    ds_read_b128 a[132:135], v49
    ds_read_b128 a[136:139], v50
    ds_read_b128 a[140:143], v51
    ds_read_b128 a[144:147], v48 offset:4096
    ds_read_b128 a[148:151], v49 offset:4096
    s_waitcnt lgkmcnt(5)
    v_mfma_f32_16x16x32_bf16 v[64:67], a[128:131], v[160:163], v[32:35]
    ds_read_b128 a[152:155], v50 offset:4096
    ds_read_b128 a[156:159], v51 offset:4096
    ds_read_b128 a[160:163], v48 offset:8192
    v_mfma_f32_16x16x32_bf16 v[68:71], a[128:131], v[176:179], v[36:39]
    ds_read_b128 a[164:167], v49 offset:8192
    ds_read_b128 a[168:171], v50 offset:8192
    ds_read_b128 a[172:175], v51 offset:8192
    v_mfma_f32_16x16x32_bf16 v[72:75], a[128:131], v[192:195], v[40:43]
    ds_read_b128 a[176:179], v48 offset:12288
    ds_read_b128 a[180:183], v49 offset:12288
    s_waitcnt lgkmcnt(12)
    v_mfma_f32_16x16x32_bf16 v[64:67], a[132:135], v[164:167], v[64:67]
    ds_read_b128 a[184:187], v50 offset:12288
    ds_read_b128 a[188:191], v51 offset:12288
    v_exp_f32 v112, v112
    v_mfma_f32_16x16x32_bf16 v[68:71], a[132:135], v[180:183], v[68:71]
    ds_read_b64_tr_b16 a[192:193], v52
    v_exp_f32 v113, v113
    v_mfma_f32_16x16x32_bf16 v[72:75], a[132:135], v[196:199], v[72:75]
    v_exp_f32 v114, v114
    ds_read_b64_tr_b16 a[194:195], v52 offset:4096
    v_exp_f32 v115, v115
    s_waitcnt lgkmcnt(15)
    v_mfma_f32_16x16x32_bf16 v[64:67], a[136:139], v[168:171], v[64:67]
    v_cvt_pk_bf16_f32 v224, v112, v113
    ds_read_b64_tr_b16 a[200:201], v53
    v_cvt_pk_bf16_f32 v225, v114, v115
    v_mfma_f32_16x16x32_bf16 v[68:71], a[136:139], v[184:187], v[68:71]
    v_exp_f32 v116, v116
    ds_read_b64_tr_b16 a[202:203], v53 offset:4096
    v_mfma_f32_16x16x32_bf16 v[72:75], a[136:139], v[200:203], v[72:75]
    v_exp_f32 v117, v117
    v_exp_f32 v118, v118
    v_exp_f32 v119, v119
    s_waitcnt lgkmcnt(15)
    v_mfma_f32_16x16x32_bf16 v[64:67], a[140:143], v[172:175], v[64:67]
    ds_read_b64_tr_b16 a[208:209], v54
    v_cvt_pk_bf16_f32 v228, v116, v117
    v_mfma_f32_16x16x32_bf16 v[68:71], a[140:143], v[188:191], v[68:71]
    v_cvt_pk_bf16_f32 v229, v118, v119
    ds_read_b64_tr_b16 a[210:211], v54 offset:4096
    v_exp_f32 v120, v120
    v_mfma_f32_16x16x32_bf16 v[72:75], a[140:143], v[204:207], v[72:75]
    v_exp_f32 v121, v121
    ds_read_b64_tr_b16 a[216:217], v55
    v_mfma_f32_16x16x32_bf16 v[76:79], a[144:147], v[160:163], v[32:35]
    v_exp_f32 v122, v122
    v_exp_f32 v123, v123
    ds_read_b64_tr_b16 a[218:219], v55 offset:4096
    v_mfma_f32_16x16x32_bf16 v[80:83], a[144:147], v[176:179], v[36:39]
    v_cvt_pk_bf16_f32 v232, v120, v121
    v_cvt_pk_bf16_f32 v233, v122, v123
    v_exp_f32 v124, v124
    v_mfma_f32_16x16x32_bf16 v[84:87], a[144:147], v[192:195], v[40:43]
    ds_read_b64_tr_b16 a[224:225], v56
    v_exp_f32 v125, v125
    s_waitcnt lgkmcnt(15)
    v_mfma_f32_16x16x32_bf16 v[76:79], a[148:151], v[164:167], v[76:79]
    v_exp_f32 v126, v126
    ds_read_b64_tr_b16 a[226:227], v56 offset:4096
    v_exp_f32 v127, v127
    v_mfma_f32_16x16x32_bf16 v[80:83], a[148:151], v[180:183], v[80:83]
    v_cvt_pk_bf16_f32 v226, v124, v125
    ds_read_b64_tr_b16 a[232:233], v57
    v_mfma_f32_16x16x32_bf16 v[84:87], a[148:151], v[196:199], v[84:87]
    v_cvt_pk_bf16_f32 v227, v126, v127
    v_exp_f32 v128, v128
    ds_read_b64_tr_b16 a[234:235], v57 offset:4096
    v_mfma_f32_16x16x32_bf16 v[76:79], a[152:155], v[168:171], v[76:79]
    v_exp_f32 v129, v129
    v_exp_f32 v130, v130
    v_exp_f32 v131, v131
    v_mfma_f32_16x16x32_bf16 v[80:83], a[152:155], v[184:187], v[80:83]
    ds_read_b64_tr_b16 a[240:241], v58
    v_cvt_pk_bf16_f32 v230, v128, v129
    v_mfma_f32_16x16x32_bf16 v[84:87], a[152:155], v[200:203], v[84:87]
    v_cvt_pk_bf16_f32 v231, v130, v131
    ds_read_b64_tr_b16 a[242:243], v58 offset:4096
    v_exp_f32 v132, v132
    v_mfma_f32_16x16x32_bf16 v[76:79], a[156:159], v[172:175], v[76:79]
    v_exp_f32 v133, v133
    ds_read_b64_tr_b16 a[248:249], v59
    v_mfma_f32_16x16x32_bf16 v[80:83], a[156:159], v[188:191], v[80:83]
    v_exp_f32 v134, v134
    v_exp_f32 v135, v135
    ds_read_b64_tr_b16 a[250:251], v59 offset:4096
    v_mfma_f32_16x16x32_bf16 v[84:87], a[156:159], v[204:207], v[84:87]
    v_cvt_pk_bf16_f32 v234, v132, v133
    v_cvt_pk_bf16_f32 v235, v134, v135
    s_waitcnt lgkmcnt(14)
    v_mfma_f32_16x16x32_bf16 a[0:3], a[192:195], v[224:227], a[0:3]
    v_exp_f32 v136, v136
    v_exp_f32 v137, v137
    v_mfma_f32_16x16x32_bf16 a[4:7], a[192:195], v[228:231], a[4:7]
    v_exp_f32 v138, v138
    v_mfma_f32_16x16x32_bf16 a[8:11], a[192:195], v[232:235], a[8:11]
    v_exp_f32 v139, v139
    s_waitcnt lgkmcnt(12)
    v_mfma_f32_16x16x32_bf16 a[12:15], a[200:203], v[224:227], a[12:15]
    v_cvt_pk_bf16_f32 v236, v136, v137
    v_cvt_pk_bf16_f32 v237, v138, v139
    v_mfma_f32_16x16x32_bf16 a[16:19], a[200:203], v[228:231], a[16:19]
    v_exp_f32 v140, v140
    v_mfma_f32_16x16x32_bf16 a[20:23], a[200:203], v[232:235], a[20:23]
    v_exp_f32 v141, v141
    s_waitcnt lgkmcnt(10)
    v_mfma_f32_16x16x32_bf16 a[24:27], a[208:211], v[224:227], a[24:27]
    v_exp_f32 v142, v142
    v_exp_f32 v143, v143
    v_mfma_f32_16x16x32_bf16 a[28:31], a[208:211], v[228:231], a[28:31]
    v_cvt_pk_bf16_f32 v240, v140, v141
    v_mfma_f32_16x16x32_bf16 a[32:35], a[208:211], v[232:235], a[32:35]
    v_cvt_pk_bf16_f32 v241, v142, v143
    s_waitcnt lgkmcnt(8)
    v_mfma_f32_16x16x32_bf16 a[36:39], a[216:219], v[224:227], a[36:39]
    v_exp_f32 v144, v144
    v_exp_f32 v145, v145
    v_mfma_f32_16x16x32_bf16 a[40:43], a[216:219], v[228:231], a[40:43]
    v_exp_f32 v146, v146
    v_mfma_f32_16x16x32_bf16 a[44:47], a[216:219], v[232:235], a[44:47]
    v_exp_f32 v147, v147
    s_waitcnt lgkmcnt(6)
    v_mfma_f32_16x16x32_bf16 a[48:51], a[224:227], v[224:227], a[48:51]
    v_cvt_pk_bf16_f32 v244, v144, v145
    v_cvt_pk_bf16_f32 v245, v146, v147
    v_mfma_f32_16x16x32_bf16 a[52:55], a[224:227], v[228:231], a[52:55]
    v_exp_f32 v148, v148
    v_mfma_f32_16x16x32_bf16 a[56:59], a[224:227], v[232:235], a[56:59]
    v_exp_f32 v149, v149
    s_waitcnt lgkmcnt(4)
    v_mfma_f32_16x16x32_bf16 a[60:63], a[232:235], v[224:227], a[60:63]
    v_exp_f32 v150, v150
    v_exp_f32 v151, v151
    v_mfma_f32_16x16x32_bf16 a[64:67], a[232:235], v[228:231], a[64:67]
    v_cvt_pk_bf16_f32 v238, v148, v149
    v_mfma_f32_16x16x32_bf16 a[68:71], a[232:235], v[232:235], a[68:71]
    v_cvt_pk_bf16_f32 v239, v150, v151
    s_waitcnt lgkmcnt(2)
    v_mfma_f32_16x16x32_bf16 a[72:75], a[240:243], v[224:227], a[72:75]
    v_exp_f32 v152, v152
    v_exp_f32 v153, v153
    v_mfma_f32_16x16x32_bf16 a[76:79], a[240:243], v[228:231], a[76:79]
    v_exp_f32 v154, v154
    v_mfma_f32_16x16x32_bf16 a[80:83], a[240:243], v[232:235], a[80:83]
    v_exp_f32 v155, v155
    s_waitcnt lgkmcnt(0)
    v_mfma_f32_16x16x32_bf16 a[84:87], a[248:251], v[224:227], a[84:87]
    v_cvt_pk_bf16_f32 v242, v152, v153
    v_cvt_pk_bf16_f32 v243, v154, v155
    v_mfma_f32_16x16x32_bf16 a[88:91], a[248:251], v[228:231], a[88:91]
    v_exp_f32 v156, v156
    v_mfma_f32_16x16x32_bf16 a[92:95], a[248:251], v[232:235], a[92:95]
    v_exp_f32 v157, v157
    v_mfma_f32_16x16x32_bf16 a[96:99], v[44:47], v[224:227], a[96:99]
    v_exp_f32 v158, v158
    v_exp_f32 v159, v159
    v_mfma_f32_16x16x32_bf16 a[100:103], v[44:47], v[228:231], a[100:103]
    v_cvt_pk_bf16_f32 v246, v156, v157
    v_mfma_f32_16x16x32_bf16 a[104:107], v[44:47], v[232:235], a[104:107]
    v_cvt_pk_bf16_f32 v247, v158, v159
    v_mfma_f32_16x16x32_bf16 v[88:91], a[160:163], v[160:163], v[32:35]
    ds_read_b64_tr_b16 a[196:197], v52 offset:8192
    v_max3_f32 v60, v64, v65, v66
    v_mfma_f32_16x16x32_bf16 v[92:95], a[160:163], v[176:179], v[36:39]
    ds_read_b64_tr_b16 a[198:199], v52 offset:12288
    v_mfma_f32_16x16x32_bf16 v[96:99], a[160:163], v[192:195], v[40:43]
    v_max3_f32 v60, v60, v67, v68
    v_mfma_f32_16x16x32_bf16 v[88:91], a[164:167], v[164:167], v[88:91]
    ds_read_b64_tr_b16 a[204:205], v53 offset:8192
    v_mfma_f32_16x16x32_bf16 v[92:95], a[164:167], v[180:183], v[92:95]
    v_max3_f32 v60, v60, v69, v70
    v_mfma_f32_16x16x32_bf16 v[96:99], a[164:167], v[196:199], v[96:99]
    ds_read_b64_tr_b16 a[206:207], v53 offset:12288
    v_mfma_f32_16x16x32_bf16 v[88:91], a[168:171], v[168:171], v[88:91]
    ds_read_b64_tr_b16 a[212:213], v54 offset:8192
    v_mfma_f32_16x16x32_bf16 v[92:95], a[168:171], v[184:187], v[92:95]
    v_max3_f32 v60, v60, v71, v72
    v_mfma_f32_16x16x32_bf16 v[96:99], a[168:171], v[200:203], v[96:99]
    ds_read_b64_tr_b16 a[214:215], v54 offset:12288
    v_max3_f32 v60, v60, v73, v74
    v_mfma_f32_16x16x32_bf16 v[88:91], a[172:175], v[172:175], v[88:91]
    ds_read_b64_tr_b16 a[220:221], v55 offset:8192
    v_mfma_f32_16x16x32_bf16 v[92:95], a[172:175], v[188:191], v[92:95]
    ds_read_b64_tr_b16 a[222:223], v55 offset:12288
    v_mfma_f32_16x16x32_bf16 v[96:99], a[172:175], v[204:207], v[96:99]
    v_max3_f32 v60, v60, v75, v76
    v_mfma_f32_16x16x32_bf16 v[100:103], a[176:179], v[160:163], v[32:35]
    ds_read_b64_tr_b16 a[228:229], v56 offset:8192
    v_mfma_f32_16x16x32_bf16 v[104:107], a[176:179], v[176:179], v[36:39]
    v_max3_f32 v60, v60, v77, v78
    v_mfma_f32_16x16x32_bf16 v[108:111], a[176:179], v[192:195], v[40:43]
    ds_read_b64_tr_b16 a[230:231], v56 offset:12288
    v_mfma_f32_16x16x32_bf16 v[100:103], a[180:183], v[164:167], v[100:103]
    ds_read_b64_tr_b16 a[236:237], v57 offset:8192
    v_mfma_f32_16x16x32_bf16 v[104:107], a[180:183], v[180:183], v[104:107]
    v_max3_f32 v60, v60, v79, v80
    ds_read_b64_tr_b16 a[238:239], v57 offset:12288
    v_mfma_f32_16x16x32_bf16 v[108:111], a[180:183], v[196:199], v[108:111]
    v_max3_f32 v60, v60, v81, v82
    v_mfma_f32_16x16x32_bf16 v[100:103], a[184:187], v[168:171], v[100:103]
    ds_read_b64_tr_b16 a[244:245], v58 offset:8192
    v_mfma_f32_16x16x32_bf16 v[104:107], a[184:187], v[184:187], v[104:107]
    ds_read_b64_tr_b16 a[246:247], v58 offset:12288
    v_mfma_f32_16x16x32_bf16 v[108:111], a[184:187], v[200:203], v[108:111]
    v_max3_f32 v60, v60, v83, v84
    v_mfma_f32_16x16x32_bf16 v[100:103], a[188:191], v[172:175], v[100:103]
    ds_read_b64_tr_b16 a[252:253], v59 offset:8192
    v_mfma_f32_16x16x32_bf16 v[104:107], a[188:191], v[188:191], v[104:107]
    v_max3_f32 v60, v60, v85, v86
    v_mfma_f32_16x16x32_bf16 v[108:111], a[188:191], v[204:207], v[108:111]
    ds_read_b64_tr_b16 a[254:255], v59 offset:12288
    s_waitcnt lgkmcnt(14)
    v_mfma_f32_16x16x32_bf16 a[0:3], a[196:199], v[236:239], a[0:3]
    v_mfma_f32_16x16x32_bf16 a[4:7], a[196:199], v[240:243], a[4:7]
    v_mfma_f32_16x16x32_bf16 a[8:11], a[196:199], v[244:247], a[8:11]
    s_waitcnt lgkmcnt(12)
    v_mfma_f32_16x16x32_bf16 a[12:15], a[204:207], v[236:239], a[12:15]
    v_mfma_f32_16x16x32_bf16 a[16:19], a[204:207], v[240:243], a[16:19]
    v_mfma_f32_16x16x32_bf16 a[20:23], a[204:207], v[244:247], a[20:23]
    s_waitcnt lgkmcnt(10)
    v_mfma_f32_16x16x32_bf16 a[24:27], a[212:215], v[236:239], a[24:27]
    v_max3_f32 v60, v60, v87, v88
    v_mfma_f32_16x16x32_bf16 a[28:31], a[212:215], v[240:243], a[28:31]
    v_max3_f32 v60, v60, v89, v90
    v_mfma_f32_16x16x32_bf16 a[32:35], a[212:215], v[244:247], a[32:35]
    s_waitcnt lgkmcnt(8)
    v_mfma_f32_16x16x32_bf16 a[36:39], a[220:223], v[236:239], a[36:39]
    v_max3_f32 v60, v60, v91, v92
    v_mfma_f32_16x16x32_bf16 a[40:43], a[220:223], v[240:243], a[40:43]
    v_max3_f32 v60, v60, v93, v94
    v_mfma_f32_16x16x32_bf16 a[44:47], a[220:223], v[244:247], a[44:47]
    s_waitcnt lgkmcnt(6)
    v_mfma_f32_16x16x32_bf16 a[48:51], a[228:231], v[236:239], a[48:51]
    v_max3_f32 v60, v60, v95, v96
    v_mfma_f32_16x16x32_bf16 a[52:55], a[228:231], v[240:243], a[52:55]
    v_mfma_f32_16x16x32_bf16 a[56:59], a[228:231], v[244:247], a[56:59]
    v_max3_f32 v60, v60, v97, v98
    s_waitcnt lgkmcnt(4)
    v_mfma_f32_16x16x32_bf16 a[60:63], a[236:239], v[236:239], a[60:63]
    v_max3_f32 v60, v60, v99, v100
    v_mfma_f32_16x16x32_bf16 a[64:67], a[236:239], v[240:243], a[64:67]
    v_mfma_f32_16x16x32_bf16 a[68:71], a[236:239], v[244:247], a[68:71]
    v_max3_f32 v60, v60, v101, v102
    s_waitcnt lgkmcnt(2)
    v_mfma_f32_16x16x32_bf16 a[72:75], a[244:247], v[236:239], a[72:75]
    v_max3_f32 v60, v60, v103, v104
    v_mfma_f32_16x16x32_bf16 a[76:79], a[244:247], v[240:243], a[76:79]
    v_mfma_f32_16x16x32_bf16 a[80:83], a[244:247], v[244:247], a[80:83]
    v_max3_f32 v60, v60, v105, v106
    s_waitcnt lgkmcnt(0)
    v_mfma_f32_16x16x32_bf16 a[84:87], a[252:255], v[236:239], a[84:87]
    v_mfma_f32_16x16x32_bf16 a[88:91], a[252:255], v[240:243], a[88:91]
    v_max3_f32 v60, v60, v107, v108
    v_mfma_f32_16x16x32_bf16 a[92:95], a[252:255], v[244:247], a[92:95]
    v_max3_f32 v60, v60, v109, v110
    v_mfma_f32_16x16x32_bf16 a[96:99], v[44:47], v[236:239], a[96:99]
    v_mfma_f32_16x16x32_bf16 a[100:103], v[44:47], v[240:243], a[100:103]
    v_max_f32 v60, v60, v111
    v_mfma_f32_16x16x32_bf16 a[104:107], v[44:47], v[244:247], a[104:107]
    v_cmp_lt_f32 vcc, s87, v60
    s_nop 3
    s_cbranch_vccnz L_slow5
L_back5:
    v_add_u32 v48, 0x10000, v18
    v_add_u32 v49, 0x10000, v19
    v_add_u32 v50, 0x10000, v20
    v_add_u32 v51, 0x10000, v21
    s_waitcnt vmcnt(4)
    v_add_u32 v52, 0xc000, v22
    v_add_u32 v53, 0xc000, v23
    v_add_u32 v54, 0xc000, v24
    v_add_u32 v55, 0xc000, v25
    v_add_u32 v56, 0xc000, v26
    v_add_u32 v57, 0xc000, v27
    v_add_u32 v58, 0xc000, v28
    v_add_u32 v59, 0xc000, v29
    s_waitcnt lgkmcnt(0)
    s_barrier
    ds_read_b128 a[128:131], v48
    ds_read_b128 a[132:135], v49
    ds_read_b128 a[136:139], v50
    ds_read_b128 a[140:143], v51
    ds_read_b128 a[144:147], v48 offset:4096
    ds_read_b128 a[148:151], v49 offset:4096
    s_waitcnt lgkmcnt(5)
    v_mfma_f32_16x16x32_bf16 v[112:115], a[128:131], v[160:163], v[32:35]
    ds_read_b128 a[152:155], v50 offset:4096
    ds_read_b128 a[156:159], v51 offset:4096
    ds_read_b128 a[160:163], v48 offset:8192
    v_mfma_f32_16x16x32_bf16 v[116:119], a[128:131], v[176:179], v[36:39]
    ds_read_b128 a[164:167], v49 offset:8192
    ds_read_b128 a[168:171], v50 offset:8192
    ds_read_b128 a[172:175], v51 offset:8192
    v_mfma_f32_16x16x32_bf16 v[120:123], a[128:131], v[192:195], v[40:43]
    ds_read_b128 a[176:179], v48 offset:12288
    ds_read_b128 a[180:183], v49 offset:12288
    s_waitcnt lgkmcnt(12)
    v_mfma_f32_16x16x32_bf16 v[112:115], a[132:135], v[164:167], v[112:115]
    ds_read_b128 a[184:187], v50 offset:12288
    ds_read_b128 a[188:191], v51 offset:12288
    v_exp_f32 v64, v64
    v_mfma_f32_16x16x32_bf16 v[116:119], a[132:135], v[180:183], v[116:119]
    ds_read_b64_tr_b16 a[192:193], v52
    v_exp_f32 v65, v65
    v_mfma_f32_16x16x32_bf16 v[120:123], a[132:135], v[196:199], v[120:123]
    v_exp_f32 v66, v66
    ds_read_b64_tr_b16 a[194:195], v52 offset:4096
    v_exp_f32 v67, v67
    s_waitcnt lgkmcnt(15)
    v_mfma_f32_16x16x32_bf16 v[112:115], a[136:139], v[168:171], v[112:115]
    v_cvt_pk_bf16_f32 v224, v64, v65
    ds_read_b64_tr_b16 a[200:201], v53
    v_cvt_pk_bf16_f32 v225, v66, v67
    v_mfma_f32_16x16x32_bf16 v[116:119], a[136:139], v[184:187], v[116:119]
    v_exp_f32 v68, v68
    ds_read_b64_tr_b16 a[202:203], v53 offset:4096
    v_mfma_f32_16x16x32_bf16 v[120:123], a[136:139], v[200:203], v[120:123]
    v_exp_f32 v69, v69
    v_exp_f32 v70, v70
    v_exp_f32 v71, v71
    s_waitcnt lgkmcnt(15)
    v_mfma_f32_16x16x32_bf16 v[112:115], a[140:143], v[172:175], v[112:115]
    ds_read_b64_tr_b16 a[208:209], v54
    v_cvt_pk_bf16_f32 v228, v68, v69
    v_mfma_f32_16x16x32_bf16 v[116:119], a[140:143], v[188:191], v[116:119]
    v_cvt_pk_bf16_f32 v229, v70, v71
    ds_read_b64_tr_b16 a[210:211], v54 offset:4096
    v_exp_f32 v72, v72
    v_mfma_f32_16x16x32_bf16 v[120:123], a[140:143], v[204:207], v[120:123]
    v_exp_f32 v73, v73
    ds_read_b64_tr_b16 a[216:217], v55
    v_mfma_f32_16x16x32_bf16 v[124:127], a[144:147], v[160:163], v[32:35]
    v_exp_f32 v74, v74
    v_exp_f32 v75, v75
    ds_read_b64_tr_b16 a[218:219], v55 offset:4096
    v_mfma_f32_16x16x32_bf16 v[128:131], a[144:147], v[176:179], v[36:39]
    v_cvt_pk_bf16_f32 v232, v72, v73
    v_cvt_pk_bf16_f32 v233, v74, v75
    v_exp_f32 v76, v76
    v_mfma_f32_16x16x32_bf16 v[132:135], a[144:147], v[192:195], v[40:43]
    ds_read_b64_tr_b16 a[224:225], v56
    v_exp_f32 v77, v77
    s_waitcnt lgkmcnt(15)
    v_mfma_f32_16x16x32_bf16 v[124:127], a[148:151], v[164:167], v[124:127]
    v_exp_f32 v78, v78
    ds_read_b64_tr_b16 a[226:227], v56 offset:4096
    v_exp_f32 v79, v79
    v_mfma_f32_16x16x32_bf16 v[128:131], a[148:151], v[180:183], v[128:131]
    v_cvt_pk_bf16_f32 v226, v76, v77
    ds_read_b64_tr_b16 a[232:233], v57
    v_mfma_f32_16x16x32_bf16 v[132:135], a[148:151], v[196:199], v[132:135]
    v_cvt_pk_bf16_f32 v227, v78, v79
    v_exp_f32 v80, v80
    ds_read_b64_tr_b16 a[234:235], v57 offset:4096
    v_mfma_f32_16x16x32_bf16 v[124:127], a[152:155], v[168:171], v[124:127]
    v_exp_f32 v81, v81
    v_exp_f32 v82, v82
    v_exp_f32 v83, v83
    v_mfma_f32_16x16x32_bf16 v[128:131], a[152:155], v[184:187], v[128:131]
    ds_read_b64_tr_b16 a[240:241], v58
    v_cvt_pk_bf16_f32 v230, v80, v81
    v_mfma_f32_16x16x32_bf16 v[132:135], a[152:155], v[200:203], v[132:135]
    v_cvt_pk_bf16_f32 v231, v82, v83
    ds_read_b64_tr_b16 a[242:243], v58 offset:4096
    v_exp_f32 v84, v84
    v_mfma_f32_16x16x32_bf16 v[124:127], a[156:159], v[172:175], v[124:127]
    v_exp_f32 v85, v85
    ds_read_b64_tr_b16 a[248:249], v59
    v_mfma_f32_16x16x32_bf16 v[128:131], a[156:159], v[188:191], v[128:131]
    v_exp_f32 v86, v86
    v_exp_f32 v87, v87
    ds_read_b64_tr_b16 a[250:251], v59 offset:4096
    v_mfma_f32_16x16x32_bf16 v[132:135], a[156:159], v[204:207], v[132:135]
    v_cvt_pk_bf16_f32 v234, v84, v85
    v_cvt_pk_bf16_f32 v235, v86, v87
    s_waitcnt lgkmcnt(14)
    v_mfma_f32_16x16x32_bf16 a[0:3], a[192:195], v[224:227], a[0:3]
    v_exp_f32 v88, v88
    v_exp_f32 v89, v89
    v_mfma_f32_16x16x32_bf16 a[4:7], a[192:195], v[228:231], a[4:7]
    v_exp_f32 v90, v90
    v_mfma_f32_16x16x32_bf16 a[8:11], a[192:195], v[232:235], a[8:11]
    v_exp_f32 v91, v91
    s_waitcnt lgkmcnt(12)
    v_mfma_f32_16x16x32_bf16 a[12:15], a[200:203], v[224:227], a[12:15]
    v_cvt_pk_bf16_f32 v236, v88, v89
    v_cvt_pk_bf16_f32 v237, v90, v91
    v_mfma_f32_16x16x32_bf16 a[16:19], a[200:203], v[228:231], a[16:19]
    v_exp_f32 v92, v92
    v_mfma_f32_16x16x32_bf16 a[20:23], a[200:203], v[232:235], a[20:23]
    v_exp_f32 v93, v93
    s_waitcnt lgkmcnt(10)
    v_mfma_f32_16x16x32_bf16 a[24:27], a[208:211], v[224:227], a[24:27]
    v_exp_f32 v94, v94
    v_exp_f32 v95, v95
    v_mfma_f32_16x16x32_bf16 a[28:31], a[208:211], v[228:231], a[28:31]
    v_cvt_pk_bf16_f32 v240, v92, v93
    v_mfma_f32_16x16x32_bf16 a[32:35], a[208:211], v[232:235], a[32:35]
    v_cvt_pk_bf16_f32 v241, v94, v95
    s_waitcnt lgkmcnt(8)
    v_mfma_f32_16x16x32_bf16 a[36:39], a[216:219], v[224:227], a[36:39]
    v_exp_f32 v96, v96
    v_exp_f32 v97, v97
    v_mfma_f32_16x16x32_bf16 a[40:43], a[216:219], v[228:231], a[40:43]
    v_exp_f32 v98, v98
    v_mfma_f32_16x16x32_bf16 a[44:47], a[216:219], v[232:235], a[44:47]
    v_exp_f32 v99, v99
    s_waitcnt lgkmcnt(6)
    v_mfma_f32_16x16x32_bf16 a[48:51], a[224:227], v[224:227], a[48:51]
    v_cvt_pk_bf16_f32 v244, v96, v97
    v_cvt_pk_bf16_f32 v245, v98, v99
    v_mfma_f32_16x16x32_bf16 a[52:55], a[224:227], v[228:231], a[52:55]
    v_exp_f32 v100, v100
    v_mfma_f32_16x16x32_bf16 a[56:59], a[224:227], v[232:235], a[56:59]
    v_exp_f32 v101, v101
    s_waitcnt lgkmcnt(4)
    v_mfma_f32_16x16x32_bf16 a[60:63], a[232:235], v[224:227], a[60:63]
    v_exp_f32 v102, v102
    v_exp_f32 v103, v103
    v_mfma_f32_16x16x32_bf16 a[64:67], a[232:235], v[228:231], a[64:67]
    v_cvt_pk_bf16_f32 v238, v100, v101
    v_mfma_f32_16x16x32_bf16 a[68:71], a[232:235], v[232:235], a[68:71]
    v_cvt_pk_bf16_f32 v239, v102, v103
    s_waitcnt lgkmcnt(2)
    v_mfma_f32_16x16x32_bf16 a[72:75], a[240:243], v[224:227], a[72:75]
    v_exp_f32 v104, v104
    v_exp_f32 v105, v105
    v_mfma_f32_16x16x32_bf16 a[76:79], a[240:243], v[228:231], a[76:79]
    v_exp_f32 v106, v106
    v_mfma_f32_16x16x32_bf16 a[80:83], a[240:243], v[232:235], a[80:83]
    v_exp_f32 v107, v107
    s_waitcnt lgkmcnt(0)
    v_mfma_f32_16x16x32_bf16 a[84:87], a[248:251], v[224:227], a[84:87]
    v_cvt_pk_bf16_f32 v242, v104, v105
    v_cvt_pk_bf16_f32 v243, v106, v107
    v_mfma_f32_16x16x32_bf16 a[88:91], a[248:251], v[228:231], a[88:91]
    v_exp_f32 v108, v108
    v_mfma_f32_16x16x32_bf16 a[92:95], a[248:251], v[232:235], a[92:95]
    v_exp_f32 v109, v109
    v_mfma_f32_16x16x32_bf16 a[96:99], v[44:47], v[224:227], a[96:99]
    v_exp_f32 v110, v110
    v_exp_f32 v111, v111
    v_mfma_f32_16x16x32_bf16 a[100:103], v[44:47], v[228:231], a[100:103]
    v_cvt_pk_bf16_f32 v246, v108, v109
    v_mfma_f32_16x16x32_bf16 a[104:107], v[44:47], v[232:235], a[104:107]
    v_cvt_pk_bf16_f32 v247, v110, v111
    v_mfma_f32_16x16x32_bf16 v[136:139], a[160:163], v[160:163], v[32:35]
    ds_read_b64_tr_b16 a[196:197], v52 offset:8192
    v_max3_f32 v60, v112, v113, v114
    v_mfma_f32_16x16x32_bf16 v[140:143], a[160:163], v[176:179], v[36:39]
    ds_read_b64_tr_b16 a[198:199], v52 offset:12288
    v_mfma_f32_16x16x32_bf16 v[144:147], a[160:163], v[192:195], v[40:43]
    v_max3_f32 v60, v60, v115, v116
    v_mfma_f32_16x16x32_bf16 v[136:139], a[164:167], v[164:167], v[136:139]
    ds_read_b64_tr_b16 a[204:205], v53 offset:8192
    v_mfma_f32_16x16x32_bf16 v[140:143], a[164:167], v[180:183], v[140:143]
    v_max3_f32 v60, v60, v117, v118
    v_mfma_f32_16x16x32_bf16 v[144:147], a[164:167], v[196:199], v[144:147]
    ds_read_b64_tr_b16 a[206:207], v53 offset:12288
    v_mfma_f32_16x16x32_bf16 v[136:139], a[168:171], v[168:171], v[136:139]
    ds_read_b64_tr_b16 a[212:213], v54 offset:8192
    v_mfma_f32_16x16x32_bf16 v[140:143], a[168:171], v[184:187], v[140:143]
    v_max3_f32 v60, v60, v119, v120
    v_mfma_f32_16x16x32_bf16 v[144:147], a[168:171], v[200:203], v[144:147]
    ds_read_b64_tr_b16 a[214:215], v54 offset:12288
    v_max3_f32 v60, v60, v121, v122
    v_mfma_f32_16x16x32_bf16 v[136:139], a[172:175], v[172:175], v[136:139]
    ds_read_b64_tr_b16 a[220:221], v55 offset:8192
    v_mfma_f32_16x16x32_bf16 v[140:143], a[172:175], v[188:191], v[140:143]
    ds_read_b64_tr_b16 a[222:223], v55 offset:12288
    v_mfma_f32_16x16x32_bf16 v[144:147], a[172:175], v[204:207], v[144:147]
    v_max3_f32 v60, v60, v123, v124
    v_mfma_f32_16x16x32_bf16 v[148:151], a[176:179], v[160:163], v[32:35]
    ds_read_b64_tr_b16 a[228:229], v56 offset:8192
    v_mfma_f32_16x16x32_bf16 v[152:155], a[176:179], v[176:179], v[36:39]
    v_max3_f32 v60, v60, v125, v126
    v_mfma_f32_16x16x32_bf16 v[156:159], a[176:179], v[192:195], v[40:43]
    ds_read_b64_tr_b16 a[230:231], v56 offset:12288
    v_mfma_f32_16x16x32_bf16 v[148:151], a[180:183], v[164:167], v[148:151]
    ds_read_b64_tr_b16 a[236:237], v57 offset:8192
    v_mfma_f32_16x16x32_bf16 v[152:155], a[180:183], v[180:183], v[152:155]
    v_max3_f32 v60, v60, v127, v128
    ds_read_b64_tr_b16 a[238:239], v57 offset:12288
    v_mfma_f32_16x16x32_bf16 v[156:159], a[180:183], v[196:199], v[156:159]
    v_max3_f32 v60, v60, v129, v130
    v_mfma_f32_16x16x32_bf16 v[148:151], a[184:187], v[168:171], v[148:151]
    ds_read_b64_tr_b16 a[244:245], v58 offset:8192
    v_mfma_f32_16x16x32_bf16 v[152:155], a[184:187], v[184:187], v[152:155]
    ds_read_b64_tr_b16 a[246:247], v58 offset:12288
    v_mfma_f32_16x16x32_bf16 v[156:159], a[184:187], v[200:203], v[156:159]
    v_max3_f32 v60, v60, v131, v132
    v_mfma_f32_16x16x32_bf16 v[148:151], a[188:191], v[172:175], v[148:151]
    ds_read_b64_tr_b16 a[252:253], v59 offset:8192
    v_mfma_f32_16x16x32_bf16 v[152:155], a[188:191], v[188:191], v[152:155]
    v_max3_f32 v60, v60, v133, v134
    v_mfma_f32_16x16x32_bf16 v[156:159], a[188:191], v[204:207], v[156:159]
    ds_read_b64_tr_b16 a[254:255], v59 offset:12288
    s_lshl_b32 s79, s70, 19
    s_lshl_b32 s80, s73, 8
    s_add_u32 s88, s79, s80
    s_add_u32 s89, s71, 0
    s_and_b32 s89, s89, 15
    s_lshl_b32 s89, s89, 15
    s_add_u32 s77, s88, s89
    buffer_load_dwordx4 v[160:163], v30, s[60:63], s77 offen
    buffer_load_dwordx4 v[164:167], v30, s[60:63], s77 offen offset:1024
    buffer_load_dwordx4 v[168:171], v30, s[60:63], s77 offen offset:2048
    buffer_load_dwordx4 v[172:175], v30, s[60:63], s77 offen offset:3072
    buffer_load_dwordx4 v[176:179], v31, s[60:63], s77 offen
    buffer_load_dwordx4 v[180:183], v31, s[60:63], s77 offen offset:1024
    buffer_load_dwordx4 v[184:187], v31, s[60:63], s77 offen offset:2048
    buffer_load_dwordx4 v[188:191], v31, s[60:63], s77 offen offset:3072
    s_add_u32 s89, s71, 1
    s_and_b32 s89, s89, 15
    s_lshl_b32 s89, s89, 15
    s_add_u32 s77, s88, s89
    buffer_load_dwordx4 v[192:195], v30, s[60:63], s77 offen
    buffer_load_dwordx4 v[196:199], v30, s[60:63], s77 offen offset:1024
    buffer_load_dwordx4 v[200:203], v30, s[60:63], s77 offen offset:2048
    buffer_load_dwordx4 v[204:207], v30, s[60:63], s77 offen offset:3072
    buffer_load_dwordx4 v[208:211], v31, s[60:63], s77 offen
    buffer_load_dwordx4 v[212:215], v31, s[60:63], s77 offen offset:1024
    buffer_load_dwordx4 v[216:219], v31, s[60:63], s77 offen offset:2048
    buffer_load_dwordx4 v[220:223], v31, s[60:63], s77 offen offset:3072
    s_waitcnt lgkmcnt(14)
    v_mfma_f32_16x16x32_bf16 a[0:3], a[196:199], v[236:239], a[0:3]
    v_mfma_f32_16x16x32_bf16 a[4:7], a[196:199], v[240:243], a[4:7]
    v_mfma_f32_16x16x32_bf16 a[8:11], a[196:199], v[244:247], a[8:11]
    s_waitcnt lgkmcnt(12)
    v_mfma_f32_16x16x32_bf16 a[12:15], a[204:207], v[236:239], a[12:15]
    v_mfma_f32_16x16x32_bf16 a[16:19], a[204:207], v[240:243], a[16:19]
    v_mfma_f32_16x16x32_bf16 a[20:23], a[204:207], v[244:247], a[20:23]
    s_waitcnt lgkmcnt(10)
    v_mfma_f32_16x16x32_bf16 a[24:27], a[212:215], v[236:239], a[24:27]
    v_max3_f32 v60, v60, v135, v136
    v_mfma_f32_16x16x32_bf16 a[28:31], a[212:215], v[240:243], a[28:31]
    v_max3_f32 v60, v60, v137, v138
    v_mfma_f32_16x16x32_bf16 a[32:35], a[212:215], v[244:247], a[32:35]
    s_waitcnt lgkmcnt(8)
    v_mfma_f32_16x16x32_bf16 a[36:39], a[220:223], v[236:239], a[36:39]
    v_max3_f32 v60, v60, v139, v140
    v_mfma_f32_16x16x32_bf16 a[40:43], a[220:223], v[240:243], a[40:43]
    v_max3_f32 v60, v60, v141, v142
    v_mfma_f32_16x16x32_bf16 a[44:47], a[220:223], v[244:247], a[44:47]
    s_waitcnt lgkmcnt(6)
    v_mfma_f32_16x16x32_bf16 a[48:51], a[228:231], v[236:239], a[48:51]
    v_max3_f32 v60, v60, v143, v144
    v_mfma_f32_16x16x32_bf16 a[52:55], a[228:231], v[240:243], a[52:55]
    v_mfma_f32_16x16x32_bf16 a[56:59], a[228:231], v[244:247], a[56:59]
    v_max3_f32 v60, v60, v145, v146
    s_waitcnt lgkmcnt(4)
    v_mfma_f32_16x16x32_bf16 a[60:63], a[236:239], v[236:239], a[60:63]
    v_max3_f32 v60, v60, v147, v148
    v_mfma_f32_16x16x32_bf16 a[64:67], a[236:239], v[240:243], a[64:67]
    v_mfma_f32_16x16x32_bf16 a[68:71], a[236:239], v[244:247], a[68:71]
    v_max3_f32 v60, v60, v149, v150
    s_waitcnt lgkmcnt(2)
    v_mfma_f32_16x16x32_bf16 a[72:75], a[244:247], v[236:239], a[72:75]
    v_max3_f32 v60, v60, v151, v152
    v_mfma_f32_16x16x32_bf16 a[76:79], a[244:247], v[240:243], a[76:79]
    v_mfma_f32_16x16x32_bf16 a[80:83], a[244:247], v[244:247], a[80:83]
    v_max3_f32 v60, v60, v153, v154
    s_waitcnt lgkmcnt(0)
    v_mfma_f32_16x16x32_bf16 a[84:87], a[252:255], v[236:239], a[84:87]
    v_mfma_f32_16x16x32_bf16 a[88:91], a[252:255], v[240:243], a[88:91]
    v_max3_f32 v60, v60, v155, v156
    v_mfma_f32_16x16x32_bf16 a[92:95], a[252:255], v[244:247], a[92:95]
    v_max3_f32 v60, v60, v157, v158
    v_mfma_f32_16x16x32_bf16 a[96:99], v[44:47], v[236:239], a[96:99]
    v_mfma_f32_16x16x32_bf16 a[100:103], v[44:47], v[240:243], a[100:103]
    v_max_f32 v60, v60, v159
    v_mfma_f32_16x16x32_bf16 a[104:107], v[44:47], v[244:247], a[104:107]
    v_cmp_lt_f32 vcc, s87, v60
    s_nop 3
    s_cbranch_vccnz L_slow6
L_back6:
    v_add_u32 v52, 0x14000, v22
    v_add_u32 v53, 0x14000, v23
    v_add_u32 v54, 0x14000, v24
    v_add_u32 v55, 0x14000, v25
    v_add_u32 v56, 0x14000, v26
    v_add_u32 v57, 0x14000, v27
    v_add_u32 v58, 0x14000, v28
    v_add_u32 v59, 0x14000, v29
    s_waitcnt vmcnt(16)
    s_waitcnt lgkmcnt(0)
    s_barrier
    v_exp_f32 v112, v112
    ds_read_b64_tr_b16 a[192:193], v52
    v_exp_f32 v113, v113
    v_exp_f32 v114, v114
    ds_read_b64_tr_b16 a[194:195], v52 offset:4096
    v_exp_f32 v115, v115
    v_cvt_pk_bf16_f32 v224, v112, v113
    ds_read_b64_tr_b16 a[200:201], v53
    v_cvt_pk_bf16_f32 v225, v114, v115
    v_exp_f32 v116, v116
    ds_read_b64_tr_b16 a[202:203], v53 offset:4096
    v_exp_f32 v117, v117
    v_exp_f32 v118, v118
    v_exp_f32 v119, v119
    ds_read_b64_tr_b16 a[208:209], v54
    v_cvt_pk_bf16_f32 v228, v116, v117
    v_cvt_pk_bf16_f32 v229, v118, v119
    ds_read_b64_tr_b16 a[210:211], v54 offset:4096
    v_exp_f32 v120, v120
    v_exp_f32 v121, v121
    ds_read_b64_tr_b16 a[216:217], v55
    v_exp_f32 v122, v122
    v_exp_f32 v123, v123
    ds_read_b64_tr_b16 a[218:219], v55 offset:4096
    v_cvt_pk_bf16_f32 v232, v120, v121
    v_cvt_pk_bf16_f32 v233, v122, v123
    v_exp_f32 v124, v124
    ds_read_b64_tr_b16 a[224:225], v56
    v_exp_f32 v125, v125
    v_exp_f32 v126, v126
    ds_read_b64_tr_b16 a[226:227], v56 offset:4096
    v_exp_f32 v127, v127
    v_cvt_pk_bf16_f32 v226, v124, v125
    ds_read_b64_tr_b16 a[232:233], v57
    v_cvt_pk_bf16_f32 v227, v126, v127
    v_exp_f32 v128, v128
    ds_read_b64_tr_b16 a[234:235], v57 offset:4096
    v_exp_f32 v129, v129
    v_exp_f32 v130, v130
    v_exp_f32 v131, v131
    ds_read_b64_tr_b16 a[240:241], v58
    v_cvt_pk_bf16_f32 v230, v128, v129
    v_cvt_pk_bf16_f32 v231, v130, v131
    ds_read_b64_tr_b16 a[242:243], v58 offset:4096
    v_exp_f32 v132, v132
    v_exp_f32 v133, v133
    ds_read_b64_tr_b16 a[248:249], v59
    v_exp_f32 v134, v134
    v_exp_f32 v135, v135
    ds_read_b64_tr_b16 a[250:251], v59 offset:4096
    v_cvt_pk_bf16_f32 v234, v132, v133
    v_cvt_pk_bf16_f32 v235, v134, v135
    s_waitcnt lgkmcnt(14)
    v_mfma_f32_16x16x32_bf16 a[0:3], a[192:195], v[224:227], a[0:3]
    v_exp_f32 v136, v136
    ds_read_b64_tr_b16 a[196:197], v52 offset:8192
    v_mfma_f32_16x16x32_bf16 a[4:7], a[192:195], v[228:231], a[4:7]
    v_exp_f32 v137, v137
    v_exp_f32 v138, v138
    v_mfma_f32_16x16x32_bf16 a[8:11], a[192:195], v[232:235], a[8:11]
    ds_read_b64_tr_b16 a[198:199], v52 offset:12288
    v_exp_f32 v139, v139
    s_waitcnt lgkmcnt(14)
    v_mfma_f32_16x16x32_bf16 a[12:15], a[200:203], v[224:227], a[12:15]
    v_cvt_pk_bf16_f32 v236, v136, v137
    ds_read_b64_tr_b16 a[204:205], v53 offset:8192
    v_mfma_f32_16x16x32_bf16 a[16:19], a[200:203], v[228:231], a[16:19]
    v_cvt_pk_bf16_f32 v237, v138, v139
    v_exp_f32 v140, v140
    v_mfma_f32_16x16x32_bf16 a[20:23], a[200:203], v[232:235], a[20:23]
    ds_read_b64_tr_b16 a[206:207], v53 offset:12288
    v_exp_f32 v141, v141
    s_waitcnt lgkmcnt(14)
    v_mfma_f32_16x16x32_bf16 a[24:27], a[208:211], v[224:227], a[24:27]
    v_exp_f32 v142, v142
    v_exp_f32 v143, v143
    v_mfma_f32_16x16x32_bf16 a[28:31], a[208:211], v[228:231], a[28:31]
    ds_read_b64_tr_b16 a[212:213], v54 offset:8192
    v_cvt_pk_bf16_f32 v240, v140, v141
    v_mfma_f32_16x16x32_bf16 a[32:35], a[208:211], v[232:235], a[32:35]
    v_cvt_pk_bf16_f32 v241, v142, v143
    ds_read_b64_tr_b16 a[214:215], v54 offset:12288
    s_waitcnt lgkmcnt(14)
    v_mfma_f32_16x16x32_bf16 a[36:39], a[216:219], v[224:227], a[36:39]
    v_exp_f32 v144, v144
    v_exp_f32 v145, v145
    v_mfma_f32_16x16x32_bf16 a[40:43], a[216:219], v[228:231], a[40:43]
    ds_read_b64_tr_b16 a[220:221], v55 offset:8192
    v_exp_f32 v146, v146
    v_mfma_f32_16x16x32_bf16 a[44:47], a[216:219], v[232:235], a[44:47]
    v_exp_f32 v147, v147
    ds_read_b64_tr_b16 a[222:223], v55 offset:12288
    s_waitcnt lgkmcnt(14)
    v_mfma_f32_16x16x32_bf16 a[48:51], a[224:227], v[224:227], a[48:51]
    v_cvt_pk_bf16_f32 v244, v144, v145
    v_cvt_pk_bf16_f32 v245, v146, v147
    v_mfma_f32_16x16x32_bf16 a[52:55], a[224:227], v[228:231], a[52:55]
    v_exp_f32 v148, v148
    v_mfma_f32_16x16x32_bf16 a[56:59], a[224:227], v[232:235], a[56:59]
    ds_read_b64_tr_b16 a[228:229], v56 offset:8192
    v_exp_f32 v149, v149
    s_waitcnt lgkmcnt(13)
    v_mfma_f32_16x16x32_bf16 a[60:63], a[232:235], v[224:227], a[60:63]
    v_exp_f32 v150, v150
    ds_read_b64_tr_b16 a[230:231], v56 offset:12288
    v_mfma_f32_16x16x32_bf16 a[64:67], a[232:235], v[228:231], a[64:67]
    v_exp_f32 v151, v151
    v_cvt_pk_bf16_f32 v238, v148, v149
    v_mfma_f32_16x16x32_bf16 a[68:71], a[232:235], v[232:235], a[68:71]
    ds_read_b64_tr_b16 a[236:237], v57 offset:8192
    v_cvt_pk_bf16_f32 v239, v150, v151
    s_waitcnt lgkmcnt(13)
    v_mfma_f32_16x16x32_bf16 a[72:75], a[240:243], v[224:227], a[72:75]
    v_exp_f32 v152, v152
    ds_read_b64_tr_b16 a[238:239], v57 offset:12288
    v_mfma_f32_16x16x32_bf16 a[76:79], a[240:243], v[228:231], a[76:79]
    v_exp_f32 v153, v153
    v_exp_f32 v154, v154
    v_mfma_f32_16x16x32_bf16 a[80:83], a[240:243], v[232:235], a[80:83]
    v_exp_f32 v155, v155
    ds_read_b64_tr_b16 a[244:245], v58 offset:8192
    s_waitcnt lgkmcnt(13)
    v_mfma_f32_16x16x32_bf16 a[84:87], a[248:251], v[224:227], a[84:87]
    v_cvt_pk_bf16_f32 v242, v152, v153
    v_cvt_pk_bf16_f32 v243, v154, v155
    v_mfma_f32_16x16x32_bf16 a[88:91], a[248:251], v[228:231], a[88:91]
    ds_read_b64_tr_b16 a[246:247], v58 offset:12288
    v_exp_f32 v156, v156
    v_mfma_f32_16x16x32_bf16 a[92:95], a[248:251], v[232:235], a[92:95]
    v_exp_f32 v157, v157
    ds_read_b64_tr_b16 a[252:253], v59 offset:8192
    v_mfma_f32_16x16x32_bf16 a[96:99], v[44:47], v[224:227], a[96:99]
    v_exp_f32 v158, v158
    v_exp_f32 v159, v159
    v_mfma_f32_16x16x32_bf16 a[100:103], v[44:47], v[228:231], a[100:103]
    ds_read_b64_tr_b16 a[254:255], v59 offset:12288
    v_cvt_pk_bf16_f32 v246, v156, v157
    v_mfma_f32_16x16x32_bf16 a[104:107], v[44:47], v[232:235], a[104:107]
    v_cvt_pk_bf16_f32 v247, v158, v159
    s_waitcnt lgkmcnt(14)
    v_mfma_f32_16x16x32_bf16 a[0:3], a[196:199], v[236:239], a[0:3]
    v_mfma_f32_16x16x32_bf16 a[4:7], a[196:199], v[240:243], a[4:7]
    v_mfma_f32_16x16x32_bf16 a[8:11], a[196:199], v[244:247], a[8:11]
    s_waitcnt lgkmcnt(12)
    v_mfma_f32_16x16x32_bf16 a[12:15], a[204:207], v[236:239], a[12:15]
    v_mfma_f32_16x16x32_bf16 a[16:19], a[204:207], v[240:243], a[16:19]
    v_mfma_f32_16x16x32_bf16 a[20:23], a[204:207], v[244:247], a[20:23]
    s_waitcnt lgkmcnt(10)
    v_mfma_f32_16x16x32_bf16 a[24:27], a[212:215], v[236:239], a[24:27]
    v_mfma_f32_16x16x32_bf16 a[28:31], a[212:215], v[240:243], a[28:31]
    v_mfma_f32_16x16x32_bf16 a[32:35], a[212:215], v[244:247], a[32:35]
    s_waitcnt lgkmcnt(8)
    v_mfma_f32_16x16x32_bf16 a[36:39], a[220:223], v[236:239], a[36:39]
    v_mfma_f32_16x16x32_bf16 a[40:43], a[220:223], v[240:243], a[40:43]
    v_mfma_f32_16x16x32_bf16 a[44:47], a[220:223], v[244:247], a[44:47]
    s_waitcnt lgkmcnt(6)
    v_mfma_f32_16x16x32_bf16 a[48:51], a[228:231], v[236:239], a[48:51]
    v_mfma_f32_16x16x32_bf16 a[52:55], a[228:231], v[240:243], a[52:55]
    v_mfma_f32_16x16x32_bf16 a[56:59], a[228:231], v[244:247], a[56:59]
    s_waitcnt lgkmcnt(4)
    v_mfma_f32_16x16x32_bf16 a[60:63], a[236:239], v[236:239], a[60:63]
    v_mfma_f32_16x16x32_bf16 a[64:67], a[236:239], v[240:243], a[64:67]
    v_mfma_f32_16x16x32_bf16 a[68:71], a[236:239], v[244:247], a[68:71]
    s_waitcnt lgkmcnt(2)
    v_mfma_f32_16x16x32_bf16 a[72:75], a[244:247], v[236:239], a[72:75]
    v_mfma_f32_16x16x32_bf16 a[76:79], a[244:247], v[240:243], a[76:79]
    v_mfma_f32_16x16x32_bf16 a[80:83], a[244:247], v[244:247], a[80:83]
    s_waitcnt lgkmcnt(0)
    v_mfma_f32_16x16x32_bf16 a[84:87], a[252:255], v[236:239], a[84:87]
    v_mfma_f32_16x16x32_bf16 a[88:91], a[252:255], v[240:243], a[88:91]
    v_mfma_f32_16x16x32_bf16 a[92:95], a[252:255], v[244:247], a[92:95]
    v_mfma_f32_16x16x32_bf16 a[96:99], v[44:47], v[236:239], a[96:99]
    v_mfma_f32_16x16x32_bf16 a[100:103], v[44:47], v[240:243], a[100:103]
    v_mfma_f32_16x16x32_bf16 a[104:107], v[44:47], v[244:247], a[104:107]
    s_add_u32 s89, s71, 2
    s_and_b32 s89, s89, 15
    s_lshl_b32 s89, s89, 15
    s_add_u32 s77, s88, s89
    buffer_load_dwordx4 v[224:227], v30, s[60:63], s77 offen
    buffer_load_dwordx4 v[228:231], v30, s[60:63], s77 offen offset:1024
    buffer_load_dwordx4 v[232:235], v30, s[60:63], s77 offen offset:2048
    buffer_load_dwordx4 v[236:239], v30, s[60:63], s77 offen offset:3072
    buffer_load_dwordx4 v[240:243], v31, s[60:63], s77 offen
    buffer_load_dwordx4 v[244:247], v31, s[60:63], s77 offen offset:1024
    buffer_load_dwordx4 v[248:251], v31, s[60:63], s77 offen offset:2048
    buffer_load_dwordx4 v[252:255], v31, s[60:63], s77 offen offset:3072
    s_add_u32 s89, s71, 3
    s_and_b32 s89, s89, 15
    s_lshl_b32 s89, s89, 15
    s_add_u32 s77, s88, s89
    buffer_load_dwordx4 v[64:67], v30, s[60:63], s77 offen
    buffer_load_dwordx4 v[68:71], v30, s[60:63], s77 offen offset:1024
    buffer_load_dwordx4 v[72:75], v30, s[60:63], s77 offen offset:2048
    buffer_load_dwordx4 v[76:79], v30, s[60:63], s77 offen offset:3072
    buffer_load_dwordx4 v[80:83], v31, s[60:63], s77 offen
    buffer_load_dwordx4 v[84:87], v31, s[60:63], s77 offen offset:1024
    buffer_load_dwordx4 v[88:91], v31, s[60:63], s77 offen offset:2048
    buffer_load_dwordx4 v[92:95], v31, s[60:63], s77 offen offset:3072
    s_add_u32 s89, s71, 4
    s_and_b32 s89, s89, 15
    s_lshl_b32 s89, s89, 15
    s_add_u32 s77, s88, s89
    buffer_load_dwordx4 v[96:99], v30, s[60:63], s77 offen
    buffer_load_dwordx4 v[100:103], v30, s[60:63], s77 offen offset:1024
    buffer_load_dwordx4 v[104:107], v30, s[60:63], s77 offen offset:2048
    buffer_load_dwordx4 v[108:111], v30, s[60:63], s77 offen offset:3072
    buffer_load_dwordx4 v[112:115], v31, s[60:63], s77 offen
    buffer_load_dwordx4 v[116:119], v31, s[60:63], s77 offen offset:1024
    buffer_load_dwordx4 v[120:123], v31, s[60:63], s77 offen offset:2048
    buffer_load_dwordx4 v[124:127], v31, s[60:63], s77 offen offset:3072
    v_lshrrev_b32 v35, 1, v2
    v_and_b32 v36, 1, v2
    v_lshlrev_b32 v36, 3, v36
    v_add_u32 v36, v36, v5
    s_lshl_b32 s79, s73, 8
    v_add_u32 v36, s79, v36
    v_add_u32 v37, 0, v35
    v_xor_b32 v37, v37, v4
    v_lshl_add_u32 v48, v37, 4, v36
    v_add_u32 v37, 2, v35
    v_xor_b32 v37, v37, v4
    v_lshl_add_u32 v49, v37, 4, v36
    v_add_u32 v37, 4, v35
    v_xor_b32 v37, v37, v4
    v_lshl_add_u32 v50, v37, 4, v36
    v_add_u32 v37, 6, v35
    v_xor_b32 v37, v37, v4
    v_lshl_add_u32 v51, v37, 4, v36
    v_add_u32 v37, 8, v35
    v_xor_b32 v37, v37, v4
    v_lshl_add_u32 v52, v37, 4, v36
    v_add_u32 v37, 10, v35
    v_xor_b32 v37, v37, v4
    v_lshl_add_u32 v53, v37, 4, v36
    v_add_u32 v37, 12, v35
    v_xor_b32 v37, v37, v4
    v_lshl_add_u32 v54, v37, 4, v36
    v_add_u32 v37, 14, v35
    v_xor_b32 v37, v37, v4
    v_lshl_add_u32 v55, v37, 4, v36
    v_accvgpr_read_b32 v38, a96
    v_rcp_f32 v38, v38
    v_accvgpr_read_b32 v128, a0
    v_mul_f32 v128, v128, v38
    v_accvgpr_read_b32 v129, a1
    v_mul_f32 v129, v129, v38
    v_accvgpr_read_b32 v130, a2
    v_mul_f32 v130, v130, v38
    v_accvgpr_read_b32 v131, a3
    v_mul_f32 v131, v131, v38
    v_cvt_pk_bf16_f32 v132, v128, v129
    v_cvt_pk_bf16_f32 v133, v130, v131
    ds_write_b64 v48, v[132:133]
    v_accvgpr_read_b32 v134, a12
    v_mul_f32 v134, v134, v38
    v_accvgpr_read_b32 v135, a13
    v_mul_f32 v135, v135, v38
    v_accvgpr_read_b32 v136, a14
    v_mul_f32 v136, v136, v38
    v_accvgpr_read_b32 v137, a15
    v_mul_f32 v137, v137, v38
    v_cvt_pk_bf16_f32 v138, v134, v135
    v_cvt_pk_bf16_f32 v139, v136, v137
    ds_write_b64 v49, v[138:139]
    v_accvgpr_read_b32 v140, a24
    v_mul_f32 v140, v140, v38
    v_accvgpr_read_b32 v141, a25
    v_mul_f32 v141, v141, v38
    v_accvgpr_read_b32 v142, a26
    v_mul_f32 v142, v142, v38
    v_accvgpr_read_b32 v143, a27
    v_mul_f32 v143, v143, v38
    v_cvt_pk_bf16_f32 v144, v140, v141
    v_cvt_pk_bf16_f32 v145, v142, v143
    ds_write_b64 v50, v[144:145]
    v_accvgpr_read_b32 v146, a36
    v_mul_f32 v146, v146, v38
    v_accvgpr_read_b32 v147, a37
    v_mul_f32 v147, v147, v38
    v_accvgpr_read_b32 v148, a38
    v_mul_f32 v148, v148, v38
    v_accvgpr_read_b32 v149, a39
    v_mul_f32 v149, v149, v38
    v_cvt_pk_bf16_f32 v150, v146, v147
    v_cvt_pk_bf16_f32 v151, v148, v149
    ds_write_b64 v51, v[150:151]
    v_accvgpr_read_b32 v152, a48
    v_mul_f32 v152, v152, v38
    v_accvgpr_read_b32 v153, a49
    v_mul_f32 v153, v153, v38
    v_accvgpr_read_b32 v154, a50
    v_mul_f32 v154, v154, v38
    v_accvgpr_read_b32 v155, a51
    v_mul_f32 v155, v155, v38
    v_cvt_pk_bf16_f32 v156, v152, v153
    v_cvt_pk_bf16_f32 v157, v154, v155
    ds_write_b64 v52, v[156:157]
    v_accvgpr_read_b32 v128, a60
    v_mul_f32 v128, v128, v38
    v_accvgpr_read_b32 v129, a61
    v_mul_f32 v129, v129, v38
    v_accvgpr_read_b32 v130, a62
    v_mul_f32 v130, v130, v38
    v_accvgpr_read_b32 v131, a63
    v_mul_f32 v131, v131, v38
    v_cvt_pk_bf16_f32 v132, v128, v129
    v_cvt_pk_bf16_f32 v133, v130, v131
    ds_write_b64 v53, v[132:133]
    v_accvgpr_read_b32 v134, a72
    v_mul_f32 v134, v134, v38
    v_accvgpr_read_b32 v135, a73
    v_mul_f32 v135, v135, v38
    v_accvgpr_read_b32 v136, a74
    v_mul_f32 v136, v136, v38
    v_accvgpr_read_b32 v137, a75
    v_mul_f32 v137, v137, v38
    v_cvt_pk_bf16_f32 v138, v134, v135
    v_cvt_pk_bf16_f32 v139, v136, v137
    ds_write_b64 v54, v[138:139]
    v_accvgpr_read_b32 v140, a84
    v_mul_f32 v140, v140, v38
    v_accvgpr_read_b32 v141, a85
    v_mul_f32 v141, v141, v38
    v_accvgpr_read_b32 v142, a86
    v_mul_f32 v142, v142, v38
    v_accvgpr_read_b32 v143, a87
    v_mul_f32 v143, v143, v38
    v_cvt_pk_bf16_f32 v144, v140, v141
    v_cvt_pk_bf16_f32 v145, v142, v143
    ds_write_b64 v55, v[144:145]
    v_accvgpr_read_b32 v38, a100
    v_rcp_f32 v38, v38
    v_accvgpr_read_b32 v146, a4
    v_mul_f32 v146, v146, v38
    v_accvgpr_read_b32 v147, a5
    v_mul_f32 v147, v147, v38
    v_accvgpr_read_b32 v148, a6
    v_mul_f32 v148, v148, v38
    v_accvgpr_read_b32 v149, a7
    v_mul_f32 v149, v149, v38
    v_cvt_pk_bf16_f32 v150, v146, v147
    v_cvt_pk_bf16_f32 v151, v148, v149
    ds_write_b64 v48, v[150:151] offset:16384
    v_accvgpr_read_b32 v152, a16
    v_mul_f32 v152, v152, v38
    v_accvgpr_read_b32 v153, a17
    v_mul_f32 v153, v153, v38
    v_accvgpr_read_b32 v154, a18
    v_mul_f32 v154, v154, v38
    v_accvgpr_read_b32 v155, a19
    v_mul_f32 v155, v155, v38
    v_cvt_pk_bf16_f32 v156, v152, v153
    v_cvt_pk_bf16_f32 v157, v154, v155
    ds_write_b64 v49, v[156:157] offset:16384
    v_accvgpr_read_b32 v128, a28
    v_mul_f32 v128, v128, v38
    v_accvgpr_read_b32 v129, a29
    v_mul_f32 v129, v129, v38
    v_accvgpr_read_b32 v130, a30
    v_mul_f32 v130, v130, v38
    v_accvgpr_read_b32 v131, a31
    v_mul_f32 v131, v131, v38
    v_cvt_pk_bf16_f32 v132, v128, v129
    v_cvt_pk_bf16_f32 v133, v130, v131
    ds_write_b64 v50, v[132:133] offset:16384
    v_accvgpr_read_b32 v134, a40
    v_mul_f32 v134, v134, v38
    v_accvgpr_read_b32 v135, a41
    v_mul_f32 v135, v135, v38
    v_accvgpr_read_b32 v136, a42
    v_mul_f32 v136, v136, v38
    v_accvgpr_read_b32 v137, a43
    v_mul_f32 v137, v137, v38
    v_cvt_pk_bf16_f32 v138, v134, v135
    v_cvt_pk_bf16_f32 v139, v136, v137
    ds_write_b64 v51, v[138:139] offset:16384
    v_accvgpr_read_b32 v140, a52
    v_mul_f32 v140, v140, v38
    v_accvgpr_read_b32 v141, a53
    v_mul_f32 v141, v141, v38
    v_accvgpr_read_b32 v142, a54
    v_mul_f32 v142, v142, v38
    v_accvgpr_read_b32 v143, a55
    v_mul_f32 v143, v143, v38
    v_cvt_pk_bf16_f32 v144, v140, v141
    v_cvt_pk_bf16_f32 v145, v142, v143
    ds_write_b64 v52, v[144:145] offset:16384
    v_accvgpr_read_b32 v146, a64
    v_mul_f32 v146, v146, v38
    v_accvgpr_read_b32 v147, a65
    v_mul_f32 v147, v147, v38
    v_accvgpr_read_b32 v148, a66
    v_mul_f32 v148, v148, v38
    v_accvgpr_read_b32 v149, a67
    v_mul_f32 v149, v149, v38
    v_cvt_pk_bf16_f32 v150, v146, v147
    v_cvt_pk_bf16_f32 v151, v148, v149
    ds_write_b64 v53, v[150:151] offset:16384
    v_accvgpr_read_b32 v152, a76
    v_mul_f32 v152, v152, v38
    v_accvgpr_read_b32 v153, a77
    v_mul_f32 v153, v153, v38
    v_accvgpr_read_b32 v154, a78
    v_mul_f32 v154, v154, v38
    v_accvgpr_read_b32 v155, a79
    v_mul_f32 v155, v155, v38
    v_cvt_pk_bf16_f32 v156, v152, v153
    v_cvt_pk_bf16_f32 v157, v154, v155
    ds_write_b64 v54, v[156:157] offset:16384
    v_accvgpr_read_b32 v128, a88
    v_mul_f32 v128, v128, v38
    v_accvgpr_read_b32 v129, a89
    v_mul_f32 v129, v129, v38
    v_accvgpr_read_b32 v130, a90
    v_mul_f32 v130, v130, v38
    v_accvgpr_read_b32 v131, a91
    v_mul_f32 v131, v131, v38
    v_cvt_pk_bf16_f32 v132, v128, v129
    v_cvt_pk_bf16_f32 v133, v130, v131
    ds_write_b64 v55, v[132:133] offset:16384
    v_accvgpr_read_b32 v38, a104
    v_rcp_f32 v38, v38
    v_accvgpr_read_b32 v134, a8
    v_mul_f32 v134, v134, v38
    v_accvgpr_read_b32 v135, a9
    v_mul_f32 v135, v135, v38
    v_accvgpr_read_b32 v136, a10
    v_mul_f32 v136, v136, v38
    v_accvgpr_read_b32 v137, a11
    v_mul_f32 v137, v137, v38
    v_cvt_pk_bf16_f32 v138, v134, v135
    v_cvt_pk_bf16_f32 v139, v136, v137
    ds_write_b64 v48, v[138:139] offset:32768
    v_accvgpr_read_b32 v140, a20
    v_mul_f32 v140, v140, v38
    v_accvgpr_read_b32 v141, a21
    v_mul_f32 v141, v141, v38
    v_accvgpr_read_b32 v142, a22
    v_mul_f32 v142, v142, v38
    v_accvgpr_read_b32 v143, a23
    v_mul_f32 v143, v143, v38
    v_cvt_pk_bf16_f32 v144, v140, v141
    v_cvt_pk_bf16_f32 v145, v142, v143
    ds_write_b64 v49, v[144:145] offset:32768
    v_accvgpr_read_b32 v146, a32
    v_mul_f32 v146, v146, v38
    v_accvgpr_read_b32 v147, a33
    v_mul_f32 v147, v147, v38
    v_accvgpr_read_b32 v148, a34
    v_mul_f32 v148, v148, v38
    v_accvgpr_read_b32 v149, a35
    v_mul_f32 v149, v149, v38
    v_cvt_pk_bf16_f32 v150, v146, v147
    v_cvt_pk_bf16_f32 v151, v148, v149
    ds_write_b64 v50, v[150:151] offset:32768
    v_accvgpr_read_b32 v152, a44
    v_mul_f32 v152, v152, v38
    v_accvgpr_read_b32 v153, a45
    v_mul_f32 v153, v153, v38
    v_accvgpr_read_b32 v154, a46
    v_mul_f32 v154, v154, v38
    v_accvgpr_read_b32 v155, a47
    v_mul_f32 v155, v155, v38
    v_cvt_pk_bf16_f32 v156, v152, v153
    v_cvt_pk_bf16_f32 v157, v154, v155
    ds_write_b64 v51, v[156:157] offset:32768
    v_accvgpr_read_b32 v128, a56
    v_mul_f32 v128, v128, v38
    v_accvgpr_read_b32 v129, a57
    v_mul_f32 v129, v129, v38
    v_accvgpr_read_b32 v130, a58
    v_mul_f32 v130, v130, v38
    v_accvgpr_read_b32 v131, a59
    v_mul_f32 v131, v131, v38
    v_cvt_pk_bf16_f32 v132, v128, v129
    v_cvt_pk_bf16_f32 v133, v130, v131
    ds_write_b64 v52, v[132:133] offset:32768
    v_accvgpr_read_b32 v134, a68
    v_mul_f32 v134, v134, v38
    v_accvgpr_read_b32 v135, a69
    v_mul_f32 v135, v135, v38
    v_accvgpr_read_b32 v136, a70
    v_mul_f32 v136, v136, v38
    v_accvgpr_read_b32 v137, a71
    v_mul_f32 v137, v137, v38
    v_cvt_pk_bf16_f32 v138, v134, v135
    v_cvt_pk_bf16_f32 v139, v136, v137
    ds_write_b64 v53, v[138:139] offset:32768
    v_accvgpr_read_b32 v140, a80
    v_mul_f32 v140, v140, v38
    v_accvgpr_read_b32 v141, a81
    v_mul_f32 v141, v141, v38
    v_accvgpr_read_b32 v142, a82
    v_mul_f32 v142, v142, v38
    v_accvgpr_read_b32 v143, a83
    v_mul_f32 v143, v143, v38
    v_cvt_pk_bf16_f32 v144, v140, v141
    v_cvt_pk_bf16_f32 v145, v142, v143
    ds_write_b64 v54, v[144:145] offset:32768
    v_accvgpr_read_b32 v146, a92
    v_mul_f32 v146, v146, v38
    v_accvgpr_read_b32 v147, a93
    v_mul_f32 v147, v147, v38
    v_accvgpr_read_b32 v148, a94
    v_mul_f32 v148, v148, v38
    v_accvgpr_read_b32 v149, a95
    v_mul_f32 v149, v149, v38
    v_cvt_pk_bf16_f32 v150, v146, v147
    v_cvt_pk_bf16_f32 v151, v148, v149
    ds_write_b64 v55, v[150:151] offset:32768
    s_waitcnt lgkmcnt(0)
    s_barrier
    s_add_u32 s89, s71, 5
    s_and_b32 s89, s89, 15
    s_lshl_b32 s89, s89, 15
    s_add_u32 s77, s88, s89
    buffer_load_dwordx4 v[128:131], v30, s[60:63], s77 offen
    buffer_load_dwordx4 v[132:135], v30, s[60:63], s77 offen offset:1024
    buffer_load_dwordx4 v[136:139], v30, s[60:63], s77 offen offset:2048
    buffer_load_dwordx4 v[140:143], v30, s[60:63], s77 offen offset:3072
    buffer_load_dwordx4 v[144:147], v31, s[60:63], s77 offen
    buffer_load_dwordx4 v[148:151], v31, s[60:63], s77 offen offset:1024
    buffer_load_dwordx4 v[152:155], v31, s[60:63], s77 offen offset:2048
    buffer_load_dwordx4 v[156:159], v31, s[60:63], s77 offen offset:3072
    s_add_u32 s89, s71, 0
    s_and_b32 s92, s89, 3
    s_lshl_b32 s92, s92, 2
    s_bfe_u32 s89, s89, 0x20002
    s_lshl_b32 s89, s89, 8
    s_add_u32 s89, s89, 0
    v_add_u32 v6, s92, v2
    v_xor_b32 v6, v6, v4
    v_lshl_add_u32 v6, v6, 4, v5
    v_add_u32 v6, s89, v6
    ds_read_b128 a[96:99], v6
    ds_read_b128 a[100:103], v6 offset:16384
    ds_read_b128 a[104:107], v6 offset:32768
    s_add_u32 s89, s71, 1
    s_and_b32 s92, s89, 3
    s_lshl_b32 s92, s92, 2
    s_bfe_u32 s89, s89, 0x20002
    s_lshl_b32 s89, s89, 8
    s_add_u32 s89, s89, 0
    v_add_u32 v7, s92, v2
    v_xor_b32 v7, v7, v4
    v_lshl_add_u32 v7, v7, 4, v5
    v_add_u32 v7, s89, v7
    ds_read_b128 a[108:111], v7
    ds_read_b128 a[112:115], v7 offset:16384
    ds_read_b128 a[116:119], v7 offset:32768
    s_waitcnt vmcnt(46)
    v_perm_b32 v32, v164, v160, s82
    s_waitcnt vmcnt(44)
    v_perm_b32 v33, v172, v168, s82
    s_waitcnt vmcnt(42)
    v_perm_b32 v34, v180, v176, s82
    s_waitcnt vmcnt(40)
    v_perm_b32 v35, v188, v184, s82
    v_perm_b32 v36, v164, v160, s83
    v_perm_b32 v37, v172, v168, s83
    v_perm_b32 v38, v180, v176, s83
    v_perm_b32 v39, v188, v184, s83
    v_perm_b32 v40, v165, v161, s82
    v_perm_b32 v41, v173, v169, s82
    v_perm_b32 v42, v181, v177, s82
    v_perm_b32 v43, v189, v185, s82
    v_perm_b32 v44, v165, v161, s83
    v_perm_b32 v45, v173, v169, s83
    v_perm_b32 v46, v181, v177, s83
    v_perm_b32 v47, v189, v185, s83
    v_perm_b32 v48, v166, v162, s82
    v_perm_b32 v49, v174, v170, s82
    v_perm_b32 v50, v182, v178, s82
    v_perm_b32 v51, v190, v186, s82
    v_perm_b32 v52, v166, v162, s83
    v_perm_b32 v53, v174, v170, s83
    v_perm_b32 v54, v182, v178, s83
    v_perm_b32 v55, v190, v186, s83
    v_perm_b32 v56, v167, v163, s82
    v_perm_b32 v57, v175, v171, s82
    v_perm_b32 v58, v183, v179, s82
    v_perm_b32 v59, v191, v187, s82
    v_perm_b32 v60, v167, v163, s83
    v_perm_b32 v61, v175, v171, s83
    v_perm_b32 v62, v183, v179, s83
    v_perm_b32 v63, v191, v187, s83
    s_add_u32 s89, s71, 6
    s_and_b32 s89, s89, 15
    s_lshl_b32 s89, s89, 15
    s_add_u32 s77, s88, s89
    buffer_load_dwordx4 v[160:163], v30, s[60:63], s77 offen
    buffer_load_dwordx4 v[164:167], v30, s[60:63], s77 offen offset:1024
    buffer_load_dwordx4 v[168:171], v30, s[60:63], s77 offen offset:2048
    buffer_load_dwordx4 v[172:175], v30, s[60:63], s77 offen offset:3072
    buffer_load_dwordx4 v[176:179], v31, s[60:63], s77 offen
    buffer_load_dwordx4 v[180:183], v31, s[60:63], s77 offen offset:1024
    buffer_load_dwordx4 v[184:187], v31, s[60:63], s77 offen offset:2048
    buffer_load_dwordx4 v[188:191], v31, s[60:63], s77 offen offset:3072
    s_add_u32 s89, s71, 2
    s_and_b32 s92, s89, 3
    s_lshl_b32 s92, s92, 2
    s_bfe_u32 s89, s89, 0x20002
    s_lshl_b32 s89, s89, 8
    s_add_u32 s89, s89, 0
    v_add_u32 v6, s92, v2
    v_xor_b32 v6, v6, v4
    v_lshl_add_u32 v6, v6, 4, v5
    v_add_u32 v6, s89, v6
    ds_read_b128 a[120:123], v6
    ds_read_b128 a[124:127], v6 offset:16384
    ds_read_b128 a[128:131], v6 offset:32768
    s_waitcnt lgkmcnt(8)
    v_mfma_f32_16x16x32_bf16 a[0:3], v[32:35], a[96:99], 0
    s_waitcnt lgkmcnt(7)
    v_mfma_f32_16x16x32_bf16 a[4:7], v[32:35], a[100:103], 0
    s_waitcnt lgkmcnt(6)
    v_mfma_f32_16x16x32_bf16 a[8:11], v[32:35], a[104:107], 0
    s_waitcnt vmcnt(46)
    v_perm_b32 v32, v196, v192, s82
    s_waitcnt vmcnt(44)
    v_perm_b32 v33, v204, v200, s82
    s_waitcnt vmcnt(42)
    v_perm_b32 v34, v212, v208, s82
    s_waitcnt vmcnt(40)
    v_perm_b32 v35, v220, v216, s82
    v_mfma_f32_16x16x32_bf16 a[12:15], v[36:39], a[96:99], 0
    v_mfma_f32_16x16x32_bf16 a[16:19], v[36:39], a[100:103], 0
    v_mfma_f32_16x16x32_bf16 a[20:23], v[36:39], a[104:107], 0
    v_perm_b32 v36, v196, v192, s83
    v_perm_b32 v37, v204, v200, s83
    v_perm_b32 v38, v212, v208, s83
    v_perm_b32 v39, v220, v216, s83
    v_mfma_f32_16x16x32_bf16 a[24:27], v[40:43], a[96:99], 0
    v_mfma_f32_16x16x32_bf16 a[28:31], v[40:43], a[100:103], 0
    v_mfma_f32_16x16x32_bf16 a[32:35], v[40:43], a[104:107], 0
    v_perm_b32 v40, v197, v193, s82
    v_perm_b32 v41, v205, v201, s82
    v_perm_b32 v42, v213, v209, s82
    v_perm_b32 v43, v221, v217, s82
    v_mfma_f32_16x16x32_bf16 a[36:39], v[44:47], a[96:99], 0
    v_mfma_f32_16x16x32_bf16 a[40:43], v[44:47], a[100:103], 0
    v_mfma_f32_16x16x32_bf16 a[44:47], v[44:47], a[104:107], 0
    v_perm_b32 v44, v197, v193, s83
    v_perm_b32 v45, v205, v201, s83
    v_perm_b32 v46, v213, v209, s83
    v_perm_b32 v47, v221, v217, s83
    v_mfma_f32_16x16x32_bf16 a[48:51], v[48:51], a[96:99], 0
    v_mfma_f32_16x16x32_bf16 a[52:55], v[48:51], a[100:103], 0
    v_mfma_f32_16x16x32_bf16 a[56:59], v[48:51], a[104:107], 0
    v_perm_b32 v48, v198, v194, s82
    v_perm_b32 v49, v206, v202, s82
    v_perm_b32 v50, v214, v210, s82
    v_perm_b32 v51, v222, v218, s82
    v_mfma_f32_16x16x32_bf16 a[60:63], v[52:55], a[96:99], 0
    v_mfma_f32_16x16x32_bf16 a[64:67], v[52:55], a[100:103], 0
    v_mfma_f32_16x16x32_bf16 a[68:71], v[52:55], a[104:107], 0
    v_perm_b32 v52, v198, v194, s83
    v_perm_b32 v53, v206, v202, s83
    v_perm_b32 v54, v214, v210, s83
    v_perm_b32 v55, v222, v218, s83
    v_mfma_f32_16x16x32_bf16 a[72:75], v[56:59], a[96:99], 0
    v_mfma_f32_16x16x32_bf16 a[76:79], v[56:59], a[100:103], 0
    v_mfma_f32_16x16x32_bf16 a[80:83], v[56:59], a[104:107], 0
    v_perm_b32 v56, v199, v195, s82
    v_perm_b32 v57, v207, v203, s82
    v_perm_b32 v58, v215, v211, s82
    v_perm_b32 v59, v223, v219, s82
    v_mfma_f32_16x16x32_bf16 a[84:87], v[60:63], a[96:99], 0
    v_mfma_f32_16x16x32_bf16 a[88:91], v[60:63], a[100:103], 0
    v_mfma_f32_16x16x32_bf16 a[92:95], v[60:63], a[104:107], 0
    v_perm_b32 v60, v199, v195, s83
    v_perm_b32 v61, v207, v203, s83
    v_perm_b32 v62, v215, v211, s83
    v_perm_b32 v63, v223, v219, s83
    s_add_u32 s89, s71, 7
    s_and_b32 s89, s89, 15
    s_lshl_b32 s89, s89, 15
    s_add_u32 s77, s88, s89
    buffer_load_dwordx4 v[192:195], v30, s[60:63], s77 offen
    buffer_load_dwordx4 v[196:199], v30, s[60:63], s77 offen offset:1024
    buffer_load_dwordx4 v[200:203], v30, s[60:63], s77 offen offset:2048
    buffer_load_dwordx4 v[204:207], v30, s[60:63], s77 offen offset:3072
    buffer_load_dwordx4 v[208:211], v31, s[60:63], s77 offen
    buffer_load_dwordx4 v[212:215], v31, s[60:63], s77 offen offset:1024
    buffer_load_dwordx4 v[216:219], v31, s[60:63], s77 offen offset:2048
    buffer_load_dwordx4 v[220:223], v31, s[60:63], s77 offen offset:3072
    s_add_u32 s89, s71, 3
    s_and_b32 s92, s89, 3
    s_lshl_b32 s92, s92, 2
    s_bfe_u32 s89, s89, 0x20002
    s_lshl_b32 s89, s89, 8
    s_add_u32 s89, s89, 0
    v_add_u32 v7, s92, v2
    v_xor_b32 v7, v7, v4
    v_lshl_add_u32 v7, v7, 4, v5
    v_add_u32 v7, s89, v7
    ds_read_b128 a[96:99], v7
    ds_read_b128 a[100:103], v7 offset:16384
    ds_read_b128 a[104:107], v7 offset:32768
    s_waitcnt lgkmcnt(8)
    v_mfma_f32_16x16x32_bf16 a[0:3], v[32:35], a[108:111], a[0:3]
    s_waitcnt lgkmcnt(7)
    v_mfma_f32_16x16x32_bf16 a[4:7], v[32:35], a[112:115], a[4:7]
    s_waitcnt lgkmcnt(6)
    v_mfma_f32_16x16x32_bf16 a[8:11], v[32:35], a[116:119], a[8:11]
    s_waitcnt vmcnt(46)
    v_perm_b32 v32, v228, v224, s82
    s_waitcnt vmcnt(44)
    v_perm_b32 v33, v236, v232, s82
    s_waitcnt vmcnt(42)
    v_perm_b32 v34, v244, v240, s82
    s_waitcnt vmcnt(40)
    v_perm_b32 v35, v252, v248, s82
    v_mfma_f32_16x16x32_bf16 a[12:15], v[36:39], a[108:111], a[12:15]
    v_mfma_f32_16x16x32_bf16 a[16:19], v[36:39], a[112:115], a[16:19]
    v_mfma_f32_16x16x32_bf16 a[20:23], v[36:39], a[116:119], a[20:23]
    v_perm_b32 v36, v228, v224, s83
    v_perm_b32 v37, v236, v232, s83
    v_perm_b32 v38, v244, v240, s83
    v_perm_b32 v39, v252, v248, s83
    v_mfma_f32_16x16x32_bf16 a[24:27], v[40:43], a[108:111], a[24:27]
    v_mfma_f32_16x16x32_bf16 a[28:31], v[40:43], a[112:115], a[28:31]
    v_mfma_f32_16x16x32_bf16 a[32:35], v[40:43], a[116:119], a[32:35]
    v_perm_b32 v40, v229, v225, s82
    v_perm_b32 v41, v237, v233, s82
    v_perm_b32 v42, v245, v241, s82
    v_perm_b32 v43, v253, v249, s82
    v_mfma_f32_16x16x32_bf16 a[36:39], v[44:47], a[108:111], a[36:39]
    v_mfma_f32_16x16x32_bf16 a[40:43], v[44:47], a[112:115], a[40:43]
    v_mfma_f32_16x16x32_bf16 a[44:47], v[44:47], a[116:119], a[44:47]
    v_perm_b32 v44, v229, v225, s83
    v_perm_b32 v45, v237, v233, s83
    v_perm_b32 v46, v245, v241, s83
    v_perm_b32 v47, v253, v249, s83
    v_mfma_f32_16x16x32_bf16 a[48:51], v[48:51], a[108:111], a[48:51]
    v_mfma_f32_16x16x32_bf16 a[52:55], v[48:51], a[112:115], a[52:55]
    v_mfma_f32_16x16x32_bf16 a[56:59], v[48:51], a[116:119], a[56:59]
    v_perm_b32 v48, v230, v226, s82
    v_perm_b32 v49, v238, v234, s82
    v_perm_b32 v50, v246, v242, s82
    v_perm_b32 v51, v254, v250, s82
    v_mfma_f32_16x16x32_bf16 a[60:63], v[52:55], a[108:111], a[60:63]
    v_mfma_f32_16x16x32_bf16 a[64:67], v[52:55], a[112:115], a[64:67]
    v_mfma_f32_16x16x32_bf16 a[68:71], v[52:55], a[116:119], a[68:71]
    v_perm_b32 v52, v230, v226, s83
    v_perm_b32 v53, v238, v234, s83
    v_perm_b32 v54, v246, v242, s83
    v_perm_b32 v55, v254, v250, s83
    v_mfma_f32_16x16x32_bf16 a[72:75], v[56:59], a[108:111], a[72:75]
    v_mfma_f32_16x16x32_bf16 a[76:79], v[56:59], a[112:115], a[76:79]
    v_mfma_f32_16x16x32_bf16 a[80:83], v[56:59], a[116:119], a[80:83]
    v_perm_b32 v56, v231, v227, s82
    v_perm_b32 v57, v239, v235, s82
    v_perm_b32 v58, v247, v243, s82
    v_perm_b32 v59, v255, v251, s82
    v_mfma_f32_16x16x32_bf16 a[84:87], v[60:63], a[108:111], a[84:87]
    v_mfma_f32_16x16x32_bf16 a[88:91], v[60:63], a[112:115], a[88:91]
    v_mfma_f32_16x16x32_bf16 a[92:95], v[60:63], a[116:119], a[92:95]
    v_perm_b32 v60, v231, v227, s83
    v_perm_b32 v61, v239, v235, s83
    v_perm_b32 v62, v247, v243, s83
    v_perm_b32 v63, v255, v251, s83
    s_add_u32 s89, s71, 8
    s_and_b32 s89, s89, 15
    s_lshl_b32 s89, s89, 15
    s_add_u32 s77, s88, s89
    buffer_load_dwordx4 v[224:227], v30, s[60:63], s77 offen
    buffer_load_dwordx4 v[228:231], v30, s[60:63], s77 offen offset:1024
    buffer_load_dwordx4 v[232:235], v30, s[60:63], s77 offen offset:2048
    buffer_load_dwordx4 v[236:239], v30, s[60:63], s77 offen offset:3072
    buffer_load_dwordx4 v[240:243], v31, s[60:63], s77 offen
    buffer_load_dwordx4 v[244:247], v31, s[60:63], s77 offen offset:1024
    buffer_load_dwordx4 v[248:251], v31, s[60:63], s77 offen offset:2048
    buffer_load_dwordx4 v[252:255], v31, s[60:63], s77 offen offset:3072
    s_add_u32 s89, s71, 4
    s_and_b32 s92, s89, 3
    s_lshl_b32 s92, s92, 2
    s_bfe_u32 s89, s89, 0x20002
    s_lshl_b32 s89, s89, 8
    s_add_u32 s89, s89, 0
    v_add_u32 v6, s92, v2
    v_xor_b32 v6, v6, v4
    v_lshl_add_u32 v6, v6, 4, v5
    v_add_u32 v6, s89, v6
    ds_read_b128 a[108:111], v6
    ds_read_b128 a[112:115], v6 offset:16384
    ds_read_b128 a[116:119], v6 offset:32768
    s_waitcnt lgkmcnt(8)
    v_mfma_f32_16x16x32_bf16 a[0:3], v[32:35], a[120:123], a[0:3]
    s_waitcnt lgkmcnt(7)
    v_mfma_f32_16x16x32_bf16 a[4:7], v[32:35], a[124:127], a[4:7]
    s_waitcnt lgkmcnt(6)
    v_mfma_f32_16x16x32_bf16 a[8:11], v[32:35], a[128:131], a[8:11]
    s_waitcnt vmcnt(46)
    v_perm_b32 v32, v68, v64, s82
    s_waitcnt vmcnt(44)
    v_perm_b32 v33, v76, v72, s82
    s_waitcnt vmcnt(42)
    v_perm_b32 v34, v84, v80, s82
    s_waitcnt vmcnt(40)
    v_perm_b32 v35, v92, v88, s82
    v_mfma_f32_16x16x32_bf16 a[12:15], v[36:39], a[120:123], a[12:15]
    v_mfma_f32_16x16x32_bf16 a[16:19], v[36:39], a[124:127], a[16:19]
    v_mfma_f32_16x16x32_bf16 a[20:23], v[36:39], a[128:131], a[20:23]
    v_perm_b32 v36, v68, v64, s83
    v_perm_b32 v37, v76, v72, s83
    v_perm_b32 v38, v84, v80, s83
    v_perm_b32 v39, v92, v88, s83
    v_mfma_f32_16x16x32_bf16 a[24:27], v[40:43], a[120:123], a[24:27]
    v_mfma_f32_16x16x32_bf16 a[28:31], v[40:43], a[124:127], a[28:31]
    v_mfma_f32_16x16x32_bf16 a[32:35], v[40:43], a[128:131], a[32:35]
    v_perm_b32 v40, v69, v65, s82
    v_perm_b32 v41, v77, v73, s82
    v_perm_b32 v42, v85, v81, s82
    v_perm_b32 v43, v93, v89, s82
    v_mfma_f32_16x16x32_bf16 a[36:39], v[44:47], a[120:123], a[36:39]
    v_mfma_f32_16x16x32_bf16 a[40:43], v[44:47], a[124:127], a[40:43]
    v_mfma_f32_16x16x32_bf16 a[44:47], v[44:47], a[128:131], a[44:47]
    v_perm_b32 v44, v69, v65, s83
    v_perm_b32 v45, v77, v73, s83
    v_perm_b32 v46, v85, v81, s83
    v_perm_b32 v47, v93, v89, s83
    v_mfma_f32_16x16x32_bf16 a[48:51], v[48:51], a[120:123], a[48:51]
    v_mfma_f32_16x16x32_bf16 a[52:55], v[48:51], a[124:127], a[52:55]
    v_mfma_f32_16x16x32_bf16 a[56:59], v[48:51], a[128:131], a[56:59]
    v_perm_b32 v48, v70, v66, s82
    v_perm_b32 v49, v78, v74, s82
    v_perm_b32 v50, v86, v82, s82
    v_perm_b32 v51, v94, v90, s82
    v_mfma_f32_16x16x32_bf16 a[60:63], v[52:55], a[120:123], a[60:63]
    v_mfma_f32_16x16x32_bf16 a[64:67], v[52:55], a[124:127], a[64:67]
    v_mfma_f32_16x16x32_bf16 a[68:71], v[52:55], a[128:131], a[68:71]
    v_perm_b32 v52, v70, v66, s83
    v_perm_b32 v53, v78, v74, s83
    v_perm_b32 v54, v86, v82, s83
    v_perm_b32 v55, v94, v90, s83
    v_mfma_f32_16x16x32_bf16 a[72:75], v[56:59], a[120:123], a[72:75]
    v_mfma_f32_16x16x32_bf16 a[76:79], v[56:59], a[124:127], a[76:79]
    v_mfma_f32_16x16x32_bf16 a[80:83], v[56:59], a[128:131], a[80:83]
    v_perm_b32 v56, v71, v67, s82
    v_perm_b32 v57, v79, v75, s82
    v_perm_b32 v58, v87, v83, s82
    v_perm_b32 v59, v95, v91, s82
    v_mfma_f32_16x16x32_bf16 a[84:87], v[60:63], a[120:123], a[84:87]
    v_mfma_f32_16x16x32_bf16 a[88:91], v[60:63], a[124:127], a[88:91]
    v_mfma_f32_16x16x32_bf16 a[92:95], v[60:63], a[128:131], a[92:95]
    v_perm_b32 v60, v71, v67, s83
    v_perm_b32 v61, v79, v75, s83
    v_perm_b32 v62, v87, v83, s83
    v_perm_b32 v63, v95, v91, s83
    s_add_u32 s89, s71, 9
    s_and_b32 s89, s89, 15
    s_lshl_b32 s89, s89, 15
    s_add_u32 s77, s88, s89
    buffer_load_dwordx4 v[64:67], v30, s[60:63], s77 offen
    buffer_load_dwordx4 v[68:71], v30, s[60:63], s77 offen offset:1024
    buffer_load_dwordx4 v[72:75], v30, s[60:63], s77 offen offset:2048
    buffer_load_dwordx4 v[76:79], v30, s[60:63], s77 offen offset:3072
    buffer_load_dwordx4 v[80:83], v31, s[60:63], s77 offen
    buffer_load_dwordx4 v[84:87], v31, s[60:63], s77 offen offset:1024
    buffer_load_dwordx4 v[88:91], v31, s[60:63], s77 offen offset:2048
    buffer_load_dwordx4 v[92:95], v31, s[60:63], s77 offen offset:3072
    s_add_u32 s89, s71, 5
    s_and_b32 s92, s89, 3
    s_lshl_b32 s92, s92, 2
    s_bfe_u32 s89, s89, 0x20002
    s_lshl_b32 s89, s89, 8
    s_add_u32 s89, s89, 0
    v_add_u32 v7, s92, v2
    v_xor_b32 v7, v7, v4
    v_lshl_add_u32 v7, v7, 4, v5
    v_add_u32 v7, s89, v7
    ds_read_b128 a[120:123], v7
    ds_read_b128 a[124:127], v7 offset:16384
    ds_read_b128 a[128:131], v7 offset:32768
    s_waitcnt lgkmcnt(8)
    v_mfma_f32_16x16x32_bf16 a[0:3], v[32:35], a[96:99], a[0:3]
    s_waitcnt lgkmcnt(7)
    v_mfma_f32_16x16x32_bf16 a[4:7], v[32:35], a[100:103], a[4:7]
    s_waitcnt lgkmcnt(6)
    v_mfma_f32_16x16x32_bf16 a[8:11], v[32:35], a[104:107], a[8:11]
    s_waitcnt vmcnt(46)
    v_perm_b32 v32, v100, v96, s82
    s_waitcnt vmcnt(44)
    v_perm_b32 v33, v108, v104, s82
    s_waitcnt vmcnt(42)
    v_perm_b32 v34, v116, v112, s82
    s_waitcnt vmcnt(40)
    v_perm_b32 v35, v124, v120, s82
    v_mfma_f32_16x16x32_bf16 a[12:15], v[36:39], a[96:99], a[12:15]
    v_mfma_f32_16x16x32_bf16 a[16:19], v[36:39], a[100:103], a[16:19]
    v_mfma_f32_16x16x32_bf16 a[20:23], v[36:39], a[104:107], a[20:23]
    v_perm_b32 v36, v100, v96, s83
    v_perm_b32 v37, v108, v104, s83
    v_perm_b32 v38, v116, v112, s83
    v_perm_b32 v39, v124, v120, s83
    v_mfma_f32_16x16x32_bf16 a[24:27], v[40:43], a[96:99], a[24:27]
    v_mfma_f32_16x16x32_bf16 a[28:31], v[40:43], a[100:103], a[28:31]
    v_mfma_f32_16x16x32_bf16 a[32:35], v[40:43], a[104:107], a[32:35]
    v_perm_b32 v40, v101, v97, s82
    v_perm_b32 v41, v109, v105, s82
    v_perm_b32 v42, v117, v113, s82
    v_perm_b32 v43, v125, v121, s82
    v_mfma_f32_16x16x32_bf16 a[36:39], v[44:47], a[96:99], a[36:39]
    v_mfma_f32_16x16x32_bf16 a[40:43], v[44:47], a[100:103], a[40:43]
    v_mfma_f32_16x16x32_bf16 a[44:47], v[44:47], a[104:107], a[44:47]
    v_perm_b32 v44, v101, v97, s83
    v_perm_b32 v45, v109, v105, s83
    v_perm_b32 v46, v117, v113, s83
    v_perm_b32 v47, v125, v121, s83
    v_mfma_f32_16x16x32_bf16 a[48:51], v[48:51], a[96:99], a[48:51]
    v_mfma_f32_16x16x32_bf16 a[52:55], v[48:51], a[100:103], a[52:55]
    v_mfma_f32_16x16x32_bf16 a[56:59], v[48:51], a[104:107], a[56:59]
    v_perm_b32 v48, v102, v98, s82
    v_perm_b32 v49, v110, v106, s82
    v_perm_b32 v50, v118, v114, s82
    v_perm_b32 v51, v126, v122, s82
    v_mfma_f32_16x16x32_bf16 a[60:63], v[52:55], a[96:99], a[60:63]
    v_mfma_f32_16x16x32_bf16 a[64:67], v[52:55], a[100:103], a[64:67]
    v_mfma_f32_16x16x32_bf16 a[68:71], v[52:55], a[104:107], a[68:71]
    v_perm_b32 v52, v102, v98, s83
    v_perm_b32 v53, v110, v106, s83
    v_perm_b32 v54, v118, v114, s83
    v_perm_b32 v55, v126, v122, s83
    v_mfma_f32_16x16x32_bf16 a[72:75], v[56:59], a[96:99], a[72:75]
    v_mfma_f32_16x16x32_bf16 a[76:79], v[56:59], a[100:103], a[76:79]
    v_mfma_f32_16x16x32_bf16 a[80:83], v[56:59], a[104:107], a[80:83]
    v_perm_b32 v56, v103, v99, s82
    v_perm_b32 v57, v111, v107, s82
    v_perm_b32 v58, v119, v115, s82
    v_perm_b32 v59, v127, v123, s82
    v_mfma_f32_16x16x32_bf16 a[84:87], v[60:63], a[96:99], a[84:87]
    v_mfma_f32_16x16x32_bf16 a[88:91], v[60:63], a[100:103], a[88:91]
    v_mfma_f32_16x16x32_bf16 a[92:95], v[60:63], a[104:107], a[92:95]
    v_perm_b32 v60, v103, v99, s83
    v_perm_b32 v61, v111, v107, s83
    v_perm_b32 v62, v119, v115, s83
    v_perm_b32 v63, v127, v123, s83
    s_add_u32 s89, s71, 10
    s_and_b32 s89, s89, 15
    s_lshl_b32 s89, s89, 15
    s_add_u32 s77, s88, s89
    buffer_load_dwordx4 v[96:99], v30, s[60:63], s77 offen
    buffer_load_dwordx4 v[100:103], v30, s[60:63], s77 offen offset:1024
    buffer_load_dwordx4 v[104:107], v30, s[60:63], s77 offen offset:2048
    buffer_load_dwordx4 v[108:111], v30, s[60:63], s77 offen offset:3072
    buffer_load_dwordx4 v[112:115], v31, s[60:63], s77 offen
    buffer_load_dwordx4 v[116:119], v31, s[60:63], s77 offen offset:1024
    buffer_load_dwordx4 v[120:123], v31, s[60:63], s77 offen offset:2048
    buffer_load_dwordx4 v[124:127], v31, s[60:63], s77 offen offset:3072
    s_add_u32 s89, s71, 6
    s_and_b32 s92, s89, 3
    s_lshl_b32 s92, s92, 2
    s_bfe_u32 s89, s89, 0x20002
    s_lshl_b32 s89, s89, 8
    s_add_u32 s89, s89, 0
    v_add_u32 v6, s92, v2
    v_xor_b32 v6, v6, v4
    v_lshl_add_u32 v6, v6, 4, v5
    v_add_u32 v6, s89, v6
    ds_read_b128 a[96:99], v6
    ds_read_b128 a[100:103], v6 offset:16384
    ds_read_b128 a[104:107], v6 offset:32768
    s_waitcnt lgkmcnt(8)
    v_mfma_f32_16x16x32_bf16 a[0:3], v[32:35], a[108:111], a[0:3]
    s_waitcnt lgkmcnt(7)
    v_mfma_f32_16x16x32_bf16 a[4:7], v[32:35], a[112:115], a[4:7]
    s_waitcnt lgkmcnt(6)
    v_mfma_f32_16x16x32_bf16 a[8:11], v[32:35], a[116:119], a[8:11]
    s_waitcnt vmcnt(46)
    v_perm_b32 v32, v132, v128, s82
    s_waitcnt vmcnt(44)
    v_perm_b32 v33, v140, v136, s82
    s_waitcnt vmcnt(42)
    v_perm_b32 v34, v148, v144, s82
    s_waitcnt vmcnt(40)
    v_perm_b32 v35, v156, v152, s82
    v_mfma_f32_16x16x32_bf16 a[12:15], v[36:39], a[108:111], a[12:15]
    v_mfma_f32_16x16x32_bf16 a[16:19], v[36:39], a[112:115], a[16:19]
    v_mfma_f32_16x16x32_bf16 a[20:23], v[36:39], a[116:119], a[20:23]
    v_perm_b32 v36, v132, v128, s83
    v_perm_b32 v37, v140, v136, s83
    v_perm_b32 v38, v148, v144, s83
    v_perm_b32 v39, v156, v152, s83
    v_mfma_f32_16x16x32_bf16 a[24:27], v[40:43], a[108:111], a[24:27]
    v_mfma_f32_16x16x32_bf16 a[28:31], v[40:43], a[112:115], a[28:31]
    v_mfma_f32_16x16x32_bf16 a[32:35], v[40:43], a[116:119], a[32:35]
    v_perm_b32 v40, v133, v129, s82
    v_perm_b32 v41, v141, v137, s82
    v_perm_b32 v42, v149, v145, s82
    v_perm_b32 v43, v157, v153, s82
    v_mfma_f32_16x16x32_bf16 a[36:39], v[44:47], a[108:111], a[36:39]
    v_mfma_f32_16x16x32_bf16 a[40:43], v[44:47], a[112:115], a[40:43]
    v_mfma_f32_16x16x32_bf16 a[44:47], v[44:47], a[116:119], a[44:47]
    v_perm_b32 v44, v133, v129, s83
    v_perm_b32 v45, v141, v137, s83
    v_perm_b32 v46, v149, v145, s83
    v_perm_b32 v47, v157, v153, s83
    v_mfma_f32_16x16x32_bf16 a[48:51], v[48:51], a[108:111], a[48:51]
    v_mfma_f32_16x16x32_bf16 a[52:55], v[48:51], a[112:115], a[52:55]
    v_mfma_f32_16x16x32_bf16 a[56:59], v[48:51], a[116:119], a[56:59]
    v_perm_b32 v48, v134, v130, s82
    v_perm_b32 v49, v142, v138, s82
    v_perm_b32 v50, v150, v146, s82
    v_perm_b32 v51, v158, v154, s82
    v_mfma_f32_16x16x32_bf16 a[60:63], v[52:55], a[108:111], a[60:63]
    v_mfma_f32_16x16x32_bf16 a[64:67], v[52:55], a[112:115], a[64:67]
    v_mfma_f32_16x16x32_bf16 a[68:71], v[52:55], a[116:119], a[68:71]
    v_perm_b32 v52, v134, v130, s83
    v_perm_b32 v53, v142, v138, s83
    v_perm_b32 v54, v150, v146, s83
    v_perm_b32 v55, v158, v154, s83
    v_mfma_f32_16x16x32_bf16 a[72:75], v[56:59], a[108:111], a[72:75]
    v_mfma_f32_16x16x32_bf16 a[76:79], v[56:59], a[112:115], a[76:79]
    v_mfma_f32_16x16x32_bf16 a[80:83], v[56:59], a[116:119], a[80:83]
    v_perm_b32 v56, v135, v131, s82
    v_perm_b32 v57, v143, v139, s82
    v_perm_b32 v58, v151, v147, s82
    v_perm_b32 v59, v159, v155, s82
    v_mfma_f32_16x16x32_bf16 a[84:87], v[60:63], a[108:111], a[84:87]
    v_mfma_f32_16x16x32_bf16 a[88:91], v[60:63], a[112:115], a[88:91]
    v_mfma_f32_16x16x32_bf16 a[92:95], v[60:63], a[116:119], a[92:95]
    v_perm_b32 v60, v135, v131, s83
    v_perm_b32 v61, v143, v139, s83
    v_perm_b32 v62, v151, v147, s83
    v_perm_b32 v63, v159, v155, s83
    s_add_u32 s89, s71, 11
    s_and_b32 s89, s89, 15
    s_lshl_b32 s89, s89, 15
    s_add_u32 s77, s88, s89
    buffer_load_dwordx4 v[128:131], v30, s[60:63], s77 offen
    buffer_load_dwordx4 v[132:135], v30, s[60:63], s77 offen offset:1024
    buffer_load_dwordx4 v[136:139], v30, s[60:63], s77 offen offset:2048
    buffer_load_dwordx4 v[140:143], v30, s[60:63], s77 offen offset:3072
    buffer_load_dwordx4 v[144:147], v31, s[60:63], s77 offen
    buffer_load_dwordx4 v[148:151], v31, s[60:63], s77 offen offset:1024
    buffer_load_dwordx4 v[152:155], v31, s[60:63], s77 offen offset:2048
    buffer_load_dwordx4 v[156:159], v31, s[60:63], s77 offen offset:3072
    s_add_u32 s89, s71, 7
    s_and_b32 s92, s89, 3
    s_lshl_b32 s92, s92, 2
    s_bfe_u32 s89, s89, 0x20002
    s_lshl_b32 s89, s89, 8
    s_add_u32 s89, s89, 0
    v_add_u32 v7, s92, v2
    v_xor_b32 v7, v7, v4
    v_lshl_add_u32 v7, v7, 4, v5
    v_add_u32 v7, s89, v7
    ds_read_b128 a[108:111], v7
    ds_read_b128 a[112:115], v7 offset:16384
    ds_read_b128 a[116:119], v7 offset:32768
    s_waitcnt lgkmcnt(8)
    v_mfma_f32_16x16x32_bf16 a[0:3], v[32:35], a[120:123], a[0:3]
    s_waitcnt lgkmcnt(7)
    v_mfma_f32_16x16x32_bf16 a[4:7], v[32:35], a[124:127], a[4:7]
    s_waitcnt lgkmcnt(6)
    v_mfma_f32_16x16x32_bf16 a[8:11], v[32:35], a[128:131], a[8:11]
    s_waitcnt vmcnt(46)
    v_perm_b32 v32, v164, v160, s82
    s_waitcnt vmcnt(44)
    v_perm_b32 v33, v172, v168, s82
    s_waitcnt vmcnt(42)
    v_perm_b32 v34, v180, v176, s82
    s_waitcnt vmcnt(40)
    v_perm_b32 v35, v188, v184, s82
    v_mfma_f32_16x16x32_bf16 a[12:15], v[36:39], a[120:123], a[12:15]
    v_mfma_f32_16x16x32_bf16 a[16:19], v[36:39], a[124:127], a[16:19]
    v_mfma_f32_16x16x32_bf16 a[20:23], v[36:39], a[128:131], a[20:23]
    v_perm_b32 v36, v164, v160, s83
    v_perm_b32 v37, v172, v168, s83
    v_perm_b32 v38, v180, v176, s83
    v_perm_b32 v39, v188, v184, s83
    v_mfma_f32_16x16x32_bf16 a[24:27], v[40:43], a[120:123], a[24:27]
    v_mfma_f32_16x16x32_bf16 a[28:31], v[40:43], a[124:127], a[28:31]
    v_mfma_f32_16x16x32_bf16 a[32:35], v[40:43], a[128:131], a[32:35]
    v_perm_b32 v40, v165, v161, s82
    v_perm_b32 v41, v173, v169, s82
    v_perm_b32 v42, v181, v177, s82
    v_perm_b32 v43, v189, v185, s82
    v_mfma_f32_16x16x32_bf16 a[36:39], v[44:47], a[120:123], a[36:39]
    v_mfma_f32_16x16x32_bf16 a[40:43], v[44:47], a[124:127], a[40:43]
    v_mfma_f32_16x16x32_bf16 a[44:47], v[44:47], a[128:131], a[44:47]
    v_perm_b32 v44, v165, v161, s83
    v_perm_b32 v45, v173, v169, s83
    v_perm_b32 v46, v181, v177, s83
    v_perm_b32 v47, v189, v185, s83
    v_mfma_f32_16x16x32_bf16 a[48:51], v[48:51], a[120:123], a[48:51]
    v_mfma_f32_16x16x32_bf16 a[52:55], v[48:51], a[124:127], a[52:55]
    v_mfma_f32_16x16x32_bf16 a[56:59], v[48:51], a[128:131], a[56:59]
    v_perm_b32 v48, v166, v162, s82
    v_perm_b32 v49, v174, v170, s82
    v_perm_b32 v50, v182, v178, s82
    v_perm_b32 v51, v190, v186, s82
    v_mfma_f32_16x16x32_bf16 a[60:63], v[52:55], a[120:123], a[60:63]
    v_mfma_f32_16x16x32_bf16 a[64:67], v[52:55], a[124:127], a[64:67]
    v_mfma_f32_16x16x32_bf16 a[68:71], v[52:55], a[128:131], a[68:71]
    v_perm_b32 v52, v166, v162, s83
    v_perm_b32 v53, v174, v170, s83
    v_perm_b32 v54, v182, v178, s83
    v_perm_b32 v55, v190, v186, s83
    v_mfma_f32_16x16x32_bf16 a[72:75], v[56:59], a[120:123], a[72:75]
    v_mfma_f32_16x16x32_bf16 a[76:79], v[56:59], a[124:127], a[76:79]
    v_mfma_f32_16x16x32_bf16 a[80:83], v[56:59], a[128:131], a[80:83]
    v_perm_b32 v56, v167, v163, s82
    v_perm_b32 v57, v175, v171, s82
    v_perm_b32 v58, v183, v179, s82
    v_perm_b32 v59, v191, v187, s82
    v_mfma_f32_16x16x32_bf16 a[84:87], v[60:63], a[120:123], a[84:87]
    v_mfma_f32_16x16x32_bf16 a[88:91], v[60:63], a[124:127], a[88:91]
    v_mfma_f32_16x16x32_bf16 a[92:95], v[60:63], a[128:131], a[92:95]
    v_perm_b32 v60, v167, v163, s83
    v_perm_b32 v61, v175, v171, s83
    v_perm_b32 v62, v183, v179, s83
    v_perm_b32 v63, v191, v187, s83
    s_add_u32 s89, s71, 12
    s_and_b32 s89, s89, 15
    s_lshl_b32 s89, s89, 15
    s_add_u32 s77, s88, s89
    buffer_load_dwordx4 v[160:163], v30, s[60:63], s77 offen
    buffer_load_dwordx4 v[164:167], v30, s[60:63], s77 offen offset:1024
    buffer_load_dwordx4 v[168:171], v30, s[60:63], s77 offen offset:2048
    buffer_load_dwordx4 v[172:175], v30, s[60:63], s77 offen offset:3072
    buffer_load_dwordx4 v[176:179], v31, s[60:63], s77 offen
    buffer_load_dwordx4 v[180:183], v31, s[60:63], s77 offen offset:1024
    buffer_load_dwordx4 v[184:187], v31, s[60:63], s77 offen offset:2048
    buffer_load_dwordx4 v[188:191], v31, s[60:63], s77 offen offset:3072
    s_add_u32 s89, s71, 8
    s_and_b32 s92, s89, 3
    s_lshl_b32 s92, s92, 2
    s_bfe_u32 s89, s89, 0x20002
    s_lshl_b32 s89, s89, 8
    s_add_u32 s89, s89, 0
    v_add_u32 v6, s92, v2
    v_xor_b32 v6, v6, v4
    v_lshl_add_u32 v6, v6, 4, v5
    v_add_u32 v6, s89, v6
    ds_read_b128 a[120:123], v6
    ds_read_b128 a[124:127], v6 offset:16384
    ds_read_b128 a[128:131], v6 offset:32768
    s_waitcnt lgkmcnt(8)
    v_mfma_f32_16x16x32_bf16 a[0:3], v[32:35], a[96:99], a[0:3]
    s_waitcnt lgkmcnt(7)
    v_mfma_f32_16x16x32_bf16 a[4:7], v[32:35], a[100:103], a[4:7]
    s_waitcnt lgkmcnt(6)
    v_mfma_f32_16x16x32_bf16 a[8:11], v[32:35], a[104:107], a[8:11]
    s_waitcnt vmcnt(46)
    v_perm_b32 v32, v196, v192, s82
    s_waitcnt vmcnt(44)
    v_perm_b32 v33, v204, v200, s82
    s_waitcnt vmcnt(42)
    v_perm_b32 v34, v212, v208, s82
    s_waitcnt vmcnt(40)
    v_perm_b32 v35, v220, v216, s82
    v_mfma_f32_16x16x32_bf16 a[12:15], v[36:39], a[96:99], a[12:15]
    v_mfma_f32_16x16x32_bf16 a[16:19], v[36:39], a[100:103], a[16:19]
    v_mfma_f32_16x16x32_bf16 a[20:23], v[36:39], a[104:107], a[20:23]
    v_perm_b32 v36, v196, v192, s83
    v_perm_b32 v37, v204, v200, s83
    v_perm_b32 v38, v212, v208, s83
    v_perm_b32 v39, v220, v216, s83
    v_mfma_f32_16x16x32_bf16 a[24:27], v[40:43], a[96:99], a[24:27]
    v_mfma_f32_16x16x32_bf16 a[28:31], v[40:43], a[100:103], a[28:31]
    v_mfma_f32_16x16x32_bf16 a[32:35], v[40:43], a[104:107], a[32:35]
    v_perm_b32 v40, v197, v193, s82
    v_perm_b32 v41, v205, v201, s82
    v_perm_b32 v42, v213, v209, s82
    v_perm_b32 v43, v221, v217, s82
    v_mfma_f32_16x16x32_bf16 a[36:39], v[44:47], a[96:99], a[36:39]
    v_mfma_f32_16x16x32_bf16 a[40:43], v[44:47], a[100:103], a[40:43]
    v_mfma_f32_16x16x32_bf16 a[44:47], v[44:47], a[104:107], a[44:47]
    v_perm_b32 v44, v197, v193, s83
    v_perm_b32 v45, v205, v201, s83
    v_perm_b32 v46, v213, v209, s83
    v_perm_b32 v47, v221, v217, s83
    v_mfma_f32_16x16x32_bf16 a[48:51], v[48:51], a[96:99], a[48:51]
    v_mfma_f32_16x16x32_bf16 a[52:55], v[48:51], a[100:103], a[52:55]
    v_mfma_f32_16x16x32_bf16 a[56:59], v[48:51], a[104:107], a[56:59]
    v_perm_b32 v48, v198, v194, s82
    v_perm_b32 v49, v206, v202, s82
    v_perm_b32 v50, v214, v210, s82
    v_perm_b32 v51, v222, v218, s82
    v_mfma_f32_16x16x32_bf16 a[60:63], v[52:55], a[96:99], a[60:63]
    v_mfma_f32_16x16x32_bf16 a[64:67], v[52:55], a[100:103], a[64:67]
    v_mfma_f32_16x16x32_bf16 a[68:71], v[52:55], a[104:107], a[68:71]
    v_perm_b32 v52, v198, v194, s83
    v_perm_b32 v53, v206, v202, s83
    v_perm_b32 v54, v214, v210, s83
    v_perm_b32 v55, v222, v218, s83
    v_mfma_f32_16x16x32_bf16 a[72:75], v[56:59], a[96:99], a[72:75]
    v_mfma_f32_16x16x32_bf16 a[76:79], v[56:59], a[100:103], a[76:79]
    v_mfma_f32_16x16x32_bf16 a[80:83], v[56:59], a[104:107], a[80:83]
    v_perm_b32 v56, v199, v195, s82
    v_perm_b32 v57, v207, v203, s82
    v_perm_b32 v58, v215, v211, s82
    v_perm_b32 v59, v223, v219, s82
    v_mfma_f32_16x16x32_bf16 a[84:87], v[60:63], a[96:99], a[84:87]
    v_mfma_f32_16x16x32_bf16 a[88:91], v[60:63], a[100:103], a[88:91]
    v_mfma_f32_16x16x32_bf16 a[92:95], v[60:63], a[104:107], a[92:95]
    v_perm_b32 v60, v199, v195, s83
    v_perm_b32 v61, v207, v203, s83
    v_perm_b32 v62, v215, v211, s83
    v_perm_b32 v63, v223, v219, s83
    s_add_u32 s89, s71, 13
    s_and_b32 s89, s89, 15
    s_lshl_b32 s89, s89, 15
    s_add_u32 s77, s88, s89
    buffer_load_dwordx4 v[192:195], v30, s[60:63], s77 offen
    buffer_load_dwordx4 v[196:199], v30, s[60:63], s77 offen offset:1024
    buffer_load_dwordx4 v[200:203], v30, s[60:63], s77 offen offset:2048
    buffer_load_dwordx4 v[204:207], v30, s[60:63], s77 offen offset:3072
    buffer_load_dwordx4 v[208:211], v31, s[60:63], s77 offen
    buffer_load_dwordx4 v[212:215], v31, s[60:63], s77 offen offset:1024
    buffer_load_dwordx4 v[216:219], v31, s[60:63], s77 offen offset:2048
    buffer_load_dwordx4 v[220:223], v31, s[60:63], s77 offen offset:3072
    s_add_u32 s89, s71, 9
    s_and_b32 s92, s89, 3
    s_lshl_b32 s92, s92, 2
    s_bfe_u32 s89, s89, 0x20002
    s_lshl_b32 s89, s89, 8
    s_add_u32 s89, s89, 0
    v_add_u32 v7, s92, v2
    v_xor_b32 v7, v7, v4
    v_lshl_add_u32 v7, v7, 4, v5
    v_add_u32 v7, s89, v7
    ds_read_b128 a[96:99], v7
    ds_read_b128 a[100:103], v7 offset:16384
    ds_read_b128 a[104:107], v7 offset:32768
    s_waitcnt lgkmcnt(8)
    v_mfma_f32_16x16x32_bf16 a[0:3], v[32:35], a[108:111], a[0:3]
    s_waitcnt lgkmcnt(7)
    v_mfma_f32_16x16x32_bf16 a[4:7], v[32:35], a[112:115], a[4:7]
    s_waitcnt lgkmcnt(6)
    v_mfma_f32_16x16x32_bf16 a[8:11], v[32:35], a[116:119], a[8:11]
    s_waitcnt vmcnt(46)
    v_perm_b32 v32, v228, v224, s82
    s_waitcnt vmcnt(44)
    v_perm_b32 v33, v236, v232, s82
    s_waitcnt vmcnt(42)
    v_perm_b32 v34, v244, v240, s82
    s_waitcnt vmcnt(40)
    v_perm_b32 v35, v252, v248, s82
    v_mfma_f32_16x16x32_bf16 a[12:15], v[36:39], a[108:111], a[12:15]
    v_mfma_f32_16x16x32_bf16 a[16:19], v[36:39], a[112:115], a[16:19]
    v_mfma_f32_16x16x32_bf16 a[20:23], v[36:39], a[116:119], a[20:23]
    v_perm_b32 v36, v228, v224, s83
    v_perm_b32 v37, v236, v232, s83
    v_perm_b32 v38, v244, v240, s83
    v_perm_b32 v39, v252, v248, s83
    v_mfma_f32_16x16x32_bf16 a[24:27], v[40:43], a[108:111], a[24:27]
    v_mfma_f32_16x16x32_bf16 a[28:31], v[40:43], a[112:115], a[28:31]
    v_mfma_f32_16x16x32_bf16 a[32:35], v[40:43], a[116:119], a[32:35]
    v_perm_b32 v40, v229, v225, s82
    v_perm_b32 v41, v237, v233, s82
    v_perm_b32 v42, v245, v241, s82
    v_perm_b32 v43, v253, v249, s82
    v_mfma_f32_16x16x32_bf16 a[36:39], v[44:47], a[108:111], a[36:39]
    v_mfma_f32_16x16x32_bf16 a[40:43], v[44:47], a[112:115], a[40:43]
    v_mfma_f32_16x16x32_bf16 a[44:47], v[44:47], a[116:119], a[44:47]
    v_perm_b32 v44, v229, v225, s83
    v_perm_b32 v45, v237, v233, s83
    v_perm_b32 v46, v245, v241, s83
    v_perm_b32 v47, v253, v249, s83
    v_mfma_f32_16x16x32_bf16 a[48:51], v[48:51], a[108:111], a[48:51]
    v_mfma_f32_16x16x32_bf16 a[52:55], v[48:51], a[112:115], a[52:55]
    v_mfma_f32_16x16x32_bf16 a[56:59], v[48:51], a[116:119], a[56:59]
    v_perm_b32 v48, v230, v226, s82
    v_perm_b32 v49, v238, v234, s82
    v_perm_b32 v50, v246, v242, s82
    v_perm_b32 v51, v254, v250, s82
    v_mfma_f32_16x16x32_bf16 a[60:63], v[52:55], a[108:111], a[60:63]
    v_mfma_f32_16x16x32_bf16 a[64:67], v[52:55], a[112:115], a[64:67]
    v_mfma_f32_16x16x32_bf16 a[68:71], v[52:55], a[116:119], a[68:71]
    v_perm_b32 v52, v230, v226, s83
    v_perm_b32 v53, v238, v234, s83
    v_perm_b32 v54, v246, v242, s83
    v_perm_b32 v55, v254, v250, s83
    v_mfma_f32_16x16x32_bf16 a[72:75], v[56:59], a[108:111], a[72:75]
    v_mfma_f32_16x16x32_bf16 a[76:79], v[56:59], a[112:115], a[76:79]
    v_mfma_f32_16x16x32_bf16 a[80:83], v[56:59], a[116:119], a[80:83]
    v_perm_b32 v56, v231, v227, s82
    v_perm_b32 v57, v239, v235, s82
    v_perm_b32 v58, v247, v243, s82
    v_perm_b32 v59, v255, v251, s82
    v_mfma_f32_16x16x32_bf16 a[84:87], v[60:63], a[108:111], a[84:87]
    v_mfma_f32_16x16x32_bf16 a[88:91], v[60:63], a[112:115], a[88:91]
    v_mfma_f32_16x16x32_bf16 a[92:95], v[60:63], a[116:119], a[92:95]
    v_perm_b32 v60, v231, v227, s83
    v_perm_b32 v61, v239, v235, s83
    v_perm_b32 v62, v247, v243, s83
    v_perm_b32 v63, v255, v251, s83
    s_add_u32 s89, s71, 14
    s_and_b32 s89, s89, 15
    s_lshl_b32 s89, s89, 15
    s_add_u32 s77, s88, s89
    buffer_load_dwordx4 v[224:227], v30, s[60:63], s77 offen
    buffer_load_dwordx4 v[228:231], v30, s[60:63], s77 offen offset:1024
    buffer_load_dwordx4 v[232:235], v30, s[60:63], s77 offen offset:2048
    buffer_load_dwordx4 v[236:239], v30, s[60:63], s77 offen offset:3072
    buffer_load_dwordx4 v[240:243], v31, s[60:63], s77 offen
    buffer_load_dwordx4 v[244:247], v31, s[60:63], s77 offen offset:1024
    buffer_load_dwordx4 v[248:251], v31, s[60:63], s77 offen offset:2048
    buffer_load_dwordx4 v[252:255], v31, s[60:63], s77 offen offset:3072
    s_add_u32 s89, s71, 10
    s_and_b32 s92, s89, 3
    s_lshl_b32 s92, s92, 2
    s_bfe_u32 s89, s89, 0x20002
    s_lshl_b32 s89, s89, 8
    s_add_u32 s89, s89, 0
    v_add_u32 v6, s92, v2
    v_xor_b32 v6, v6, v4
    v_lshl_add_u32 v6, v6, 4, v5
    v_add_u32 v6, s89, v6
    ds_read_b128 a[108:111], v6
    ds_read_b128 a[112:115], v6 offset:16384
    ds_read_b128 a[116:119], v6 offset:32768
    s_waitcnt lgkmcnt(8)
    v_mfma_f32_16x16x32_bf16 a[0:3], v[32:35], a[120:123], a[0:3]
    s_waitcnt lgkmcnt(7)
    v_mfma_f32_16x16x32_bf16 a[4:7], v[32:35], a[124:127], a[4:7]
    s_waitcnt lgkmcnt(6)
    v_mfma_f32_16x16x32_bf16 a[8:11], v[32:35], a[128:131], a[8:11]
    s_waitcnt vmcnt(46)
    v_perm_b32 v32, v68, v64, s82
    s_waitcnt vmcnt(44)
    v_perm_b32 v33, v76, v72, s82
    s_waitcnt vmcnt(42)
    v_perm_b32 v34, v84, v80, s82
    s_waitcnt vmcnt(40)
    v_perm_b32 v35, v92, v88, s82
    v_mfma_f32_16x16x32_bf16 a[12:15], v[36:39], a[120:123], a[12:15]
    v_mfma_f32_16x16x32_bf16 a[16:19], v[36:39], a[124:127], a[16:19]
    v_mfma_f32_16x16x32_bf16 a[20:23], v[36:39], a[128:131], a[20:23]
    v_perm_b32 v36, v68, v64, s83
    v_perm_b32 v37, v76, v72, s83
    v_perm_b32 v38, v84, v80, s83
    v_perm_b32 v39, v92, v88, s83
    v_mfma_f32_16x16x32_bf16 a[24:27], v[40:43], a[120:123], a[24:27]
    v_mfma_f32_16x16x32_bf16 a[28:31], v[40:43], a[124:127], a[28:31]
    v_mfma_f32_16x16x32_bf16 a[32:35], v[40:43], a[128:131], a[32:35]
    v_perm_b32 v40, v69, v65, s82
    v_perm_b32 v41, v77, v73, s82
    v_perm_b32 v42, v85, v81, s82
    v_perm_b32 v43, v93, v89, s82
    v_mfma_f32_16x16x32_bf16 a[36:39], v[44:47], a[120:123], a[36:39]
    v_mfma_f32_16x16x32_bf16 a[40:43], v[44:47], a[124:127], a[40:43]
    v_mfma_f32_16x16x32_bf16 a[44:47], v[44:47], a[128:131], a[44:47]
    v_perm_b32 v44, v69, v65, s83
    v_perm_b32 v45, v77, v73, s83
    v_perm_b32 v46, v85, v81, s83
    v_perm_b32 v47, v93, v89, s83
    v_mfma_f32_16x16x32_bf16 a[48:51], v[48:51], a[120:123], a[48:51]
    v_mfma_f32_16x16x32_bf16 a[52:55], v[48:51], a[124:127], a[52:55]
    v_mfma_f32_16x16x32_bf16 a[56:59], v[48:51], a[128:131], a[56:59]
    v_perm_b32 v48, v70, v66, s82
    v_perm_b32 v49, v78, v74, s82
    v_perm_b32 v50, v86, v82, s82
    v_perm_b32 v51, v94, v90, s82
    v_mfma_f32_16x16x32_bf16 a[60:63], v[52:55], a[120:123], a[60:63]
    v_mfma_f32_16x16x32_bf16 a[64:67], v[52:55], a[124:127], a[64:67]
    v_mfma_f32_16x16x32_bf16 a[68:71], v[52:55], a[128:131], a[68:71]
    v_perm_b32 v52, v70, v66, s83
    v_perm_b32 v53, v78, v74, s83
    v_perm_b32 v54, v86, v82, s83
    v_perm_b32 v55, v94, v90, s83
    v_mfma_f32_16x16x32_bf16 a[72:75], v[56:59], a[120:123], a[72:75]
    v_mfma_f32_16x16x32_bf16 a[76:79], v[56:59], a[124:127], a[76:79]
    v_mfma_f32_16x16x32_bf16 a[80:83], v[56:59], a[128:131], a[80:83]
    v_perm_b32 v56, v71, v67, s82
    v_perm_b32 v57, v79, v75, s82
    v_perm_b32 v58, v87, v83, s82
    v_perm_b32 v59, v95, v91, s82
    v_mfma_f32_16x16x32_bf16 a[84:87], v[60:63], a[120:123], a[84:87]
    v_mfma_f32_16x16x32_bf16 a[88:91], v[60:63], a[124:127], a[88:91]
    v_mfma_f32_16x16x32_bf16 a[92:95], v[60:63], a[128:131], a[92:95]
    v_perm_b32 v60, v71, v67, s83
    v_perm_b32 v61, v79, v75, s83
    v_perm_b32 v62, v87, v83, s83
    v_perm_b32 v63, v95, v91, s83
    s_add_u32 s89, s71, 15
    s_and_b32 s89, s89, 15
    s_lshl_b32 s89, s89, 15
    s_add_u32 s77, s88, s89
    buffer_load_dwordx4 v[64:67], v30, s[60:63], s77 offen
    buffer_load_dwordx4 v[68:71], v30, s[60:63], s77 offen offset:1024
    buffer_load_dwordx4 v[72:75], v30, s[60:63], s77 offen offset:2048
    buffer_load_dwordx4 v[76:79], v30, s[60:63], s77 offen offset:3072
    buffer_load_dwordx4 v[80:83], v31, s[60:63], s77 offen
    buffer_load_dwordx4 v[84:87], v31, s[60:63], s77 offen offset:1024
    buffer_load_dwordx4 v[88:91], v31, s[60:63], s77 offen offset:2048
    buffer_load_dwordx4 v[92:95], v31, s[60:63], s77 offen offset:3072
    s_add_u32 s89, s71, 11
    s_and_b32 s92, s89, 3
    s_lshl_b32 s92, s92, 2
    s_bfe_u32 s89, s89, 0x20002
    s_lshl_b32 s89, s89, 8
    s_add_u32 s89, s89, 0
    v_add_u32 v7, s92, v2
    v_xor_b32 v7, v7, v4
    v_lshl_add_u32 v7, v7, 4, v5
    v_add_u32 v7, s89, v7
    ds_read_b128 a[120:123], v7
    ds_read_b128 a[124:127], v7 offset:16384
    ds_read_b128 a[128:131], v7 offset:32768
    s_waitcnt lgkmcnt(8)
    v_mfma_f32_16x16x32_bf16 a[0:3], v[32:35], a[96:99], a[0:3]
    s_waitcnt lgkmcnt(7)
    v_mfma_f32_16x16x32_bf16 a[4:7], v[32:35], a[100:103], a[4:7]
    s_waitcnt lgkmcnt(6)
    v_mfma_f32_16x16x32_bf16 a[8:11], v[32:35], a[104:107], a[8:11]
    s_waitcnt vmcnt(46)
    v_perm_b32 v32, v100, v96, s82
    s_waitcnt vmcnt(44)
    v_perm_b32 v33, v108, v104, s82
    s_waitcnt vmcnt(42)
    v_perm_b32 v34, v116, v112, s82
    s_waitcnt vmcnt(40)
    v_perm_b32 v35, v124, v120, s82
    v_mfma_f32_16x16x32_bf16 a[12:15], v[36:39], a[96:99], a[12:15]
    v_mfma_f32_16x16x32_bf16 a[16:19], v[36:39], a[100:103], a[16:19]
    v_mfma_f32_16x16x32_bf16 a[20:23], v[36:39], a[104:107], a[20:23]
    v_perm_b32 v36, v100, v96, s83
    v_perm_b32 v37, v108, v104, s83
    v_perm_b32 v38, v116, v112, s83
    v_perm_b32 v39, v124, v120, s83
    v_mfma_f32_16x16x32_bf16 a[24:27], v[40:43], a[96:99], a[24:27]
    v_mfma_f32_16x16x32_bf16 a[28:31], v[40:43], a[100:103], a[28:31]
    v_mfma_f32_16x16x32_bf16 a[32:35], v[40:43], a[104:107], a[32:35]
    v_perm_b32 v40, v101, v97, s82
    v_perm_b32 v41, v109, v105, s82
    v_perm_b32 v42, v117, v113, s82
    v_perm_b32 v43, v125, v121, s82
    v_mfma_f32_16x16x32_bf16 a[36:39], v[44:47], a[96:99], a[36:39]
    v_mfma_f32_16x16x32_bf16 a[40:43], v[44:47], a[100:103], a[40:43]
    v_mfma_f32_16x16x32_bf16 a[44:47], v[44:47], a[104:107], a[44:47]
    v_perm_b32 v44, v101, v97, s83
    v_perm_b32 v45, v109, v105, s83
    v_perm_b32 v46, v117, v113, s83
    v_perm_b32 v47, v125, v121, s83
    v_mfma_f32_16x16x32_bf16 a[48:51], v[48:51], a[96:99], a[48:51]
    v_mfma_f32_16x16x32_bf16 a[52:55], v[48:51], a[100:103], a[52:55]
    v_mfma_f32_16x16x32_bf16 a[56:59], v[48:51], a[104:107], a[56:59]
    v_perm_b32 v48, v102, v98, s82
    v_perm_b32 v49, v110, v106, s82
    v_perm_b32 v50, v118, v114, s82
    v_perm_b32 v51, v126, v122, s82
    v_mfma_f32_16x16x32_bf16 a[60:63], v[52:55], a[96:99], a[60:63]
    v_mfma_f32_16x16x32_bf16 a[64:67], v[52:55], a[100:103], a[64:67]
    v_mfma_f32_16x16x32_bf16 a[68:71], v[52:55], a[104:107], a[68:71]
    v_perm_b32 v52, v102, v98, s83
    v_perm_b32 v53, v110, v106, s83
    v_perm_b32 v54, v118, v114, s83
    v_perm_b32 v55, v126, v122, s83
    v_mfma_f32_16x16x32_bf16 a[72:75], v[56:59], a[96:99], a[72:75]
    v_mfma_f32_16x16x32_bf16 a[76:79], v[56:59], a[100:103], a[76:79]
    v_mfma_f32_16x16x32_bf16 a[80:83], v[56:59], a[104:107], a[80:83]
    v_perm_b32 v56, v103, v99, s82
    v_perm_b32 v57, v111, v107, s82
    v_perm_b32 v58, v119, v115, s82
    v_perm_b32 v59, v127, v123, s82
    v_mfma_f32_16x16x32_bf16 a[84:87], v[60:63], a[96:99], a[84:87]
    v_mfma_f32_16x16x32_bf16 a[88:91], v[60:63], a[100:103], a[88:91]
    v_mfma_f32_16x16x32_bf16 a[92:95], v[60:63], a[104:107], a[92:95]
    v_perm_b32 v60, v103, v99, s83
    v_perm_b32 v61, v111, v107, s83
    v_perm_b32 v62, v119, v115, s83
    v_perm_b32 v63, v127, v123, s83
    s_add_u32 s89, s71, 12
    s_and_b32 s92, s89, 3
    s_lshl_b32 s92, s92, 2
    s_bfe_u32 s89, s89, 0x20002
    s_lshl_b32 s89, s89, 8
    s_add_u32 s89, s89, 0
    v_add_u32 v6, s92, v2
    v_xor_b32 v6, v6, v4
    v_lshl_add_u32 v6, v6, 4, v5
    v_add_u32 v6, s89, v6
    ds_read_b128 a[96:99], v6
    ds_read_b128 a[100:103], v6 offset:16384
    ds_read_b128 a[104:107], v6 offset:32768
    s_waitcnt lgkmcnt(8)
    v_mfma_f32_16x16x32_bf16 a[0:3], v[32:35], a[108:111], a[0:3]
    s_waitcnt lgkmcnt(7)
    v_mfma_f32_16x16x32_bf16 a[4:7], v[32:35], a[112:115], a[4:7]
    s_waitcnt lgkmcnt(6)
    v_mfma_f32_16x16x32_bf16 a[8:11], v[32:35], a[116:119], a[8:11]
    s_waitcnt vmcnt(38)
    v_perm_b32 v32, v132, v128, s82
    s_waitcnt vmcnt(36)
    v_perm_b32 v33, v140, v136, s82
    s_waitcnt vmcnt(34)
    v_perm_b32 v34, v148, v144, s82
    s_waitcnt vmcnt(32)
    v_perm_b32 v35, v156, v152, s82
    v_mfma_f32_16x16x32_bf16 a[12:15], v[36:39], a[108:111], a[12:15]
    v_mfma_f32_16x16x32_bf16 a[16:19], v[36:39], a[112:115], a[16:19]
    v_mfma_f32_16x16x32_bf16 a[20:23], v[36:39], a[116:119], a[20:23]
    v_perm_b32 v36, v132, v128, s83
    v_perm_b32 v37, v140, v136, s83
    v_perm_b32 v38, v148, v144, s83
    v_perm_b32 v39, v156, v152, s83
    v_mfma_f32_16x16x32_bf16 a[24:27], v[40:43], a[108:111], a[24:27]
    v_mfma_f32_16x16x32_bf16 a[28:31], v[40:43], a[112:115], a[28:31]
    v_mfma_f32_16x16x32_bf16 a[32:35], v[40:43], a[116:119], a[32:35]
    v_perm_b32 v40, v133, v129, s82
    v_perm_b32 v41, v141, v137, s82
    v_perm_b32 v42, v149, v145, s82
    v_perm_b32 v43, v157, v153, s82
    v_mfma_f32_16x16x32_bf16 a[36:39], v[44:47], a[108:111], a[36:39]
    v_mfma_f32_16x16x32_bf16 a[40:43], v[44:47], a[112:115], a[40:43]
    v_mfma_f32_16x16x32_bf16 a[44:47], v[44:47], a[116:119], a[44:47]
    v_perm_b32 v44, v133, v129, s83
    v_perm_b32 v45, v141, v137, s83
    v_perm_b32 v46, v149, v145, s83
    v_perm_b32 v47, v157, v153, s83
    v_mfma_f32_16x16x32_bf16 a[48:51], v[48:51], a[108:111], a[48:51]
    v_mfma_f32_16x16x32_bf16 a[52:55], v[48:51], a[112:115], a[52:55]
    v_mfma_f32_16x16x32_bf16 a[56:59], v[48:51], a[116:119], a[56:59]
    v_perm_b32 v48, v134, v130, s82
    v_perm_b32 v49, v142, v138, s82
    v_perm_b32 v50, v150, v146, s82
    v_perm_b32 v51, v158, v154, s82
    v_mfma_f32_16x16x32_bf16 a[60:63], v[52:55], a[108:111], a[60:63]
    v_mfma_f32_16x16x32_bf16 a[64:67], v[52:55], a[112:115], a[64:67]
    v_mfma_f32_16x16x32_bf16 a[68:71], v[52:55], a[116:119], a[68:71]
    v_perm_b32 v52, v134, v130, s83
    v_perm_b32 v53, v142, v138, s83
    v_perm_b32 v54, v150, v146, s83
    v_perm_b32 v55, v158, v154, s83
    v_mfma_f32_16x16x32_bf16 a[72:75], v[56:59], a[108:111], a[72:75]
    v_mfma_f32_16x16x32_bf16 a[76:79], v[56:59], a[112:115], a[76:79]
    v_mfma_f32_16x16x32_bf16 a[80:83], v[56:59], a[116:119], a[80:83]
    v_perm_b32 v56, v135, v131, s82
    v_perm_b32 v57, v143, v139, s82
    v_perm_b32 v58, v151, v147, s82
    v_perm_b32 v59, v159, v155, s82
    v_mfma_f32_16x16x32_bf16 a[84:87], v[60:63], a[108:111], a[84:87]
    v_mfma_f32_16x16x32_bf16 a[88:91], v[60:63], a[112:115], a[88:91]
    v_mfma_f32_16x16x32_bf16 a[92:95], v[60:63], a[116:119], a[92:95]
    v_perm_b32 v60, v135, v131, s83
    v_perm_b32 v61, v143, v139, s83
    v_perm_b32 v62, v151, v147, s83
    v_perm_b32 v63, v159, v155, s83
    s_add_u32 s89, s71, 13
    s_and_b32 s92, s89, 3
    s_lshl_b32 s92, s92, 2
    s_bfe_u32 s89, s89, 0x20002
    s_lshl_b32 s89, s89, 8
    s_add_u32 s89, s89, 0
    v_add_u32 v7, s92, v2
    v_xor_b32 v7, v7, v4
    v_lshl_add_u32 v7, v7, 4, v5
    v_add_u32 v7, s89, v7
    ds_read_b128 a[108:111], v7
    ds_read_b128 a[112:115], v7 offset:16384
    ds_read_b128 a[116:119], v7 offset:32768
    s_waitcnt lgkmcnt(8)
    v_mfma_f32_16x16x32_bf16 a[0:3], v[32:35], a[120:123], a[0:3]
    s_waitcnt lgkmcnt(7)
    v_mfma_f32_16x16x32_bf16 a[4:7], v[32:35], a[124:127], a[4:7]
    s_waitcnt lgkmcnt(6)
    v_mfma_f32_16x16x32_bf16 a[8:11], v[32:35], a[128:131], a[8:11]
    s_waitcnt vmcnt(30)
    v_perm_b32 v32, v164, v160, s82
    s_waitcnt vmcnt(28)
    v_perm_b32 v33, v172, v168, s82
    s_waitcnt vmcnt(26)
    v_perm_b32 v34, v180, v176, s82
    s_waitcnt vmcnt(24)
    v_perm_b32 v35, v188, v184, s82
    v_mfma_f32_16x16x32_bf16 a[12:15], v[36:39], a[120:123], a[12:15]
    v_mfma_f32_16x16x32_bf16 a[16:19], v[36:39], a[124:127], a[16:19]
    v_mfma_f32_16x16x32_bf16 a[20:23], v[36:39], a[128:131], a[20:23]
    v_perm_b32 v36, v164, v160, s83
    v_perm_b32 v37, v172, v168, s83
    v_perm_b32 v38, v180, v176, s83
    v_perm_b32 v39, v188, v184, s83
    v_mfma_f32_16x16x32_bf16 a[24:27], v[40:43], a[120:123], a[24:27]
    v_mfma_f32_16x16x32_bf16 a[28:31], v[40:43], a[124:127], a[28:31]
    v_mfma_f32_16x16x32_bf16 a[32:35], v[40:43], a[128:131], a[32:35]
    v_perm_b32 v40, v165, v161, s82
    v_perm_b32 v41, v173, v169, s82
    v_perm_b32 v42, v181, v177, s82
    v_perm_b32 v43, v189, v185, s82
    v_mfma_f32_16x16x32_bf16 a[36:39], v[44:47], a[120:123], a[36:39]
    v_mfma_f32_16x16x32_bf16 a[40:43], v[44:47], a[124:127], a[40:43]
    v_mfma_f32_16x16x32_bf16 a[44:47], v[44:47], a[128:131], a[44:47]
    v_perm_b32 v44, v165, v161, s83
    v_perm_b32 v45, v173, v169, s83
    v_perm_b32 v46, v181, v177, s83
    v_perm_b32 v47, v189, v185, s83
    v_mfma_f32_16x16x32_bf16 a[48:51], v[48:51], a[120:123], a[48:51]
    v_mfma_f32_16x16x32_bf16 a[52:55], v[48:51], a[124:127], a[52:55]
    v_mfma_f32_16x16x32_bf16 a[56:59], v[48:51], a[128:131], a[56:59]
    v_perm_b32 v48, v166, v162, s82
    v_perm_b32 v49, v174, v170, s82
    v_perm_b32 v50, v182, v178, s82
    v_perm_b32 v51, v190, v186, s82
    v_mfma_f32_16x16x32_bf16 a[60:63], v[52:55], a[120:123], a[60:63]
    v_mfma_f32_16x16x32_bf16 a[64:67], v[52:55], a[124:127], a[64:67]
    v_mfma_f32_16x16x32_bf16 a[68:71], v[52:55], a[128:131], a[68:71]
    v_perm_b32 v52, v166, v162, s83
    v_perm_b32 v53, v174, v170, s83
    v_perm_b32 v54, v182, v178, s83
    v_perm_b32 v55, v190, v186, s83
    v_mfma_f32_16x16x32_bf16 a[72:75], v[56:59], a[120:123], a[72:75]
    v_mfma_f32_16x16x32_bf16 a[76:79], v[56:59], a[124:127], a[76:79]
    v_mfma_f32_16x16x32_bf16 a[80:83], v[56:59], a[128:131], a[80:83]
    v_perm_b32 v56, v167, v163, s82
    v_perm_b32 v57, v175, v171, s82
    v_perm_b32 v58, v183, v179, s82
    v_perm_b32 v59, v191, v187, s82
    v_mfma_f32_16x16x32_bf16 a[84:87], v[60:63], a[120:123], a[84:87]
    v_mfma_f32_16x16x32_bf16 a[88:91], v[60:63], a[124:127], a[88:91]
    v_mfma_f32_16x16x32_bf16 a[92:95], v[60:63], a[128:131], a[92:95]
    v_perm_b32 v60, v167, v163, s83
    v_perm_b32 v61, v175, v171, s83
    v_perm_b32 v62, v183, v179, s83
    v_perm_b32 v63, v191, v187, s83
    s_add_u32 s89, s71, 14
    s_and_b32 s92, s89, 3
    s_lshl_b32 s92, s92, 2
    s_bfe_u32 s89, s89, 0x20002
    s_lshl_b32 s89, s89, 8
    s_add_u32 s89, s89, 0
    v_add_u32 v6, s92, v2
    v_xor_b32 v6, v6, v4
    v_lshl_add_u32 v6, v6, 4, v5
    v_add_u32 v6, s89, v6
    ds_read_b128 a[120:123], v6
    ds_read_b128 a[124:127], v6 offset:16384
    ds_read_b128 a[128:131], v6 offset:32768
    s_waitcnt lgkmcnt(8)
    v_mfma_f32_16x16x32_bf16 a[0:3], v[32:35], a[96:99], a[0:3]
    s_waitcnt lgkmcnt(7)
    v_mfma_f32_16x16x32_bf16 a[4:7], v[32:35], a[100:103], a[4:7]
    s_waitcnt lgkmcnt(6)
    v_mfma_f32_16x16x32_bf16 a[8:11], v[32:35], a[104:107], a[8:11]
    s_waitcnt vmcnt(22)
    v_perm_b32 v32, v196, v192, s82
    s_waitcnt vmcnt(20)
    v_perm_b32 v33, v204, v200, s82
    s_waitcnt vmcnt(18)
    v_perm_b32 v34, v212, v208, s82
    s_waitcnt vmcnt(16)
    v_perm_b32 v35, v220, v216, s82
    v_mfma_f32_16x16x32_bf16 a[12:15], v[36:39], a[96:99], a[12:15]
    v_mfma_f32_16x16x32_bf16 a[16:19], v[36:39], a[100:103], a[16:19]
    v_mfma_f32_16x16x32_bf16 a[20:23], v[36:39], a[104:107], a[20:23]
    v_perm_b32 v36, v196, v192, s83
    v_perm_b32 v37, v204, v200, s83
    v_perm_b32 v38, v212, v208, s83
    v_perm_b32 v39, v220, v216, s83
    v_mfma_f32_16x16x32_bf16 a[24:27], v[40:43], a[96:99], a[24:27]
    v_mfma_f32_16x16x32_bf16 a[28:31], v[40:43], a[100:103], a[28:31]
    v_mfma_f32_16x16x32_bf16 a[32:35], v[40:43], a[104:107], a[32:35]
    v_perm_b32 v40, v197, v193, s82
    v_perm_b32 v41, v205, v201, s82
    v_perm_b32 v42, v213, v209, s82
    v_perm_b32 v43, v221, v217, s82
    v_mfma_f32_16x16x32_bf16 a[36:39], v[44:47], a[96:99], a[36:39]
    v_mfma_f32_16x16x32_bf16 a[40:43], v[44:47], a[100:103], a[40:43]
    v_mfma_f32_16x16x32_bf16 a[44:47], v[44:47], a[104:107], a[44:47]
    v_perm_b32 v44, v197, v193, s83
    v_perm_b32 v45, v205, v201, s83
    v_perm_b32 v46, v213, v209, s83
    v_perm_b32 v47, v221, v217, s83
    v_mfma_f32_16x16x32_bf16 a[48:51], v[48:51], a[96:99], a[48:51]
    v_mfma_f32_16x16x32_bf16 a[52:55], v[48:51], a[100:103], a[52:55]
    v_mfma_f32_16x16x32_bf16 a[56:59], v[48:51], a[104:107], a[56:59]
    v_perm_b32 v48, v198, v194, s82
    v_perm_b32 v49, v206, v202, s82
    v_perm_b32 v50, v214, v210, s82
    v_perm_b32 v51, v222, v218, s82
    v_mfma_f32_16x16x32_bf16 a[60:63], v[52:55], a[96:99], a[60:63]
    v_mfma_f32_16x16x32_bf16 a[64:67], v[52:55], a[100:103], a[64:67]
    v_mfma_f32_16x16x32_bf16 a[68:71], v[52:55], a[104:107], a[68:71]
    v_perm_b32 v52, v198, v194, s83
    v_perm_b32 v53, v206, v202, s83
    v_perm_b32 v54, v214, v210, s83
    v_perm_b32 v55, v222, v218, s83
    v_mfma_f32_16x16x32_bf16 a[72:75], v[56:59], a[96:99], a[72:75]
    v_mfma_f32_16x16x32_bf16 a[76:79], v[56:59], a[100:103], a[76:79]
    v_mfma_f32_16x16x32_bf16 a[80:83], v[56:59], a[104:107], a[80:83]
    v_perm_b32 v56, v199, v195, s82
    v_perm_b32 v57, v207, v203, s82
    v_perm_b32 v58, v215, v211, s82
    v_perm_b32 v59, v223, v219, s82
    v_mfma_f32_16x16x32_bf16 a[84:87], v[60:63], a[96:99], a[84:87]
    v_mfma_f32_16x16x32_bf16 a[88:91], v[60:63], a[100:103], a[88:91]
    v_mfma_f32_16x16x32_bf16 a[92:95], v[60:63], a[104:107], a[92:95]
    v_perm_b32 v60, v199, v195, s83
    v_perm_b32 v61, v207, v203, s83
    v_perm_b32 v62, v215, v211, s83
    v_perm_b32 v63, v223, v219, s83
    s_add_u32 s89, s71, 15
    s_and_b32 s92, s89, 3
    s_lshl_b32 s92, s92, 2
    s_bfe_u32 s89, s89, 0x20002
    s_lshl_b32 s89, s89, 8
    s_add_u32 s89, s89, 0
    v_add_u32 v7, s92, v2
    v_xor_b32 v7, v7, v4
    v_lshl_add_u32 v7, v7, 4, v5
    v_add_u32 v7, s89, v7
    ds_read_b128 a[96:99], v7
    ds_read_b128 a[100:103], v7 offset:16384
    ds_read_b128 a[104:107], v7 offset:32768
    s_waitcnt lgkmcnt(8)
    v_mfma_f32_16x16x32_bf16 a[0:3], v[32:35], a[108:111], a[0:3]
    s_waitcnt lgkmcnt(7)
    v_mfma_f32_16x16x32_bf16 a[4:7], v[32:35], a[112:115], a[4:7]
    s_waitcnt lgkmcnt(6)
    v_mfma_f32_16x16x32_bf16 a[8:11], v[32:35], a[116:119], a[8:11]
    s_waitcnt vmcnt(14)
    v_perm_b32 v32, v228, v224, s82
    s_waitcnt vmcnt(12)
    v_perm_b32 v33, v236, v232, s82
    s_waitcnt vmcnt(10)
    v_perm_b32 v34, v244, v240, s82
    s_waitcnt vmcnt(8)
    v_perm_b32 v35, v252, v248, s82
    v_mfma_f32_16x16x32_bf16 a[12:15], v[36:39], a[108:111], a[12:15]
    v_mfma_f32_16x16x32_bf16 a[16:19], v[36:39], a[112:115], a[16:19]
    v_mfma_f32_16x16x32_bf16 a[20:23], v[36:39], a[116:119], a[20:23]
    v_perm_b32 v36, v228, v224, s83
    v_perm_b32 v37, v236, v232, s83
    v_perm_b32 v38, v244, v240, s83
    v_perm_b32 v39, v252, v248, s83
    v_mfma_f32_16x16x32_bf16 a[24:27], v[40:43], a[108:111], a[24:27]
    v_mfma_f32_16x16x32_bf16 a[28:31], v[40:43], a[112:115], a[28:31]
    v_mfma_f32_16x16x32_bf16 a[32:35], v[40:43], a[116:119], a[32:35]
    v_perm_b32 v40, v229, v225, s82
    v_perm_b32 v41, v237, v233, s82
    v_perm_b32 v42, v245, v241, s82
    v_perm_b32 v43, v253, v249, s82
    v_mfma_f32_16x16x32_bf16 a[36:39], v[44:47], a[108:111], a[36:39]
    v_mfma_f32_16x16x32_bf16 a[40:43], v[44:47], a[112:115], a[40:43]
    v_mfma_f32_16x16x32_bf16 a[44:47], v[44:47], a[116:119], a[44:47]
    v_perm_b32 v44, v229, v225, s83
    v_perm_b32 v45, v237, v233, s83
    v_perm_b32 v46, v245, v241, s83
    v_perm_b32 v47, v253, v249, s83
    v_mfma_f32_16x16x32_bf16 a[48:51], v[48:51], a[108:111], a[48:51]
    v_mfma_f32_16x16x32_bf16 a[52:55], v[48:51], a[112:115], a[52:55]
    v_mfma_f32_16x16x32_bf16 a[56:59], v[48:51], a[116:119], a[56:59]
    v_perm_b32 v48, v230, v226, s82
    v_perm_b32 v49, v238, v234, s82
    v_perm_b32 v50, v246, v242, s82
    v_perm_b32 v51, v254, v250, s82
    v_mfma_f32_16x16x32_bf16 a[60:63], v[52:55], a[108:111], a[60:63]
    v_mfma_f32_16x16x32_bf16 a[64:67], v[52:55], a[112:115], a[64:67]
    v_mfma_f32_16x16x32_bf16 a[68:71], v[52:55], a[116:119], a[68:71]
    v_perm_b32 v52, v230, v226, s83
    v_perm_b32 v53, v238, v234, s83
    v_perm_b32 v54, v246, v242, s83
    v_perm_b32 v55, v254, v250, s83
    v_mfma_f32_16x16x32_bf16 a[72:75], v[56:59], a[108:111], a[72:75]
    v_mfma_f32_16x16x32_bf16 a[76:79], v[56:59], a[112:115], a[76:79]
    v_mfma_f32_16x16x32_bf16 a[80:83], v[56:59], a[116:119], a[80:83]
    v_perm_b32 v56, v231, v227, s82
    v_perm_b32 v57, v239, v235, s82
    v_perm_b32 v58, v247, v243, s82
    v_perm_b32 v59, v255, v251, s82
    v_mfma_f32_16x16x32_bf16 a[84:87], v[60:63], a[108:111], a[84:87]
    v_mfma_f32_16x16x32_bf16 a[88:91], v[60:63], a[112:115], a[88:91]
    v_mfma_f32_16x16x32_bf16 a[92:95], v[60:63], a[116:119], a[92:95]
    v_perm_b32 v60, v231, v227, s83
    v_perm_b32 v61, v239, v235, s83
    v_perm_b32 v62, v247, v243, s83
    v_perm_b32 v63, v255, v251, s83
    s_waitcnt lgkmcnt(5)
    v_mfma_f32_16x16x32_bf16 a[0:3], v[32:35], a[120:123], a[0:3]
    s_waitcnt lgkmcnt(4)
    v_mfma_f32_16x16x32_bf16 a[4:7], v[32:35], a[124:127], a[4:7]
    s_waitcnt lgkmcnt(3)
    v_mfma_f32_16x16x32_bf16 a[8:11], v[32:35], a[128:131], a[8:11]
    s_waitcnt vmcnt(6)
    v_perm_b32 v32, v68, v64, s82
    s_waitcnt vmcnt(4)
    v_perm_b32 v33, v76, v72, s82
    s_waitcnt vmcnt(2)
    v_perm_b32 v34, v84, v80, s82
    s_waitcnt vmcnt(0)
    v_perm_b32 v35, v92, v88, s82
    v_mfma_f32_16x16x32_bf16 a[12:15], v[36:39], a[120:123], a[12:15]
    v_mfma_f32_16x16x32_bf16 a[16:19], v[36:39], a[124:127], a[16:19]
    v_mfma_f32_16x16x32_bf16 a[20:23], v[36:39], a[128:131], a[20:23]
    v_perm_b32 v36, v68, v64, s83
    v_perm_b32 v37, v76, v72, s83
    v_perm_b32 v38, v84, v80, s83
    v_perm_b32 v39, v92, v88, s83
    v_mfma_f32_16x16x32_bf16 a[24:27], v[40:43], a[120:123], a[24:27]
    v_mfma_f32_16x16x32_bf16 a[28:31], v[40:43], a[124:127], a[28:31]
    v_mfma_f32_16x16x32_bf16 a[32:35], v[40:43], a[128:131], a[32:35]
    v_perm_b32 v40, v69, v65, s82
    v_perm_b32 v41, v77, v73, s82
    v_perm_b32 v42, v85, v81, s82
    v_perm_b32 v43, v93, v89, s82
    v_mfma_f32_16x16x32_bf16 a[36:39], v[44:47], a[120:123], a[36:39]
    v_mfma_f32_16x16x32_bf16 a[40:43], v[44:47], a[124:127], a[40:43]
    v_mfma_f32_16x16x32_bf16 a[44:47], v[44:47], a[128:131], a[44:47]
    v_perm_b32 v44, v69, v65, s83
    v_perm_b32 v45, v77, v73, s83
    v_perm_b32 v46, v85, v81, s83
    v_perm_b32 v47, v93, v89, s83
    v_mfma_f32_16x16x32_bf16 a[48:51], v[48:51], a[120:123], a[48:51]
    v_mfma_f32_16x16x32_bf16 a[52:55], v[48:51], a[124:127], a[52:55]
    v_mfma_f32_16x16x32_bf16 a[56:59], v[48:51], a[128:131], a[56:59]
    v_perm_b32 v48, v70, v66, s82
    v_perm_b32 v49, v78, v74, s82
    v_perm_b32 v50, v86, v82, s82
    v_perm_b32 v51, v94, v90, s82
    v_mfma_f32_16x16x32_bf16 a[60:63], v[52:55], a[120:123], a[60:63]
    v_mfma_f32_16x16x32_bf16 a[64:67], v[52:55], a[124:127], a[64:67]
    v_mfma_f32_16x16x32_bf16 a[68:71], v[52:55], a[128:131], a[68:71]
    v_perm_b32 v52, v70, v66, s83
    v_perm_b32 v53, v78, v74, s83
    v_perm_b32 v54, v86, v82, s83
    v_perm_b32 v55, v94, v90, s83
    v_mfma_f32_16x16x32_bf16 a[72:75], v[56:59], a[120:123], a[72:75]
    v_mfma_f32_16x16x32_bf16 a[76:79], v[56:59], a[124:127], a[76:79]
    v_mfma_f32_16x16x32_bf16 a[80:83], v[56:59], a[128:131], a[80:83]
    v_perm_b32 v56, v71, v67, s82
    v_perm_b32 v57, v79, v75, s82
    v_perm_b32 v58, v87, v83, s82
    v_perm_b32 v59, v95, v91, s82
    v_mfma_f32_16x16x32_bf16 a[84:87], v[60:63], a[120:123], a[84:87]
    v_mfma_f32_16x16x32_bf16 a[88:91], v[60:63], a[124:127], a[88:91]
    v_mfma_f32_16x16x32_bf16 a[92:95], v[60:63], a[128:131], a[92:95]
    v_perm_b32 v60, v71, v67, s83
    v_perm_b32 v61, v79, v75, s83
    v_perm_b32 v62, v87, v83, s83
    v_perm_b32 v63, v95, v91, s83
    s_waitcnt lgkmcnt(2)
    v_mfma_f32_16x16x32_bf16 a[0:3], v[32:35], a[96:99], a[0:3]
    s_waitcnt lgkmcnt(1)
    v_mfma_f32_16x16x32_bf16 a[4:7], v[32:35], a[100:103], a[4:7]
    s_waitcnt lgkmcnt(0)
    v_mfma_f32_16x16x32_bf16 a[8:11], v[32:35], a[104:107], a[8:11]
    v_mfma_f32_16x16x32_bf16 a[12:15], v[36:39], a[96:99], a[12:15]
    v_mfma_f32_16x16x32_bf16 a[16:19], v[36:39], a[100:103], a[16:19]
    v_mfma_f32_16x16x32_bf16 a[20:23], v[36:39], a[104:107], a[20:23]
    v_mfma_f32_16x16x32_bf16 a[24:27], v[40:43], a[96:99], a[24:27]
    v_mfma_f32_16x16x32_bf16 a[28:31], v[40:43], a[100:103], a[28:31]
    v_mfma_f32_16x16x32_bf16 a[32:35], v[40:43], a[104:107], a[32:35]
    v_mfma_f32_16x16x32_bf16 a[36:39], v[44:47], a[96:99], a[36:39]
    v_mfma_f32_16x16x32_bf16 a[40:43], v[44:47], a[100:103], a[40:43]
    v_mfma_f32_16x16x32_bf16 a[44:47], v[44:47], a[104:107], a[44:47]
    v_mfma_f32_16x16x32_bf16 a[48:51], v[48:51], a[96:99], a[48:51]
    v_mfma_f32_16x16x32_bf16 a[52:55], v[48:51], a[100:103], a[52:55]
    v_mfma_f32_16x16x32_bf16 a[56:59], v[48:51], a[104:107], a[56:59]
    v_mfma_f32_16x16x32_bf16 a[60:63], v[52:55], a[96:99], a[60:63]
    v_mfma_f32_16x16x32_bf16 a[64:67], v[52:55], a[100:103], a[64:67]
    v_mfma_f32_16x16x32_bf16 a[68:71], v[52:55], a[104:107], a[68:71]
    v_mfma_f32_16x16x32_bf16 a[72:75], v[56:59], a[96:99], a[72:75]
    v_mfma_f32_16x16x32_bf16 a[76:79], v[56:59], a[100:103], a[76:79]
    v_mfma_f32_16x16x32_bf16 a[80:83], v[56:59], a[104:107], a[80:83]
    v_mfma_f32_16x16x32_bf16 a[84:87], v[60:63], a[96:99], a[84:87]
    v_mfma_f32_16x16x32_bf16 a[88:91], v[60:63], a[100:103], a[88:91]
    v_mfma_f32_16x16x32_bf16 a[92:95], v[60:63], a[104:107], a[92:95]
    v_and_b32 v6, 63, v0
    v_lshlrev_b32 v6, 4, v6
    v_accvgpr_read_b32 v64, a0
    v_accvgpr_read_b32 v65, a12
    v_accvgpr_read_b32 v66, a24
    v_accvgpr_read_b32 v67, a36
    v_accvgpr_read_b32 v68, a48
    v_accvgpr_read_b32 v69, a60
    v_accvgpr_read_b32 v70, a72
    v_accvgpr_read_b32 v71, a84
    v_cvt_pk_bf16_f32 v72, v64, v65
    v_cvt_pk_bf16_f32 v73, v66, v67
    v_cvt_pk_bf16_f32 v74, v68, v69
    v_cvt_pk_bf16_f32 v75, v70, v71
    buffer_store_dwordx4 v[72:75], v6, s[64:67], s85 offen sc0 sc1
    v_accvgpr_read_b32 v76, a1
    v_accvgpr_read_b32 v77, a13
    v_accvgpr_read_b32 v78, a25
    v_accvgpr_read_b32 v79, a37
    v_accvgpr_read_b32 v80, a49
    v_accvgpr_read_b32 v81, a61
    v_accvgpr_read_b32 v82, a73
    v_accvgpr_read_b32 v83, a85
    v_cvt_pk_bf16_f32 v84, v76, v77
    v_cvt_pk_bf16_f32 v85, v78, v79
    v_cvt_pk_bf16_f32 v86, v80, v81
    v_cvt_pk_bf16_f32 v87, v82, v83
    buffer_store_dwordx4 v[84:87], v6, s[64:67], s85 offen offset:1024 sc0 sc1
    v_accvgpr_read_b32 v88, a2
    v_accvgpr_read_b32 v89, a14
    v_accvgpr_read_b32 v90, a26
    v_accvgpr_read_b32 v91, a38
    v_accvgpr_read_b32 v92, a50
    v_accvgpr_read_b32 v93, a62
    v_accvgpr_read_b32 v94, a74
    v_accvgpr_read_b32 v95, a86
    v_cvt_pk_bf16_f32 v96, v88, v89
    v_cvt_pk_bf16_f32 v97, v90, v91
    v_cvt_pk_bf16_f32 v98, v92, v93
    v_cvt_pk_bf16_f32 v99, v94, v95
    buffer_store_dwordx4 v[96:99], v6, s[64:67], s85 offen offset:2048 sc0 sc1
    v_accvgpr_read_b32 v100, a3
    v_accvgpr_read_b32 v101, a15
    v_accvgpr_read_b32 v102, a27
    v_accvgpr_read_b32 v103, a39
    v_accvgpr_read_b32 v104, a51
    v_accvgpr_read_b32 v105, a63
    v_accvgpr_read_b32 v106, a75
    v_accvgpr_read_b32 v107, a87
    v_cvt_pk_bf16_f32 v108, v100, v101
    v_cvt_pk_bf16_f32 v109, v102, v103
    v_cvt_pk_bf16_f32 v110, v104, v105
    v_cvt_pk_bf16_f32 v111, v106, v107
    buffer_store_dwordx4 v[108:111], v6, s[64:67], s85 offen offset:3072 sc0 sc1
    v_accvgpr_read_b32 v64, a4
    v_accvgpr_read_b32 v65, a16
    v_accvgpr_read_b32 v66, a28
    v_accvgpr_read_b32 v67, a40
    v_accvgpr_read_b32 v68, a52
    v_accvgpr_read_b32 v69, a64
    v_accvgpr_read_b32 v70, a76
    v_accvgpr_read_b32 v71, a88
    v_cvt_pk_bf16_f32 v72, v64, v65
    v_cvt_pk_bf16_f32 v73, v66, v67
    v_cvt_pk_bf16_f32 v74, v68, v69
    v_cvt_pk_bf16_f32 v75, v70, v71
    s_add_u32 s85, s85, 0x1000
    buffer_store_dwordx4 v[72:75], v6, s[64:67], s85 offen sc0 sc1
    v_accvgpr_read_b32 v76, a5
    v_accvgpr_read_b32 v77, a17
    v_accvgpr_read_b32 v78, a29
    v_accvgpr_read_b32 v79, a41
    v_accvgpr_read_b32 v80, a53
    v_accvgpr_read_b32 v81, a65
    v_accvgpr_read_b32 v82, a77
    v_accvgpr_read_b32 v83, a89
    v_cvt_pk_bf16_f32 v84, v76, v77
    v_cvt_pk_bf16_f32 v85, v78, v79
    v_cvt_pk_bf16_f32 v86, v80, v81
    v_cvt_pk_bf16_f32 v87, v82, v83
    buffer_store_dwordx4 v[84:87], v6, s[64:67], s85 offen offset:1024 sc0 sc1
    v_accvgpr_read_b32 v88, a6
    v_accvgpr_read_b32 v89, a18
    v_accvgpr_read_b32 v90, a30
    v_accvgpr_read_b32 v91, a42
    v_accvgpr_read_b32 v92, a54
    v_accvgpr_read_b32 v93, a66
    v_accvgpr_read_b32 v94, a78
    v_accvgpr_read_b32 v95, a90
    v_cvt_pk_bf16_f32 v96, v88, v89
    v_cvt_pk_bf16_f32 v97, v90, v91
    v_cvt_pk_bf16_f32 v98, v92, v93
    v_cvt_pk_bf16_f32 v99, v94, v95
    buffer_store_dwordx4 v[96:99], v6, s[64:67], s85 offen offset:2048 sc0 sc1
    v_accvgpr_read_b32 v100, a7
    v_accvgpr_read_b32 v101, a19
    v_accvgpr_read_b32 v102, a31
    v_accvgpr_read_b32 v103, a43
    v_accvgpr_read_b32 v104, a55
    v_accvgpr_read_b32 v105, a67
    v_accvgpr_read_b32 v106, a79
    v_accvgpr_read_b32 v107, a91
    v_cvt_pk_bf16_f32 v108, v100, v101
    v_cvt_pk_bf16_f32 v109, v102, v103
    v_cvt_pk_bf16_f32 v110, v104, v105
    v_cvt_pk_bf16_f32 v111, v106, v107
    buffer_store_dwordx4 v[108:111], v6, s[64:67], s85 offen offset:3072 sc0 sc1
    v_accvgpr_read_b32 v64, a8
    v_accvgpr_read_b32 v65, a20
    v_accvgpr_read_b32 v66, a32
    v_accvgpr_read_b32 v67, a44
    v_accvgpr_read_b32 v68, a56
    v_accvgpr_read_b32 v69, a68
    v_accvgpr_read_b32 v70, a80
    v_accvgpr_read_b32 v71, a92
    v_cvt_pk_bf16_f32 v72, v64, v65
    v_cvt_pk_bf16_f32 v73, v66, v67
    v_cvt_pk_bf16_f32 v74, v68, v69
    v_cvt_pk_bf16_f32 v75, v70, v71
    s_add_u32 s85, s85, 0x1000
    buffer_store_dwordx4 v[72:75], v6, s[64:67], s85 offen sc0 sc1
    v_accvgpr_read_b32 v76, a9
    v_accvgpr_read_b32 v77, a21
    v_accvgpr_read_b32 v78, a33
    v_accvgpr_read_b32 v79, a45
    v_accvgpr_read_b32 v80, a57
    v_accvgpr_read_b32 v81, a69
    v_accvgpr_read_b32 v82, a81
    v_accvgpr_read_b32 v83, a93
    v_cvt_pk_bf16_f32 v84, v76, v77
    v_cvt_pk_bf16_f32 v85, v78, v79
    v_cvt_pk_bf16_f32 v86, v80, v81
    v_cvt_pk_bf16_f32 v87, v82, v83
    buffer_store_dwordx4 v[84:87], v6, s[64:67], s85 offen offset:1024 sc0 sc1
    v_accvgpr_read_b32 v88, a10
    v_accvgpr_read_b32 v89, a22
    v_accvgpr_read_b32 v90, a34
    v_accvgpr_read_b32 v91, a46
    v_accvgpr_read_b32 v92, a58
    v_accvgpr_read_b32 v93, a70
    v_accvgpr_read_b32 v94, a82
    v_accvgpr_read_b32 v95, a94
    v_cvt_pk_bf16_f32 v96, v88, v89
    v_cvt_pk_bf16_f32 v97, v90, v91
    v_cvt_pk_bf16_f32 v98, v92, v93
    v_cvt_pk_bf16_f32 v99, v94, v95
    buffer_store_dwordx4 v[96:99], v6, s[64:67], s85 offen offset:2048 sc0 sc1
    v_accvgpr_read_b32 v100, a11
    v_accvgpr_read_b32 v101, a23
    v_accvgpr_read_b32 v102, a35
    v_accvgpr_read_b32 v103, a47
    v_accvgpr_read_b32 v104, a59
    v_accvgpr_read_b32 v105, a71
    v_accvgpr_read_b32 v106, a83
    v_accvgpr_read_b32 v107, a95
    v_cvt_pk_bf16_f32 v108, v100, v101
    v_cvt_pk_bf16_f32 v109, v102, v103
    v_cvt_pk_bf16_f32 v110, v104, v105
    v_cvt_pk_bf16_f32 v111, v106, v107
    buffer_store_dwordx4 v[108:111], v6, s[64:67], s85 offen offset:3072 sc0 sc1
L_exit:
    s_endpgm
L_slow0:
    s_nop 7
    s_nop 7
    v_and_b32 v254, 63, v0
    v_xor_b32 v252, 16, v254
    v_lshlrev_b32 v252, 2, v252
    v_xor_b32 v253, 32, v254
    v_lshlrev_b32 v253, 2, v253
    v_max3_f32 v248, v112, v113, v114
    v_max3_f32 v248, v248, v115, v124
    v_max3_f32 v248, v248, v125, v126
    v_max3_f32 v248, v248, v127, v136
    v_max3_f32 v248, v248, v137, v138
    v_max3_f32 v248, v248, v139, v148
    v_max3_f32 v248, v248, v149, v150
    v_max_f32 v248, v248, v151
    ds_bpermute_b32 v255, v252, v248
    s_waitcnt lgkmcnt(0)
    v_max_f32 v248, v248, v255
    ds_bpermute_b32 v255, v253, v248
    s_waitcnt lgkmcnt(0)
    v_max_f32 v248, v248, v255
    v_max_f32 v248, 0, v248
    v_sub_f32 v112, v112, v248
    v_sub_f32 v113, v113, v248
    v_sub_f32 v114, v114, v248
    v_sub_f32 v115, v115, v248
    v_sub_f32 v124, v124, v248
    v_sub_f32 v125, v125, v248
    v_sub_f32 v126, v126, v248
    v_sub_f32 v127, v127, v248
    v_sub_f32 v136, v136, v248
    v_sub_f32 v137, v137, v248
    v_sub_f32 v138, v138, v248
    v_sub_f32 v139, v139, v248
    v_sub_f32 v148, v148, v248
    v_sub_f32 v149, v149, v248
    v_sub_f32 v150, v150, v248
    v_sub_f32 v151, v151, v248
    v_sub_f32 v32, v32, v248
    v_sub_f32 v33, v33, v248
    v_sub_f32 v34, v34, v248
    v_sub_f32 v35, v35, v248
    v_sub_f32 v255, 0, v248
    v_exp_f32 v255, v255
    v_accvgpr_read_b32 v254, a0
    v_mul_f32 v254, v254, v255
    v_accvgpr_write_b32 a0, v254
    v_accvgpr_read_b32 v254, a1
    v_mul_f32 v254, v254, v255
    v_accvgpr_write_b32 a1, v254
    v_accvgpr_read_b32 v254, a2
    v_mul_f32 v254, v254, v255
    v_accvgpr_write_b32 a2, v254
    v_accvgpr_read_b32 v254, a3
    v_mul_f32 v254, v254, v255
    v_accvgpr_write_b32 a3, v254
    v_accvgpr_read_b32 v254, a12
    v_mul_f32 v254, v254, v255
    v_accvgpr_write_b32 a12, v254
    v_accvgpr_read_b32 v254, a13
    v_mul_f32 v254, v254, v255
    v_accvgpr_write_b32 a13, v254
    v_accvgpr_read_b32 v254, a14
    v_mul_f32 v254, v254, v255
    v_accvgpr_write_b32 a14, v254
    v_accvgpr_read_b32 v254, a15
    v_mul_f32 v254, v254, v255
    v_accvgpr_write_b32 a15, v254
    v_accvgpr_read_b32 v254, a24
    v_mul_f32 v254, v254, v255
    v_accvgpr_write_b32 a24, v254
    v_accvgpr_read_b32 v254, a25
    v_mul_f32 v254, v254, v255
    v_accvgpr_write_b32 a25, v254
    v_accvgpr_read_b32 v254, a26
    v_mul_f32 v254, v254, v255
    v_accvgpr_write_b32 a26, v254
    v_accvgpr_read_b32 v254, a27
    v_mul_f32 v254, v254, v255
    v_accvgpr_write_b32 a27, v254
    v_accvgpr_read_b32 v254, a36
    v_mul_f32 v254, v254, v255
    v_accvgpr_write_b32 a36, v254
    v_accvgpr_read_b32 v254, a37
    v_mul_f32 v254, v254, v255
    v_accvgpr_write_b32 a37, v254
    v_accvgpr_read_b32 v254, a38
    v_mul_f32 v254, v254, v255
    v_accvgpr_write_b32 a38, v254
    v_accvgpr_read_b32 v254, a39
    v_mul_f32 v254, v254, v255
    v_accvgpr_write_b32 a39, v254
    v_accvgpr_read_b32 v254, a48
    v_mul_f32 v254, v254, v255
    v_accvgpr_write_b32 a48, v254
    v_accvgpr_read_b32 v254, a49
    v_mul_f32 v254, v254, v255
    v_accvgpr_write_b32 a49, v254
    v_accvgpr_read_b32 v254, a50
    v_mul_f32 v254, v254, v255
    v_accvgpr_write_b32 a50, v254
    v_accvgpr_read_b32 v254, a51
    v_mul_f32 v254, v254, v255
    v_accvgpr_write_b32 a51, v254
    v_accvgpr_read_b32 v254, a60
    v_mul_f32 v254, v254, v255
    v_accvgpr_write_b32 a60, v254
    v_accvgpr_read_b32 v254, a61
    v_mul_f32 v254, v254, v255
    v_accvgpr_write_b32 a61, v254
    v_accvgpr_read_b32 v254, a62
    v_mul_f32 v254, v254, v255
    v_accvgpr_write_b32 a62, v254
    v_accvgpr_read_b32 v254, a63
    v_mul_f32 v254, v254, v255
    v_accvgpr_write_b32 a63, v254
    v_accvgpr_read_b32 v254, a72
    v_mul_f32 v254, v254, v255
    v_accvgpr_write_b32 a72, v254
    v_accvgpr_read_b32 v254, a73
    v_mul_f32 v254, v254, v255
    v_accvgpr_write_b32 a73, v254
    v_accvgpr_read_b32 v254, a74
    v_mul_f32 v254, v254, v255
    v_accvgpr_write_b32 a74, v254
    v_accvgpr_read_b32 v254, a75
    v_mul_f32 v254, v254, v255
    v_accvgpr_write_b32 a75, v254
    v_accvgpr_read_b32 v254, a84
    v_mul_f32 v254, v254, v255
    v_accvgpr_write_b32 a84, v254
    v_accvgpr_read_b32 v254, a85
    v_mul_f32 v254, v254, v255
    v_accvgpr_write_b32 a85, v254
    v_accvgpr_read_b32 v254, a86
    v_mul_f32 v254, v254, v255
    v_accvgpr_write_b32 a86, v254
    v_accvgpr_read_b32 v254, a87
    v_mul_f32 v254, v254, v255
    v_accvgpr_write_b32 a87, v254
    v_accvgpr_read_b32 v254, a96
    v_mul_f32 v254, v254, v255
    v_accvgpr_write_b32 a96, v254
    v_accvgpr_read_b32 v254, a97
    v_mul_f32 v254, v254, v255
    v_accvgpr_write_b32 a97, v254
    v_accvgpr_read_b32 v254, a98
    v_mul_f32 v254, v254, v255
    v_accvgpr_write_b32 a98, v254
    v_accvgpr_read_b32 v254, a99
    v_mul_f32 v254, v254, v255
    v_accvgpr_write_b32 a99, v254
    v_max3_f32 v249, v116, v117, v118
    v_max3_f32 v249, v249, v119, v128
    v_max3_f32 v249, v249, v129, v130
    v_max3_f32 v249, v249, v131, v140
    v_max3_f32 v249, v249, v141, v142
    v_max3_f32 v249, v249, v143, v152
    v_max3_f32 v249, v249, v153, v154
    v_max_f32 v249, v249, v155
    ds_bpermute_b32 v255, v252, v249
    s_waitcnt lgkmcnt(0)
    v_max_f32 v249, v249, v255
    ds_bpermute_b32 v255, v253, v249
    s_waitcnt lgkmcnt(0)
    v_max_f32 v249, v249, v255
    v_max_f32 v249, 0, v249
    v_sub_f32 v116, v116, v249
    v_sub_f32 v117, v117, v249
    v_sub_f32 v118, v118, v249
    v_sub_f32 v119, v119, v249
    v_sub_f32 v128, v128, v249
    v_sub_f32 v129, v129, v249
    v_sub_f32 v130, v130, v249
    v_sub_f32 v131, v131, v249
    v_sub_f32 v140, v140, v249
    v_sub_f32 v141, v141, v249
    v_sub_f32 v142, v142, v249
    v_sub_f32 v143, v143, v249
    v_sub_f32 v152, v152, v249
    v_sub_f32 v153, v153, v249
    v_sub_f32 v154, v154, v249
    v_sub_f32 v155, v155, v249
    v_sub_f32 v36, v36, v249
    v_sub_f32 v37, v37, v249
    v_sub_f32 v38, v38, v249
    v_sub_f32 v39, v39, v249
    v_sub_f32 v255, 0, v249
    v_exp_f32 v255, v255
    v_accvgpr_read_b32 v254, a4
    v_mul_f32 v254, v254, v255
    v_accvgpr_write_b32 a4, v254
    v_accvgpr_read_b32 v254, a5
    v_mul_f32 v254, v254, v255
    v_accvgpr_write_b32 a5, v254
    v_accvgpr_read_b32 v254, a6
    v_mul_f32 v254, v254, v255
    v_accvgpr_write_b32 a6, v254
    v_accvgpr_read_b32 v254, a7
    v_mul_f32 v254, v254, v255
    v_accvgpr_write_b32 a7, v254
    v_accvgpr_read_b32 v254, a16
    v_mul_f32 v254, v254, v255
    v_accvgpr_write_b32 a16, v254
    v_accvgpr_read_b32 v254, a17
    v_mul_f32 v254, v254, v255
    v_accvgpr_write_b32 a17, v254
    v_accvgpr_read_b32 v254, a18
    v_mul_f32 v254, v254, v255
    v_accvgpr_write_b32 a18, v254
    v_accvgpr_read_b32 v254, a19
    v_mul_f32 v254, v254, v255
    v_accvgpr_write_b32 a19, v254
    v_accvgpr_read_b32 v254, a28
    v_mul_f32 v254, v254, v255
    v_accvgpr_write_b32 a28, v254
    v_accvgpr_read_b32 v254, a29
    v_mul_f32 v254, v254, v255
    v_accvgpr_write_b32 a29, v254
    v_accvgpr_read_b32 v254, a30
    v_mul_f32 v254, v254, v255
    v_accvgpr_write_b32 a30, v254
    v_accvgpr_read_b32 v254, a31
    v_mul_f32 v254, v254, v255
    v_accvgpr_write_b32 a31, v254
    v_accvgpr_read_b32 v254, a40
    v_mul_f32 v254, v254, v255
    v_accvgpr_write_b32 a40, v254
    v_accvgpr_read_b32 v254, a41
    v_mul_f32 v254, v254, v255
    v_accvgpr_write_b32 a41, v254
    v_accvgpr_read_b32 v254, a42
    v_mul_f32 v254, v254, v255
    v_accvgpr_write_b32 a42, v254
    v_accvgpr_read_b32 v254, a43
    v_mul_f32 v254, v254, v255
    v_accvgpr_write_b32 a43, v254
    v_accvgpr_read_b32 v254, a52
    v_mul_f32 v254, v254, v255
    v_accvgpr_write_b32 a52, v254
    v_accvgpr_read_b32 v254, a53
    v_mul_f32 v254, v254, v255
    v_accvgpr_write_b32 a53, v254
    v_accvgpr_read_b32 v254, a54
    v_mul_f32 v254, v254, v255
    v_accvgpr_write_b32 a54, v254
    v_accvgpr_read_b32 v254, a55
    v_mul_f32 v254, v254, v255
    v_accvgpr_write_b32 a55, v254
    v_accvgpr_read_b32 v254, a64
    v_mul_f32 v254, v254, v255
    v_accvgpr_write_b32 a64, v254
    v_accvgpr_read_b32 v254, a65
    v_mul_f32 v254, v254, v255
    v_accvgpr_write_b32 a65, v254
    v_accvgpr_read_b32 v254, a66
    v_mul_f32 v254, v254, v255
    v_accvgpr_write_b32 a66, v254
    v_accvgpr_read_b32 v254, a67
    v_mul_f32 v254, v254, v255
    v_accvgpr_write_b32 a67, v254
    v_accvgpr_read_b32 v254, a76
    v_mul_f32 v254, v254, v255
    v_accvgpr_write_b32 a76, v254
    v_accvgpr_read_b32 v254, a77
    v_mul_f32 v254, v254, v255
    v_accvgpr_write_b32 a77, v254
    v_accvgpr_read_b32 v254, a78
    v_mul_f32 v254, v254, v255
    v_accvgpr_write_b32 a78, v254
    v_accvgpr_read_b32 v254, a79
    v_mul_f32 v254, v254, v255
    v_accvgpr_write_b32 a79, v254
    v_accvgpr_read_b32 v254, a88
    v_mul_f32 v254, v254, v255
    v_accvgpr_write_b32 a88, v254
    v_accvgpr_read_b32 v254, a89
    v_mul_f32 v254, v254, v255
    v_accvgpr_write_b32 a89, v254
    v_accvgpr_read_b32 v254, a90
    v_mul_f32 v254, v254, v255
    v_accvgpr_write_b32 a90, v254
    v_accvgpr_read_b32 v254, a91
    v_mul_f32 v254, v254, v255
    v_accvgpr_write_b32 a91, v254
    v_accvgpr_read_b32 v254, a100
    v_mul_f32 v254, v254, v255
    v_accvgpr_write_b32 a100, v254
    v_accvgpr_read_b32 v254, a101
    v_mul_f32 v254, v254, v255
    v_accvgpr_write_b32 a101, v254
    v_accvgpr_read_b32 v254, a102
    v_mul_f32 v254, v254, v255
    v_accvgpr_write_b32 a102, v254
    v_accvgpr_read_b32 v254, a103
    v_mul_f32 v254, v254, v255
    v_accvgpr_write_b32 a103, v254
    v_max3_f32 v250, v120, v121, v122
    v_max3_f32 v250, v250, v123, v132
    v_max3_f32 v250, v250, v133, v134
    v_max3_f32 v250, v250, v135, v144
    v_max3_f32 v250, v250, v145, v146
    v_max3_f32 v250, v250, v147, v156
    v_max3_f32 v250, v250, v157, v158
    v_max_f32 v250, v250, v159
    ds_bpermute_b32 v255, v252, v250
    s_waitcnt lgkmcnt(0)
    v_max_f32 v250, v250, v255
    ds_bpermute_b32 v255, v253, v250
    s_waitcnt lgkmcnt(0)
    v_max_f32 v250, v250, v255
    v_max_f32 v250, 0, v250
    v_sub_f32 v120, v120, v250
    v_sub_f32 v121, v121, v250
    v_sub_f32 v122, v122, v250
    v_sub_f32 v123, v123, v250
    v_sub_f32 v132, v132, v250
    v_sub_f32 v133, v133, v250
    v_sub_f32 v134, v134, v250
    v_sub_f32 v135, v135, v250
    v_sub_f32 v144, v144, v250
    v_sub_f32 v145, v145, v250
    v_sub_f32 v146, v146, v250
    v_sub_f32 v147, v147, v250
    v_sub_f32 v156, v156, v250
    v_sub_f32 v157, v157, v250
    v_sub_f32 v158, v158, v250
    v_sub_f32 v159, v159, v250
    v_sub_f32 v40, v40, v250
    v_sub_f32 v41, v41, v250
    v_sub_f32 v42, v42, v250
    v_sub_f32 v43, v43, v250
    v_sub_f32 v255, 0, v250
    v_exp_f32 v255, v255
    v_accvgpr_read_b32 v254, a8
    v_mul_f32 v254, v254, v255
    v_accvgpr_write_b32 a8, v254
    v_accvgpr_read_b32 v254, a9
    v_mul_f32 v254, v254, v255
    v_accvgpr_write_b32 a9, v254
    v_accvgpr_read_b32 v254, a10
    v_mul_f32 v254, v254, v255
    v_accvgpr_write_b32 a10, v254
    v_accvgpr_read_b32 v254, a11
    v_mul_f32 v254, v254, v255
    v_accvgpr_write_b32 a11, v254
    v_accvgpr_read_b32 v254, a20
    v_mul_f32 v254, v254, v255
    v_accvgpr_write_b32 a20, v254
    v_accvgpr_read_b32 v254, a21
    v_mul_f32 v254, v254, v255
    v_accvgpr_write_b32 a21, v254
    v_accvgpr_read_b32 v254, a22
    v_mul_f32 v254, v254, v255
    v_accvgpr_write_b32 a22, v254
    v_accvgpr_read_b32 v254, a23
    v_mul_f32 v254, v254, v255
    v_accvgpr_write_b32 a23, v254
    v_accvgpr_read_b32 v254, a32
    v_mul_f32 v254, v254, v255
    v_accvgpr_write_b32 a32, v254
    v_accvgpr_read_b32 v254, a33
    v_mul_f32 v254, v254, v255
    v_accvgpr_write_b32 a33, v254
    v_accvgpr_read_b32 v254, a34
    v_mul_f32 v254, v254, v255
    v_accvgpr_write_b32 a34, v254
    v_accvgpr_read_b32 v254, a35
    v_mul_f32 v254, v254, v255
    v_accvgpr_write_b32 a35, v254
    v_accvgpr_read_b32 v254, a44
    v_mul_f32 v254, v254, v255
    v_accvgpr_write_b32 a44, v254
    v_accvgpr_read_b32 v254, a45
    v_mul_f32 v254, v254, v255
    v_accvgpr_write_b32 a45, v254
    v_accvgpr_read_b32 v254, a46
    v_mul_f32 v254, v254, v255
    v_accvgpr_write_b32 a46, v254
    v_accvgpr_read_b32 v254, a47
    v_mul_f32 v254, v254, v255
    v_accvgpr_write_b32 a47, v254
    v_accvgpr_read_b32 v254, a56
    v_mul_f32 v254, v254, v255
    v_accvgpr_write_b32 a56, v254
    v_accvgpr_read_b32 v254, a57
    v_mul_f32 v254, v254, v255
    v_accvgpr_write_b32 a57, v254
    v_accvgpr_read_b32 v254, a58
    v_mul_f32 v254, v254, v255
    v_accvgpr_write_b32 a58, v254
    v_accvgpr_read_b32 v254, a59
    v_mul_f32 v254, v254, v255
    v_accvgpr_write_b32 a59, v254
    v_accvgpr_read_b32 v254, a68
    v_mul_f32 v254, v254, v255
    v_accvgpr_write_b32 a68, v254
    v_accvgpr_read_b32 v254, a69
    v_mul_f32 v254, v254, v255
    v_accvgpr_write_b32 a69, v254
    v_accvgpr_read_b32 v254, a70
    v_mul_f32 v254, v254, v255
    v_accvgpr_write_b32 a70, v254
    v_accvgpr_read_b32 v254, a71
    v_mul_f32 v254, v254, v255
    v_accvgpr_write_b32 a71, v254
    v_accvgpr_read_b32 v254, a80
    v_mul_f32 v254, v254, v255
    v_accvgpr_write_b32 a80, v254
    v_accvgpr_read_b32 v254, a81
    v_mul_f32 v254, v254, v255
    v_accvgpr_write_b32 a81, v254
    v_accvgpr_read_b32 v254, a82
    v_mul_f32 v254, v254, v255
    v_accvgpr_write_b32 a82, v254
    v_accvgpr_read_b32 v254, a83
    v_mul_f32 v254, v254, v255
    v_accvgpr_write_b32 a83, v254
    v_accvgpr_read_b32 v254, a92
    v_mul_f32 v254, v254, v255
    v_accvgpr_write_b32 a92, v254
    v_accvgpr_read_b32 v254, a93
    v_mul_f32 v254, v254, v255
    v_accvgpr_write_b32 a93, v254
    v_accvgpr_read_b32 v254, a94
    v_mul_f32 v254, v254, v255
    v_accvgpr_write_b32 a94, v254
    v_accvgpr_read_b32 v254, a95
    v_mul_f32 v254, v254, v255
    v_accvgpr_write_b32 a95, v254
    v_accvgpr_read_b32 v254, a104
    v_mul_f32 v254, v254, v255
    v_accvgpr_write_b32 a104, v254
    v_accvgpr_read_b32 v254, a105
    v_mul_f32 v254, v254, v255
    v_accvgpr_write_b32 a105, v254
    v_accvgpr_read_b32 v254, a106
    v_mul_f32 v254, v254, v255
    v_accvgpr_write_b32 a106, v254
    v_accvgpr_read_b32 v254, a107
    v_mul_f32 v254, v254, v255
    v_accvgpr_write_b32 a107, v254
    s_nop 7
    s_nop 7
    s_branch L_back0
L_slow1:
    s_nop 7
    s_nop 7
    v_and_b32 v254, 63, v0
    v_xor_b32 v252, 16, v254
    v_lshlrev_b32 v252, 2, v252
    v_xor_b32 v253, 32, v254
    v_lshlrev_b32 v253, 2, v253
    v_max3_f32 v248, v64, v65, v66
    v_max3_f32 v248, v248, v67, v76
    v_max3_f32 v248, v248, v77, v78
    v_max3_f32 v248, v248, v79, v88
    v_max3_f32 v248, v248, v89, v90
    v_max3_f32 v248, v248, v91, v100
    v_max3_f32 v248, v248, v101, v102
    v_max_f32 v248, v248, v103
    ds_bpermute_b32 v255, v252, v248
    s_waitcnt lgkmcnt(0)
    v_max_f32 v248, v248, v255
    ds_bpermute_b32 v255, v253, v248
    s_waitcnt lgkmcnt(0)
    v_max_f32 v248, v248, v255
    v_max_f32 v248, 0, v248
    v_sub_f32 v64, v64, v248
    v_sub_f32 v65, v65, v248
    v_sub_f32 v66, v66, v248
    v_sub_f32 v67, v67, v248
    v_sub_f32 v76, v76, v248
    v_sub_f32 v77, v77, v248
    v_sub_f32 v78, v78, v248
    v_sub_f32 v79, v79, v248
    v_sub_f32 v88, v88, v248
    v_sub_f32 v89, v89, v248
    v_sub_f32 v90, v90, v248
    v_sub_f32 v91, v91, v248
    v_sub_f32 v100, v100, v248
    v_sub_f32 v101, v101, v248
    v_sub_f32 v102, v102, v248
    v_sub_f32 v103, v103, v248
    v_sub_f32 v32, v32, v248
    v_sub_f32 v33, v33, v248
    v_sub_f32 v34, v34, v248
    v_sub_f32 v35, v35, v248
    v_sub_f32 v255, 0, v248
    v_exp_f32 v255, v255
    v_accvgpr_read_b32 v254, a0
    v_mul_f32 v254, v254, v255
    v_accvgpr_write_b32 a0, v254
    v_accvgpr_read_b32 v254, a1
    v_mul_f32 v254, v254, v255
    v_accvgpr_write_b32 a1, v254
    v_accvgpr_read_b32 v254, a2
    v_mul_f32 v254, v254, v255
    v_accvgpr_write_b32 a2, v254
    v_accvgpr_read_b32 v254, a3
    v_mul_f32 v254, v254, v255
    v_accvgpr_write_b32 a3, v254
    v_accvgpr_read_b32 v254, a12
    v_mul_f32 v254, v254, v255
    v_accvgpr_write_b32 a12, v254
    v_accvgpr_read_b32 v254, a13
    v_mul_f32 v254, v254, v255
    v_accvgpr_write_b32 a13, v254
    v_accvgpr_read_b32 v254, a14
    v_mul_f32 v254, v254, v255
    v_accvgpr_write_b32 a14, v254
    v_accvgpr_read_b32 v254, a15
    v_mul_f32 v254, v254, v255
    v_accvgpr_write_b32 a15, v254
    v_accvgpr_read_b32 v254, a24
    v_mul_f32 v254, v254, v255
    v_accvgpr_write_b32 a24, v254
    v_accvgpr_read_b32 v254, a25
    v_mul_f32 v254, v254, v255
    v_accvgpr_write_b32 a25, v254
    v_accvgpr_read_b32 v254, a26
    v_mul_f32 v254, v254, v255
    v_accvgpr_write_b32 a26, v254
    v_accvgpr_read_b32 v254, a27
    v_mul_f32 v254, v254, v255
    v_accvgpr_write_b32 a27, v254
    v_accvgpr_read_b32 v254, a36
    v_mul_f32 v254, v254, v255
    v_accvgpr_write_b32 a36, v254
    v_accvgpr_read_b32 v254, a37
    v_mul_f32 v254, v254, v255
    v_accvgpr_write_b32 a37, v254
    v_accvgpr_read_b32 v254, a38
    v_mul_f32 v254, v254, v255
    v_accvgpr_write_b32 a38, v254
    v_accvgpr_read_b32 v254, a39
    v_mul_f32 v254, v254, v255
    v_accvgpr_write_b32 a39, v254
    v_accvgpr_read_b32 v254, a48
    v_mul_f32 v254, v254, v255
    v_accvgpr_write_b32 a48, v254
    v_accvgpr_read_b32 v254, a49
    v_mul_f32 v254, v254, v255
    v_accvgpr_write_b32 a49, v254
    v_accvgpr_read_b32 v254, a50
    v_mul_f32 v254, v254, v255
    v_accvgpr_write_b32 a50, v254
    v_accvgpr_read_b32 v254, a51
    v_mul_f32 v254, v254, v255
    v_accvgpr_write_b32 a51, v254
    v_accvgpr_read_b32 v254, a60
    v_mul_f32 v254, v254, v255
    v_accvgpr_write_b32 a60, v254
    v_accvgpr_read_b32 v254, a61
    v_mul_f32 v254, v254, v255
    v_accvgpr_write_b32 a61, v254
    v_accvgpr_read_b32 v254, a62
    v_mul_f32 v254, v254, v255
    v_accvgpr_write_b32 a62, v254
    v_accvgpr_read_b32 v254, a63
    v_mul_f32 v254, v254, v255
    v_accvgpr_write_b32 a63, v254
    v_accvgpr_read_b32 v254, a72
    v_mul_f32 v254, v254, v255
    v_accvgpr_write_b32 a72, v254
    v_accvgpr_read_b32 v254, a73
    v_mul_f32 v254, v254, v255
    v_accvgpr_write_b32 a73, v254
    v_accvgpr_read_b32 v254, a74
    v_mul_f32 v254, v254, v255
    v_accvgpr_write_b32 a74, v254
    v_accvgpr_read_b32 v254, a75
    v_mul_f32 v254, v254, v255
    v_accvgpr_write_b32 a75, v254
    v_accvgpr_read_b32 v254, a84
    v_mul_f32 v254, v254, v255
    v_accvgpr_write_b32 a84, v254
    v_accvgpr_read_b32 v254, a85
    v_mul_f32 v254, v254, v255
    v_accvgpr_write_b32 a85, v254
    v_accvgpr_read_b32 v254, a86
    v_mul_f32 v254, v254, v255
    v_accvgpr_write_b32 a86, v254
    v_accvgpr_read_b32 v254, a87
    v_mul_f32 v254, v254, v255
    v_accvgpr_write_b32 a87, v254
    v_accvgpr_read_b32 v254, a96
    v_mul_f32 v254, v254, v255
    v_accvgpr_write_b32 a96, v254
    v_accvgpr_read_b32 v254, a97
    v_mul_f32 v254, v254, v255
    v_accvgpr_write_b32 a97, v254
    v_accvgpr_read_b32 v254, a98
    v_mul_f32 v254, v254, v255
    v_accvgpr_write_b32 a98, v254
    v_accvgpr_read_b32 v254, a99
    v_mul_f32 v254, v254, v255
    v_accvgpr_write_b32 a99, v254
    v_max3_f32 v249, v68, v69, v70
    v_max3_f32 v249, v249, v71, v80
    v_max3_f32 v249, v249, v81, v82
    v_max3_f32 v249, v249, v83, v92
    v_max3_f32 v249, v249, v93, v94
    v_max3_f32 v249, v249, v95, v104
    v_max3_f32 v249, v249, v105, v106
    v_max_f32 v249, v249, v107
    ds_bpermute_b32 v255, v252, v249
    s_waitcnt lgkmcnt(0)
    v_max_f32 v249, v249, v255
    ds_bpermute_b32 v255, v253, v249
    s_waitcnt lgkmcnt(0)
    v_max_f32 v249, v249, v255
    v_max_f32 v249, 0, v249
    v_sub_f32 v68, v68, v249
    v_sub_f32 v69, v69, v249
    v_sub_f32 v70, v70, v249
    v_sub_f32 v71, v71, v249
    v_sub_f32 v80, v80, v249
    v_sub_f32 v81, v81, v249
    v_sub_f32 v82, v82, v249
    v_sub_f32 v83, v83, v249
    v_sub_f32 v92, v92, v249
    v_sub_f32 v93, v93, v249
    v_sub_f32 v94, v94, v249
    v_sub_f32 v95, v95, v249
    v_sub_f32 v104, v104, v249
    v_sub_f32 v105, v105, v249
    v_sub_f32 v106, v106, v249
    v_sub_f32 v107, v107, v249
    v_sub_f32 v36, v36, v249
    v_sub_f32 v37, v37, v249
    v_sub_f32 v38, v38, v249
    v_sub_f32 v39, v39, v249
    v_sub_f32 v255, 0, v249
    v_exp_f32 v255, v255
    v_accvgpr_read_b32 v254, a4
    v_mul_f32 v254, v254, v255
    v_accvgpr_write_b32 a4, v254
    v_accvgpr_read_b32 v254, a5
    v_mul_f32 v254, v254, v255
    v_accvgpr_write_b32 a5, v254
    v_accvgpr_read_b32 v254, a6
    v_mul_f32 v254, v254, v255
    v_accvgpr_write_b32 a6, v254
    v_accvgpr_read_b32 v254, a7
    v_mul_f32 v254, v254, v255
    v_accvgpr_write_b32 a7, v254
    v_accvgpr_read_b32 v254, a16
    v_mul_f32 v254, v254, v255
    v_accvgpr_write_b32 a16, v254
    v_accvgpr_read_b32 v254, a17
    v_mul_f32 v254, v254, v255
    v_accvgpr_write_b32 a17, v254
    v_accvgpr_read_b32 v254, a18
    v_mul_f32 v254, v254, v255
    v_accvgpr_write_b32 a18, v254
    v_accvgpr_read_b32 v254, a19
    v_mul_f32 v254, v254, v255
    v_accvgpr_write_b32 a19, v254
    v_accvgpr_read_b32 v254, a28
    v_mul_f32 v254, v254, v255
    v_accvgpr_write_b32 a28, v254
    v_accvgpr_read_b32 v254, a29
    v_mul_f32 v254, v254, v255
    v_accvgpr_write_b32 a29, v254
    v_accvgpr_read_b32 v254, a30
    v_mul_f32 v254, v254, v255
    v_accvgpr_write_b32 a30, v254
    v_accvgpr_read_b32 v254, a31
    v_mul_f32 v254, v254, v255
    v_accvgpr_write_b32 a31, v254
    v_accvgpr_read_b32 v254, a40
    v_mul_f32 v254, v254, v255
    v_accvgpr_write_b32 a40, v254
    v_accvgpr_read_b32 v254, a41
    v_mul_f32 v254, v254, v255
    v_accvgpr_write_b32 a41, v254
    v_accvgpr_read_b32 v254, a42
    v_mul_f32 v254, v254, v255
    v_accvgpr_write_b32 a42, v254
    v_accvgpr_read_b32 v254, a43
    v_mul_f32 v254, v254, v255
    v_accvgpr_write_b32 a43, v254
    v_accvgpr_read_b32 v254, a52
    v_mul_f32 v254, v254, v255
    v_accvgpr_write_b32 a52, v254
    v_accvgpr_read_b32 v254, a53
    v_mul_f32 v254, v254, v255
    v_accvgpr_write_b32 a53, v254
    v_accvgpr_read_b32 v254, a54
    v_mul_f32 v254, v254, v255
    v_accvgpr_write_b32 a54, v254
    v_accvgpr_read_b32 v254, a55
    v_mul_f32 v254, v254, v255
    v_accvgpr_write_b32 a55, v254
    v_accvgpr_read_b32 v254, a64
    v_mul_f32 v254, v254, v255
    v_accvgpr_write_b32 a64, v254
    v_accvgpr_read_b32 v254, a65
    v_mul_f32 v254, v254, v255
    v_accvgpr_write_b32 a65, v254
    v_accvgpr_read_b32 v254, a66
    v_mul_f32 v254, v254, v255
    v_accvgpr_write_b32 a66, v254
    v_accvgpr_read_b32 v254, a67
    v_mul_f32 v254, v254, v255
    v_accvgpr_write_b32 a67, v254
    v_accvgpr_read_b32 v254, a76
    v_mul_f32 v254, v254, v255
    v_accvgpr_write_b32 a76, v254
    v_accvgpr_read_b32 v254, a77
    v_mul_f32 v254, v254, v255
    v_accvgpr_write_b32 a77, v254
    v_accvgpr_read_b32 v254, a78
    v_mul_f32 v254, v254, v255
    v_accvgpr_write_b32 a78, v254
    v_accvgpr_read_b32 v254, a79
    v_mul_f32 v254, v254, v255
    v_accvgpr_write_b32 a79, v254
    v_accvgpr_read_b32 v254, a88
    v_mul_f32 v254, v254, v255
    v_accvgpr_write_b32 a88, v254
    v_accvgpr_read_b32 v254, a89
    v_mul_f32 v254, v254, v255
    v_accvgpr_write_b32 a89, v254
    v_accvgpr_read_b32 v254, a90
    v_mul_f32 v254, v254, v255
    v_accvgpr_write_b32 a90, v254
    v_accvgpr_read_b32 v254, a91
    v_mul_f32 v254, v254, v255
    v_accvgpr_write_b32 a91, v254
    v_accvgpr_read_b32 v254, a100
    v_mul_f32 v254, v254, v255
    v_accvgpr_write_b32 a100, v254
    v_accvgpr_read_b32 v254, a101
    v_mul_f32 v254, v254, v255
    v_accvgpr_write_b32 a101, v254
    v_accvgpr_read_b32 v254, a102
    v_mul_f32 v254, v254, v255
    v_accvgpr_write_b32 a102, v254
    v_accvgpr_read_b32 v254, a103
    v_mul_f32 v254, v254, v255
    v_accvgpr_write_b32 a103, v254
    v_max3_f32 v250, v72, v73, v74
    v_max3_f32 v250, v250, v75, v84
    v_max3_f32 v250, v250, v85, v86
    v_max3_f32 v250, v250, v87, v96
    v_max3_f32 v250, v250, v97, v98
    v_max3_f32 v250, v250, v99, v108
    v_max3_f32 v250, v250, v109, v110
    v_max_f32 v250, v250, v111
    ds_bpermute_b32 v255, v252, v250
    s_waitcnt lgkmcnt(0)
    v_max_f32 v250, v250, v255
    ds_bpermute_b32 v255, v253, v250
    s_waitcnt lgkmcnt(0)
    v_max_f32 v250, v250, v255
    v_max_f32 v250, 0, v250
    v_sub_f32 v72, v72, v250
    v_sub_f32 v73, v73, v250
    v_sub_f32 v74, v74, v250
    v_sub_f32 v75, v75, v250
    v_sub_f32 v84, v84, v250
    v_sub_f32 v85, v85, v250
    v_sub_f32 v86, v86, v250
    v_sub_f32 v87, v87, v250
    v_sub_f32 v96, v96, v250
    v_sub_f32 v97, v97, v250
    v_sub_f32 v98, v98, v250
    v_sub_f32 v99, v99, v250
    v_sub_f32 v108, v108, v250
    v_sub_f32 v109, v109, v250
    v_sub_f32 v110, v110, v250
    v_sub_f32 v111, v111, v250
    v_sub_f32 v40, v40, v250
    v_sub_f32 v41, v41, v250
    v_sub_f32 v42, v42, v250
    v_sub_f32 v43, v43, v250
    v_sub_f32 v255, 0, v250
    v_exp_f32 v255, v255
    v_accvgpr_read_b32 v254, a8
    v_mul_f32 v254, v254, v255
    v_accvgpr_write_b32 a8, v254
    v_accvgpr_read_b32 v254, a9
    v_mul_f32 v254, v254, v255
    v_accvgpr_write_b32 a9, v254
    v_accvgpr_read_b32 v254, a10
    v_mul_f32 v254, v254, v255
    v_accvgpr_write_b32 a10, v254
    v_accvgpr_read_b32 v254, a11
    v_mul_f32 v254, v254, v255
    v_accvgpr_write_b32 a11, v254
    v_accvgpr_read_b32 v254, a20
    v_mul_f32 v254, v254, v255
    v_accvgpr_write_b32 a20, v254
    v_accvgpr_read_b32 v254, a21
    v_mul_f32 v254, v254, v255
    v_accvgpr_write_b32 a21, v254
    v_accvgpr_read_b32 v254, a22
    v_mul_f32 v254, v254, v255
    v_accvgpr_write_b32 a22, v254
    v_accvgpr_read_b32 v254, a23
    v_mul_f32 v254, v254, v255
    v_accvgpr_write_b32 a23, v254
    v_accvgpr_read_b32 v254, a32
    v_mul_f32 v254, v254, v255
    v_accvgpr_write_b32 a32, v254
    v_accvgpr_read_b32 v254, a33
    v_mul_f32 v254, v254, v255
    v_accvgpr_write_b32 a33, v254
    v_accvgpr_read_b32 v254, a34
    v_mul_f32 v254, v254, v255
    v_accvgpr_write_b32 a34, v254
    v_accvgpr_read_b32 v254, a35
    v_mul_f32 v254, v254, v255
    v_accvgpr_write_b32 a35, v254
    v_accvgpr_read_b32 v254, a44
    v_mul_f32 v254, v254, v255
    v_accvgpr_write_b32 a44, v254
    v_accvgpr_read_b32 v254, a45
    v_mul_f32 v254, v254, v255
    v_accvgpr_write_b32 a45, v254
    v_accvgpr_read_b32 v254, a46
    v_mul_f32 v254, v254, v255
    v_accvgpr_write_b32 a46, v254
    v_accvgpr_read_b32 v254, a47
    v_mul_f32 v254, v254, v255
    v_accvgpr_write_b32 a47, v254
    v_accvgpr_read_b32 v254, a56
    v_mul_f32 v254, v254, v255
    v_accvgpr_write_b32 a56, v254
    v_accvgpr_read_b32 v254, a57
    v_mul_f32 v254, v254, v255
    v_accvgpr_write_b32 a57, v254
    v_accvgpr_read_b32 v254, a58
    v_mul_f32 v254, v254, v255
    v_accvgpr_write_b32 a58, v254
    v_accvgpr_read_b32 v254, a59
    v_mul_f32 v254, v254, v255
    v_accvgpr_write_b32 a59, v254
    v_accvgpr_read_b32 v254, a68
    v_mul_f32 v254, v254, v255
    v_accvgpr_write_b32 a68, v254
    v_accvgpr_read_b32 v254, a69
    v_mul_f32 v254, v254, v255
    v_accvgpr_write_b32 a69, v254
    v_accvgpr_read_b32 v254, a70
    v_mul_f32 v254, v254, v255
    v_accvgpr_write_b32 a70, v254
    v_accvgpr_read_b32 v254, a71
    v_mul_f32 v254, v254, v255
    v_accvgpr_write_b32 a71, v254
    v_accvgpr_read_b32 v254, a80
    v_mul_f32 v254, v254, v255
    v_accvgpr_write_b32 a80, v254
    v_accvgpr_read_b32 v254, a81
    v_mul_f32 v254, v254, v255
    v_accvgpr_write_b32 a81, v254
    v_accvgpr_read_b32 v254, a82
    v_mul_f32 v254, v254, v255
    v_accvgpr_write_b32 a82, v254
    v_accvgpr_read_b32 v254, a83
    v_mul_f32 v254, v254, v255
    v_accvgpr_write_b32 a83, v254
    v_accvgpr_read_b32 v254, a92
    v_mul_f32 v254, v254, v255
    v_accvgpr_write_b32 a92, v254
    v_accvgpr_read_b32 v254, a93
    v_mul_f32 v254, v254, v255
    v_accvgpr_write_b32 a93, v254
    v_accvgpr_read_b32 v254, a94
    v_mul_f32 v254, v254, v255
    v_accvgpr_write_b32 a94, v254
    v_accvgpr_read_b32 v254, a95
    v_mul_f32 v254, v254, v255
    v_accvgpr_write_b32 a95, v254
    v_accvgpr_read_b32 v254, a104
    v_mul_f32 v254, v254, v255
    v_accvgpr_write_b32 a104, v254
    v_accvgpr_read_b32 v254, a105
    v_mul_f32 v254, v254, v255
    v_accvgpr_write_b32 a105, v254
    v_accvgpr_read_b32 v254, a106
    v_mul_f32 v254, v254, v255
    v_accvgpr_write_b32 a106, v254
    v_accvgpr_read_b32 v254, a107
    v_mul_f32 v254, v254, v255
    v_accvgpr_write_b32 a107, v254
    s_nop 7
    s_nop 7
    s_branch L_back1
L_slow2:
    s_nop 7
    s_nop 7
    v_and_b32 v254, 63, v0
    v_xor_b32 v252, 16, v254
    v_lshlrev_b32 v252, 2, v252
    v_xor_b32 v253, 32, v254
    v_lshlrev_b32 v253, 2, v253
    v_max3_f32 v248, v112, v113, v114
    v_max3_f32 v248, v248, v115, v124
    v_max3_f32 v248, v248, v125, v126
    v_max3_f32 v248, v248, v127, v136
    v_max3_f32 v248, v248, v137, v138
    v_max3_f32 v248, v248, v139, v148
    v_max3_f32 v248, v248, v149, v150
    v_max_f32 v248, v248, v151
    ds_bpermute_b32 v255, v252, v248
    s_waitcnt lgkmcnt(0)
    v_max_f32 v248, v248, v255
    ds_bpermute_b32 v255, v253, v248
    s_waitcnt lgkmcnt(0)
    v_max_f32 v248, v248, v255
    v_max_f32 v248, 0, v248
    v_sub_f32 v112, v112, v248
    v_sub_f32 v113, v113, v248
    v_sub_f32 v114, v114, v248
    v_sub_f32 v115, v115, v248
    v_sub_f32 v124, v124, v248
    v_sub_f32 v125, v125, v248
    v_sub_f32 v126, v126, v248
    v_sub_f32 v127, v127, v248
    v_sub_f32 v136, v136, v248
    v_sub_f32 v137, v137, v248
    v_sub_f32 v138, v138, v248
    v_sub_f32 v139, v139, v248
    v_sub_f32 v148, v148, v248
    v_sub_f32 v149, v149, v248
    v_sub_f32 v150, v150, v248
    v_sub_f32 v151, v151, v248
    v_sub_f32 v32, v32, v248
    v_sub_f32 v33, v33, v248
    v_sub_f32 v34, v34, v248
    v_sub_f32 v35, v35, v248
    v_sub_f32 v255, 0, v248
    v_exp_f32 v255, v255
    v_accvgpr_read_b32 v254, a0
    v_mul_f32 v254, v254, v255
    v_accvgpr_write_b32 a0, v254
    v_accvgpr_read_b32 v254, a1
    v_mul_f32 v254, v254, v255
    v_accvgpr_write_b32 a1, v254
    v_accvgpr_read_b32 v254, a2
    v_mul_f32 v254, v254, v255
    v_accvgpr_write_b32 a2, v254
    v_accvgpr_read_b32 v254, a3
    v_mul_f32 v254, v254, v255
    v_accvgpr_write_b32 a3, v254
    v_accvgpr_read_b32 v254, a12
    v_mul_f32 v254, v254, v255
    v_accvgpr_write_b32 a12, v254
    v_accvgpr_read_b32 v254, a13
    v_mul_f32 v254, v254, v255
    v_accvgpr_write_b32 a13, v254
    v_accvgpr_read_b32 v254, a14
    v_mul_f32 v254, v254, v255
    v_accvgpr_write_b32 a14, v254
    v_accvgpr_read_b32 v254, a15
    v_mul_f32 v254, v254, v255
    v_accvgpr_write_b32 a15, v254
    v_accvgpr_read_b32 v254, a24
    v_mul_f32 v254, v254, v255
    v_accvgpr_write_b32 a24, v254
    v_accvgpr_read_b32 v254, a25
    v_mul_f32 v254, v254, v255
    v_accvgpr_write_b32 a25, v254
    v_accvgpr_read_b32 v254, a26
    v_mul_f32 v254, v254, v255
    v_accvgpr_write_b32 a26, v254
    v_accvgpr_read_b32 v254, a27
    v_mul_f32 v254, v254, v255
    v_accvgpr_write_b32 a27, v254
    v_accvgpr_read_b32 v254, a36
    v_mul_f32 v254, v254, v255
    v_accvgpr_write_b32 a36, v254
    v_accvgpr_read_b32 v254, a37
    v_mul_f32 v254, v254, v255
    v_accvgpr_write_b32 a37, v254
    v_accvgpr_read_b32 v254, a38
    v_mul_f32 v254, v254, v255
    v_accvgpr_write_b32 a38, v254
    v_accvgpr_read_b32 v254, a39
    v_mul_f32 v254, v254, v255
    v_accvgpr_write_b32 a39, v254
    v_accvgpr_read_b32 v254, a48
    v_mul_f32 v254, v254, v255
    v_accvgpr_write_b32 a48, v254
    v_accvgpr_read_b32 v254, a49
    v_mul_f32 v254, v254, v255
    v_accvgpr_write_b32 a49, v254
    v_accvgpr_read_b32 v254, a50
    v_mul_f32 v254, v254, v255
    v_accvgpr_write_b32 a50, v254
    v_accvgpr_read_b32 v254, a51
    v_mul_f32 v254, v254, v255
    v_accvgpr_write_b32 a51, v254
    v_accvgpr_read_b32 v254, a60
    v_mul_f32 v254, v254, v255
    v_accvgpr_write_b32 a60, v254
    v_accvgpr_read_b32 v254, a61
    v_mul_f32 v254, v254, v255
    v_accvgpr_write_b32 a61, v254
    v_accvgpr_read_b32 v254, a62
    v_mul_f32 v254, v254, v255
    v_accvgpr_write_b32 a62, v254
    v_accvgpr_read_b32 v254, a63
    v_mul_f32 v254, v254, v255
    v_accvgpr_write_b32 a63, v254
    v_accvgpr_read_b32 v254, a72
    v_mul_f32 v254, v254, v255
    v_accvgpr_write_b32 a72, v254
    v_accvgpr_read_b32 v254, a73
    v_mul_f32 v254, v254, v255
    v_accvgpr_write_b32 a73, v254
    v_accvgpr_read_b32 v254, a74
    v_mul_f32 v254, v254, v255
    v_accvgpr_write_b32 a74, v254
    v_accvgpr_read_b32 v254, a75
    v_mul_f32 v254, v254, v255
    v_accvgpr_write_b32 a75, v254
    v_accvgpr_read_b32 v254, a84
    v_mul_f32 v254, v254, v255
    v_accvgpr_write_b32 a84, v254
    v_accvgpr_read_b32 v254, a85
    v_mul_f32 v254, v254, v255
    v_accvgpr_write_b32 a85, v254
    v_accvgpr_read_b32 v254, a86
    v_mul_f32 v254, v254, v255
    v_accvgpr_write_b32 a86, v254
    v_accvgpr_read_b32 v254, a87
    v_mul_f32 v254, v254, v255
    v_accvgpr_write_b32 a87, v254
    v_accvgpr_read_b32 v254, a96
    v_mul_f32 v254, v254, v255
    v_accvgpr_write_b32 a96, v254
    v_accvgpr_read_b32 v254, a97
    v_mul_f32 v254, v254, v255
    v_accvgpr_write_b32 a97, v254
    v_accvgpr_read_b32 v254, a98
    v_mul_f32 v254, v254, v255
    v_accvgpr_write_b32 a98, v254
    v_accvgpr_read_b32 v254, a99
    v_mul_f32 v254, v254, v255
    v_accvgpr_write_b32 a99, v254
    v_max3_f32 v249, v116, v117, v118
    v_max3_f32 v249, v249, v119, v128
    v_max3_f32 v249, v249, v129, v130
    v_max3_f32 v249, v249, v131, v140
    v_max3_f32 v249, v249, v141, v142
    v_max3_f32 v249, v249, v143, v152
    v_max3_f32 v249, v249, v153, v154
    v_max_f32 v249, v249, v155
    ds_bpermute_b32 v255, v252, v249
    s_waitcnt lgkmcnt(0)
    v_max_f32 v249, v249, v255
    ds_bpermute_b32 v255, v253, v249
    s_waitcnt lgkmcnt(0)
    v_max_f32 v249, v249, v255
    v_max_f32 v249, 0, v249
    v_sub_f32 v116, v116, v249
    v_sub_f32 v117, v117, v249
    v_sub_f32 v118, v118, v249
    v_sub_f32 v119, v119, v249
    v_sub_f32 v128, v128, v249
    v_sub_f32 v129, v129, v249
    v_sub_f32 v130, v130, v249
    v_sub_f32 v131, v131, v249
    v_sub_f32 v140, v140, v249
    v_sub_f32 v141, v141, v249
    v_sub_f32 v142, v142, v249
    v_sub_f32 v143, v143, v249
    v_sub_f32 v152, v152, v249
    v_sub_f32 v153, v153, v249
    v_sub_f32 v154, v154, v249
    v_sub_f32 v155, v155, v249
    v_sub_f32 v36, v36, v249
    v_sub_f32 v37, v37, v249
    v_sub_f32 v38, v38, v249
    v_sub_f32 v39, v39, v249
    v_sub_f32 v255, 0, v249
    v_exp_f32 v255, v255
    v_accvgpr_read_b32 v254, a4
    v_mul_f32 v254, v254, v255
    v_accvgpr_write_b32 a4, v254
    v_accvgpr_read_b32 v254, a5
    v_mul_f32 v254, v254, v255
    v_accvgpr_write_b32 a5, v254
    v_accvgpr_read_b32 v254, a6
    v_mul_f32 v254, v254, v255
    v_accvgpr_write_b32 a6, v254
    v_accvgpr_read_b32 v254, a7
    v_mul_f32 v254, v254, v255
    v_accvgpr_write_b32 a7, v254
    v_accvgpr_read_b32 v254, a16
    v_mul_f32 v254, v254, v255
    v_accvgpr_write_b32 a16, v254
    v_accvgpr_read_b32 v254, a17
    v_mul_f32 v254, v254, v255
    v_accvgpr_write_b32 a17, v254
    v_accvgpr_read_b32 v254, a18
    v_mul_f32 v254, v254, v255
    v_accvgpr_write_b32 a18, v254
    v_accvgpr_read_b32 v254, a19
    v_mul_f32 v254, v254, v255
    v_accvgpr_write_b32 a19, v254
    v_accvgpr_read_b32 v254, a28
    v_mul_f32 v254, v254, v255
    v_accvgpr_write_b32 a28, v254
    v_accvgpr_read_b32 v254, a29
    v_mul_f32 v254, v254, v255
    v_accvgpr_write_b32 a29, v254
    v_accvgpr_read_b32 v254, a30
    v_mul_f32 v254, v254, v255
    v_accvgpr_write_b32 a30, v254
    v_accvgpr_read_b32 v254, a31
    v_mul_f32 v254, v254, v255
    v_accvgpr_write_b32 a31, v254
    v_accvgpr_read_b32 v254, a40
    v_mul_f32 v254, v254, v255
    v_accvgpr_write_b32 a40, v254
    v_accvgpr_read_b32 v254, a41
    v_mul_f32 v254, v254, v255
    v_accvgpr_write_b32 a41, v254
    v_accvgpr_read_b32 v254, a42
    v_mul_f32 v254, v254, v255
    v_accvgpr_write_b32 a42, v254
    v_accvgpr_read_b32 v254, a43
    v_mul_f32 v254, v254, v255
    v_accvgpr_write_b32 a43, v254
    v_accvgpr_read_b32 v254, a52
    v_mul_f32 v254, v254, v255
    v_accvgpr_write_b32 a52, v254
    v_accvgpr_read_b32 v254, a53
    v_mul_f32 v254, v254, v255
    v_accvgpr_write_b32 a53, v254
    v_accvgpr_read_b32 v254, a54
    v_mul_f32 v254, v254, v255
    v_accvgpr_write_b32 a54, v254
    v_accvgpr_read_b32 v254, a55
    v_mul_f32 v254, v254, v255
    v_accvgpr_write_b32 a55, v254
    v_accvgpr_read_b32 v254, a64
    v_mul_f32 v254, v254, v255
    v_accvgpr_write_b32 a64, v254
    v_accvgpr_read_b32 v254, a65
    v_mul_f32 v254, v254, v255
    v_accvgpr_write_b32 a65, v254
    v_accvgpr_read_b32 v254, a66
    v_mul_f32 v254, v254, v255
    v_accvgpr_write_b32 a66, v254
    v_accvgpr_read_b32 v254, a67
    v_mul_f32 v254, v254, v255
    v_accvgpr_write_b32 a67, v254
    v_accvgpr_read_b32 v254, a76
    v_mul_f32 v254, v254, v255
    v_accvgpr_write_b32 a76, v254
    v_accvgpr_read_b32 v254, a77
    v_mul_f32 v254, v254, v255
    v_accvgpr_write_b32 a77, v254
    v_accvgpr_read_b32 v254, a78
    v_mul_f32 v254, v254, v255
    v_accvgpr_write_b32 a78, v254
    v_accvgpr_read_b32 v254, a79
    v_mul_f32 v254, v254, v255
    v_accvgpr_write_b32 a79, v254
    v_accvgpr_read_b32 v254, a88
    v_mul_f32 v254, v254, v255
    v_accvgpr_write_b32 a88, v254
    v_accvgpr_read_b32 v254, a89
    v_mul_f32 v254, v254, v255
    v_accvgpr_write_b32 a89, v254
    v_accvgpr_read_b32 v254, a90
    v_mul_f32 v254, v254, v255
    v_accvgpr_write_b32 a90, v254
    v_accvgpr_read_b32 v254, a91
    v_mul_f32 v254, v254, v255
    v_accvgpr_write_b32 a91, v254
    v_accvgpr_read_b32 v254, a100
    v_mul_f32 v254, v254, v255
    v_accvgpr_write_b32 a100, v254
    v_accvgpr_read_b32 v254, a101
    v_mul_f32 v254, v254, v255
    v_accvgpr_write_b32 a101, v254
    v_accvgpr_read_b32 v254, a102
    v_mul_f32 v254, v254, v255
    v_accvgpr_write_b32 a102, v254
    v_accvgpr_read_b32 v254, a103
    v_mul_f32 v254, v254, v255
    v_accvgpr_write_b32 a103, v254
    v_max3_f32 v250, v120, v121, v122
    v_max3_f32 v250, v250, v123, v132
    v_max3_f32 v250, v250, v133, v134
    v_max3_f32 v250, v250, v135, v144
    v_max3_f32 v250, v250, v145, v146
    v_max3_f32 v250, v250, v147, v156
    v_max3_f32 v250, v250, v157, v158
    v_max_f32 v250, v250, v159
    ds_bpermute_b32 v255, v252, v250
    s_waitcnt lgkmcnt(0)
    v_max_f32 v250, v250, v255
    ds_bpermute_b32 v255, v253, v250
    s_waitcnt lgkmcnt(0)
    v_max_f32 v250, v250, v255
    v_max_f32 v250, 0, v250
    v_sub_f32 v120, v120, v250
    v_sub_f32 v121, v121, v250
    v_sub_f32 v122, v122, v250
    v_sub_f32 v123, v123, v250
    v_sub_f32 v132, v132, v250
    v_sub_f32 v133, v133, v250
    v_sub_f32 v134, v134, v250
    v_sub_f32 v135, v135, v250
    v_sub_f32 v144, v144, v250
    v_sub_f32 v145, v145, v250
    v_sub_f32 v146, v146, v250
    v_sub_f32 v147, v147, v250
    v_sub_f32 v156, v156, v250
    v_sub_f32 v157, v157, v250
    v_sub_f32 v158, v158, v250
    v_sub_f32 v159, v159, v250
    v_sub_f32 v40, v40, v250
    v_sub_f32 v41, v41, v250
    v_sub_f32 v42, v42, v250
    v_sub_f32 v43, v43, v250
    v_sub_f32 v255, 0, v250
    v_exp_f32 v255, v255
    v_accvgpr_read_b32 v254, a8
    v_mul_f32 v254, v254, v255
    v_accvgpr_write_b32 a8, v254
    v_accvgpr_read_b32 v254, a9
    v_mul_f32 v254, v254, v255
    v_accvgpr_write_b32 a9, v254
    v_accvgpr_read_b32 v254, a10
    v_mul_f32 v254, v254, v255
    v_accvgpr_write_b32 a10, v254
    v_accvgpr_read_b32 v254, a11
    v_mul_f32 v254, v254, v255
    v_accvgpr_write_b32 a11, v254
    v_accvgpr_read_b32 v254, a20
    v_mul_f32 v254, v254, v255
    v_accvgpr_write_b32 a20, v254
    v_accvgpr_read_b32 v254, a21
    v_mul_f32 v254, v254, v255
    v_accvgpr_write_b32 a21, v254
    v_accvgpr_read_b32 v254, a22
    v_mul_f32 v254, v254, v255
    v_accvgpr_write_b32 a22, v254
    v_accvgpr_read_b32 v254, a23
    v_mul_f32 v254, v254, v255
    v_accvgpr_write_b32 a23, v254
    v_accvgpr_read_b32 v254, a32
    v_mul_f32 v254, v254, v255
    v_accvgpr_write_b32 a32, v254
    v_accvgpr_read_b32 v254, a33
    v_mul_f32 v254, v254, v255
    v_accvgpr_write_b32 a33, v254
    v_accvgpr_read_b32 v254, a34
    v_mul_f32 v254, v254, v255
    v_accvgpr_write_b32 a34, v254
    v_accvgpr_read_b32 v254, a35
    v_mul_f32 v254, v254, v255
    v_accvgpr_write_b32 a35, v254
    v_accvgpr_read_b32 v254, a44
    v_mul_f32 v254, v254, v255
    v_accvgpr_write_b32 a44, v254
    v_accvgpr_read_b32 v254, a45
    v_mul_f32 v254, v254, v255
    v_accvgpr_write_b32 a45, v254
    v_accvgpr_read_b32 v254, a46
    v_mul_f32 v254, v254, v255
    v_accvgpr_write_b32 a46, v254
    v_accvgpr_read_b32 v254, a47
    v_mul_f32 v254, v254, v255
    v_accvgpr_write_b32 a47, v254
    v_accvgpr_read_b32 v254, a56
    v_mul_f32 v254, v254, v255
    v_accvgpr_write_b32 a56, v254
    v_accvgpr_read_b32 v254, a57
    v_mul_f32 v254, v254, v255
    v_accvgpr_write_b32 a57, v254
    v_accvgpr_read_b32 v254, a58
    v_mul_f32 v254, v254, v255
    v_accvgpr_write_b32 a58, v254
    v_accvgpr_read_b32 v254, a59
    v_mul_f32 v254, v254, v255
    v_accvgpr_write_b32 a59, v254
    v_accvgpr_read_b32 v254, a68
    v_mul_f32 v254, v254, v255
    v_accvgpr_write_b32 a68, v254
    v_accvgpr_read_b32 v254, a69
    v_mul_f32 v254, v254, v255
    v_accvgpr_write_b32 a69, v254
    v_accvgpr_read_b32 v254, a70
    v_mul_f32 v254, v254, v255
    v_accvgpr_write_b32 a70, v254
    v_accvgpr_read_b32 v254, a71
    v_mul_f32 v254, v254, v255
    v_accvgpr_write_b32 a71, v254
    v_accvgpr_read_b32 v254, a80
    v_mul_f32 v254, v254, v255
    v_accvgpr_write_b32 a80, v254
    v_accvgpr_read_b32 v254, a81
    v_mul_f32 v254, v254, v255
    v_accvgpr_write_b32 a81, v254
    v_accvgpr_read_b32 v254, a82
    v_mul_f32 v254, v254, v255
    v_accvgpr_write_b32 a82, v254
    v_accvgpr_read_b32 v254, a83
    v_mul_f32 v254, v254, v255
    v_accvgpr_write_b32 a83, v254
    v_accvgpr_read_b32 v254, a92
    v_mul_f32 v254, v254, v255
    v_accvgpr_write_b32 a92, v254
    v_accvgpr_read_b32 v254, a93
    v_mul_f32 v254, v254, v255
    v_accvgpr_write_b32 a93, v254
    v_accvgpr_read_b32 v254, a94
    v_mul_f32 v254, v254, v255
    v_accvgpr_write_b32 a94, v254
    v_accvgpr_read_b32 v254, a95
    v_mul_f32 v254, v254, v255
    v_accvgpr_write_b32 a95, v254
    v_accvgpr_read_b32 v254, a104
    v_mul_f32 v254, v254, v255
    v_accvgpr_write_b32 a104, v254
    v_accvgpr_read_b32 v254, a105
    v_mul_f32 v254, v254, v255
    v_accvgpr_write_b32 a105, v254
    v_accvgpr_read_b32 v254, a106
    v_mul_f32 v254, v254, v255
    v_accvgpr_write_b32 a106, v254
    v_accvgpr_read_b32 v254, a107
    v_mul_f32 v254, v254, v255
    v_accvgpr_write_b32 a107, v254
    s_nop 7
    s_nop 7
    s_branch L_back2
L_slow3:
    s_nop 7
    s_nop 7
    v_and_b32 v254, 63, v0
    v_xor_b32 v252, 16, v254
    v_lshlrev_b32 v252, 2, v252
    v_xor_b32 v253, 32, v254
    v_lshlrev_b32 v253, 2, v253
    v_max3_f32 v248, v64, v65, v66
    v_max3_f32 v248, v248, v67, v76
    v_max3_f32 v248, v248, v77, v78
    v_max3_f32 v248, v248, v79, v88
    v_max3_f32 v248, v248, v89, v90
    v_max3_f32 v248, v248, v91, v100
    v_max3_f32 v248, v248, v101, v102
    v_max_f32 v248, v248, v103
    ds_bpermute_b32 v255, v252, v248
    s_waitcnt lgkmcnt(0)
    v_max_f32 v248, v248, v255
    ds_bpermute_b32 v255, v253, v248
    s_waitcnt lgkmcnt(0)
    v_max_f32 v248, v248, v255
    v_max_f32 v248, 0, v248
    v_sub_f32 v64, v64, v248
    v_sub_f32 v65, v65, v248
    v_sub_f32 v66, v66, v248
    v_sub_f32 v67, v67, v248
    v_sub_f32 v76, v76, v248
    v_sub_f32 v77, v77, v248
    v_sub_f32 v78, v78, v248
    v_sub_f32 v79, v79, v248
    v_sub_f32 v88, v88, v248
    v_sub_f32 v89, v89, v248
    v_sub_f32 v90, v90, v248
    v_sub_f32 v91, v91, v248
    v_sub_f32 v100, v100, v248
    v_sub_f32 v101, v101, v248
    v_sub_f32 v102, v102, v248
    v_sub_f32 v103, v103, v248
    v_sub_f32 v32, v32, v248
    v_sub_f32 v33, v33, v248
    v_sub_f32 v34, v34, v248
    v_sub_f32 v35, v35, v248
    v_sub_f32 v255, 0, v248
    v_exp_f32 v255, v255
    v_accvgpr_read_b32 v254, a0
    v_mul_f32 v254, v254, v255
    v_accvgpr_write_b32 a0, v254
    v_accvgpr_read_b32 v254, a1
    v_mul_f32 v254, v254, v255
    v_accvgpr_write_b32 a1, v254
    v_accvgpr_read_b32 v254, a2
    v_mul_f32 v254, v254, v255
    v_accvgpr_write_b32 a2, v254
    v_accvgpr_read_b32 v254, a3
    v_mul_f32 v254, v254, v255
    v_accvgpr_write_b32 a3, v254
    v_accvgpr_read_b32 v254, a12
    v_mul_f32 v254, v254, v255
    v_accvgpr_write_b32 a12, v254
    v_accvgpr_read_b32 v254, a13
    v_mul_f32 v254, v254, v255
    v_accvgpr_write_b32 a13, v254
    v_accvgpr_read_b32 v254, a14
    v_mul_f32 v254, v254, v255
    v_accvgpr_write_b32 a14, v254
    v_accvgpr_read_b32 v254, a15
    v_mul_f32 v254, v254, v255
    v_accvgpr_write_b32 a15, v254
    v_accvgpr_read_b32 v254, a24
    v_mul_f32 v254, v254, v255
    v_accvgpr_write_b32 a24, v254
    v_accvgpr_read_b32 v254, a25
    v_mul_f32 v254, v254, v255
    v_accvgpr_write_b32 a25, v254
    v_accvgpr_read_b32 v254, a26
    v_mul_f32 v254, v254, v255
    v_accvgpr_write_b32 a26, v254
    v_accvgpr_read_b32 v254, a27
    v_mul_f32 v254, v254, v255
    v_accvgpr_write_b32 a27, v254
    v_accvgpr_read_b32 v254, a36
    v_mul_f32 v254, v254, v255
    v_accvgpr_write_b32 a36, v254
    v_accvgpr_read_b32 v254, a37
    v_mul_f32 v254, v254, v255
    v_accvgpr_write_b32 a37, v254
    v_accvgpr_read_b32 v254, a38
    v_mul_f32 v254, v254, v255
    v_accvgpr_write_b32 a38, v254
    v_accvgpr_read_b32 v254, a39
    v_mul_f32 v254, v254, v255
    v_accvgpr_write_b32 a39, v254
    v_accvgpr_read_b32 v254, a48
    v_mul_f32 v254, v254, v255
    v_accvgpr_write_b32 a48, v254
    v_accvgpr_read_b32 v254, a49
    v_mul_f32 v254, v254, v255
    v_accvgpr_write_b32 a49, v254
    v_accvgpr_read_b32 v254, a50
    v_mul_f32 v254, v254, v255
    v_accvgpr_write_b32 a50, v254
    v_accvgpr_read_b32 v254, a51
    v_mul_f32 v254, v254, v255
    v_accvgpr_write_b32 a51, v254
    v_accvgpr_read_b32 v254, a60
    v_mul_f32 v254, v254, v255
    v_accvgpr_write_b32 a60, v254
    v_accvgpr_read_b32 v254, a61
    v_mul_f32 v254, v254, v255
    v_accvgpr_write_b32 a61, v254
    v_accvgpr_read_b32 v254, a62
    v_mul_f32 v254, v254, v255
    v_accvgpr_write_b32 a62, v254
    v_accvgpr_read_b32 v254, a63
    v_mul_f32 v254, v254, v255
    v_accvgpr_write_b32 a63, v254
    v_accvgpr_read_b32 v254, a72
    v_mul_f32 v254, v254, v255
    v_accvgpr_write_b32 a72, v254
    v_accvgpr_read_b32 v254, a73
    v_mul_f32 v254, v254, v255
    v_accvgpr_write_b32 a73, v254
    v_accvgpr_read_b32 v254, a74
    v_mul_f32 v254, v254, v255
    v_accvgpr_write_b32 a74, v254
    v_accvgpr_read_b32 v254, a75
    v_mul_f32 v254, v254, v255
    v_accvgpr_write_b32 a75, v254
    v_accvgpr_read_b32 v254, a84
    v_mul_f32 v254, v254, v255
    v_accvgpr_write_b32 a84, v254
    v_accvgpr_read_b32 v254, a85
    v_mul_f32 v254, v254, v255
    v_accvgpr_write_b32 a85, v254
    v_accvgpr_read_b32 v254, a86
    v_mul_f32 v254, v254, v255
    v_accvgpr_write_b32 a86, v254
    v_accvgpr_read_b32 v254, a87
    v_mul_f32 v254, v254, v255
    v_accvgpr_write_b32 a87, v254
    v_accvgpr_read_b32 v254, a96
    v_mul_f32 v254, v254, v255
    v_accvgpr_write_b32 a96, v254
    v_accvgpr_read_b32 v254, a97
    v_mul_f32 v254, v254, v255
    v_accvgpr_write_b32 a97, v254
    v_accvgpr_read_b32 v254, a98
    v_mul_f32 v254, v254, v255
    v_accvgpr_write_b32 a98, v254
    v_accvgpr_read_b32 v254, a99
    v_mul_f32 v254, v254, v255
    v_accvgpr_write_b32 a99, v254
    v_max3_f32 v249, v68, v69, v70
    v_max3_f32 v249, v249, v71, v80
    v_max3_f32 v249, v249, v81, v82
    v_max3_f32 v249, v249, v83, v92
    v_max3_f32 v249, v249, v93, v94
    v_max3_f32 v249, v249, v95, v104
    v_max3_f32 v249, v249, v105, v106
    v_max_f32 v249, v249, v107
    ds_bpermute_b32 v255, v252, v249
    s_waitcnt lgkmcnt(0)
    v_max_f32 v249, v249, v255
    ds_bpermute_b32 v255, v253, v249
    s_waitcnt lgkmcnt(0)
    v_max_f32 v249, v249, v255
    v_max_f32 v249, 0, v249
    v_sub_f32 v68, v68, v249
    v_sub_f32 v69, v69, v249
    v_sub_f32 v70, v70, v249
    v_sub_f32 v71, v71, v249
    v_sub_f32 v80, v80, v249
    v_sub_f32 v81, v81, v249
    v_sub_f32 v82, v82, v249
    v_sub_f32 v83, v83, v249
    v_sub_f32 v92, v92, v249
    v_sub_f32 v93, v93, v249
    v_sub_f32 v94, v94, v249
    v_sub_f32 v95, v95, v249
    v_sub_f32 v104, v104, v249
    v_sub_f32 v105, v105, v249
    v_sub_f32 v106, v106, v249
    v_sub_f32 v107, v107, v249
    v_sub_f32 v36, v36, v249
    v_sub_f32 v37, v37, v249
    v_sub_f32 v38, v38, v249
    v_sub_f32 v39, v39, v249
    v_sub_f32 v255, 0, v249
    v_exp_f32 v255, v255
    v_accvgpr_read_b32 v254, a4
    v_mul_f32 v254, v254, v255
    v_accvgpr_write_b32 a4, v254
    v_accvgpr_read_b32 v254, a5
    v_mul_f32 v254, v254, v255
    v_accvgpr_write_b32 a5, v254
    v_accvgpr_read_b32 v254, a6
    v_mul_f32 v254, v254, v255
    v_accvgpr_write_b32 a6, v254
    v_accvgpr_read_b32 v254, a7
    v_mul_f32 v254, v254, v255
    v_accvgpr_write_b32 a7, v254
    v_accvgpr_read_b32 v254, a16
    v_mul_f32 v254, v254, v255
    v_accvgpr_write_b32 a16, v254
    v_accvgpr_read_b32 v254, a17
    v_mul_f32 v254, v254, v255
    v_accvgpr_write_b32 a17, v254
    v_accvgpr_read_b32 v254, a18
    v_mul_f32 v254, v254, v255
    v_accvgpr_write_b32 a18, v254
    v_accvgpr_read_b32 v254, a19
    v_mul_f32 v254, v254, v255
    v_accvgpr_write_b32 a19, v254
    v_accvgpr_read_b32 v254, a28
    v_mul_f32 v254, v254, v255
    v_accvgpr_write_b32 a28, v254
    v_accvgpr_read_b32 v254, a29
    v_mul_f32 v254, v254, v255
    v_accvgpr_write_b32 a29, v254
    v_accvgpr_read_b32 v254, a30
    v_mul_f32 v254, v254, v255
    v_accvgpr_write_b32 a30, v254
    v_accvgpr_read_b32 v254, a31
    v_mul_f32 v254, v254, v255
    v_accvgpr_write_b32 a31, v254
    v_accvgpr_read_b32 v254, a40
    v_mul_f32 v254, v254, v255
    v_accvgpr_write_b32 a40, v254
    v_accvgpr_read_b32 v254, a41
    v_mul_f32 v254, v254, v255
    v_accvgpr_write_b32 a41, v254
    v_accvgpr_read_b32 v254, a42
    v_mul_f32 v254, v254, v255
    v_accvgpr_write_b32 a42, v254
    v_accvgpr_read_b32 v254, a43
    v_mul_f32 v254, v254, v255
    v_accvgpr_write_b32 a43, v254
    v_accvgpr_read_b32 v254, a52
    v_mul_f32 v254, v254, v255
    v_accvgpr_write_b32 a52, v254
    v_accvgpr_read_b32 v254, a53
    v_mul_f32 v254, v254, v255
    v_accvgpr_write_b32 a53, v254
    v_accvgpr_read_b32 v254, a54
    v_mul_f32 v254, v254, v255
    v_accvgpr_write_b32 a54, v254
    v_accvgpr_read_b32 v254, a55
    v_mul_f32 v254, v254, v255
    v_accvgpr_write_b32 a55, v254
    v_accvgpr_read_b32 v254, a64
    v_mul_f32 v254, v254, v255
    v_accvgpr_write_b32 a64, v254
    v_accvgpr_read_b32 v254, a65
    v_mul_f32 v254, v254, v255
    v_accvgpr_write_b32 a65, v254
    v_accvgpr_read_b32 v254, a66
    v_mul_f32 v254, v254, v255
    v_accvgpr_write_b32 a66, v254
    v_accvgpr_read_b32 v254, a67
    v_mul_f32 v254, v254, v255
    v_accvgpr_write_b32 a67, v254
    v_accvgpr_read_b32 v254, a76
    v_mul_f32 v254, v254, v255
    v_accvgpr_write_b32 a76, v254
    v_accvgpr_read_b32 v254, a77
    v_mul_f32 v254, v254, v255
    v_accvgpr_write_b32 a77, v254
    v_accvgpr_read_b32 v254, a78
    v_mul_f32 v254, v254, v255
    v_accvgpr_write_b32 a78, v254
    v_accvgpr_read_b32 v254, a79
    v_mul_f32 v254, v254, v255
    v_accvgpr_write_b32 a79, v254
    v_accvgpr_read_b32 v254, a88
    v_mul_f32 v254, v254, v255
    v_accvgpr_write_b32 a88, v254
    v_accvgpr_read_b32 v254, a89
    v_mul_f32 v254, v254, v255
    v_accvgpr_write_b32 a89, v254
    v_accvgpr_read_b32 v254, a90
    v_mul_f32 v254, v254, v255
    v_accvgpr_write_b32 a90, v254
    v_accvgpr_read_b32 v254, a91
    v_mul_f32 v254, v254, v255
    v_accvgpr_write_b32 a91, v254
    v_accvgpr_read_b32 v254, a100
    v_mul_f32 v254, v254, v255
    v_accvgpr_write_b32 a100, v254
    v_accvgpr_read_b32 v254, a101
    v_mul_f32 v254, v254, v255
    v_accvgpr_write_b32 a101, v254
    v_accvgpr_read_b32 v254, a102
    v_mul_f32 v254, v254, v255
    v_accvgpr_write_b32 a102, v254
    v_accvgpr_read_b32 v254, a103
    v_mul_f32 v254, v254, v255
    v_accvgpr_write_b32 a103, v254
    v_max3_f32 v250, v72, v73, v74
    v_max3_f32 v250, v250, v75, v84
    v_max3_f32 v250, v250, v85, v86
    v_max3_f32 v250, v250, v87, v96
    v_max3_f32 v250, v250, v97, v98
    v_max3_f32 v250, v250, v99, v108
    v_max3_f32 v250, v250, v109, v110
    v_max_f32 v250, v250, v111
    ds_bpermute_b32 v255, v252, v250
    s_waitcnt lgkmcnt(0)
    v_max_f32 v250, v250, v255
    ds_bpermute_b32 v255, v253, v250
    s_waitcnt lgkmcnt(0)
    v_max_f32 v250, v250, v255
    v_max_f32 v250, 0, v250
    v_sub_f32 v72, v72, v250
    v_sub_f32 v73, v73, v250
    v_sub_f32 v74, v74, v250
    v_sub_f32 v75, v75, v250
    v_sub_f32 v84, v84, v250
    v_sub_f32 v85, v85, v250
    v_sub_f32 v86, v86, v250
    v_sub_f32 v87, v87, v250
    v_sub_f32 v96, v96, v250
    v_sub_f32 v97, v97, v250
    v_sub_f32 v98, v98, v250
    v_sub_f32 v99, v99, v250
    v_sub_f32 v108, v108, v250
    v_sub_f32 v109, v109, v250
    v_sub_f32 v110, v110, v250
    v_sub_f32 v111, v111, v250
    v_sub_f32 v40, v40, v250
    v_sub_f32 v41, v41, v250
    v_sub_f32 v42, v42, v250
    v_sub_f32 v43, v43, v250
    v_sub_f32 v255, 0, v250
    v_exp_f32 v255, v255
    v_accvgpr_read_b32 v254, a8
    v_mul_f32 v254, v254, v255
    v_accvgpr_write_b32 a8, v254
    v_accvgpr_read_b32 v254, a9
    v_mul_f32 v254, v254, v255
    v_accvgpr_write_b32 a9, v254
    v_accvgpr_read_b32 v254, a10
    v_mul_f32 v254, v254, v255
    v_accvgpr_write_b32 a10, v254
    v_accvgpr_read_b32 v254, a11
    v_mul_f32 v254, v254, v255
    v_accvgpr_write_b32 a11, v254
    v_accvgpr_read_b32 v254, a20
    v_mul_f32 v254, v254, v255
    v_accvgpr_write_b32 a20, v254
    v_accvgpr_read_b32 v254, a21
    v_mul_f32 v254, v254, v255
    v_accvgpr_write_b32 a21, v254
    v_accvgpr_read_b32 v254, a22
    v_mul_f32 v254, v254, v255
    v_accvgpr_write_b32 a22, v254
    v_accvgpr_read_b32 v254, a23
    v_mul_f32 v254, v254, v255
    v_accvgpr_write_b32 a23, v254
    v_accvgpr_read_b32 v254, a32
    v_mul_f32 v254, v254, v255
    v_accvgpr_write_b32 a32, v254
    v_accvgpr_read_b32 v254, a33
    v_mul_f32 v254, v254, v255
    v_accvgpr_write_b32 a33, v254
    v_accvgpr_read_b32 v254, a34
    v_mul_f32 v254, v254, v255
    v_accvgpr_write_b32 a34, v254
    v_accvgpr_read_b32 v254, a35
    v_mul_f32 v254, v254, v255
    v_accvgpr_write_b32 a35, v254
    v_accvgpr_read_b32 v254, a44
    v_mul_f32 v254, v254, v255
    v_accvgpr_write_b32 a44, v254
    v_accvgpr_read_b32 v254, a45
    v_mul_f32 v254, v254, v255
    v_accvgpr_write_b32 a45, v254
    v_accvgpr_read_b32 v254, a46
    v_mul_f32 v254, v254, v255
    v_accvgpr_write_b32 a46, v254
    v_accvgpr_read_b32 v254, a47
    v_mul_f32 v254, v254, v255
    v_accvgpr_write_b32 a47, v254
    v_accvgpr_read_b32 v254, a56
    v_mul_f32 v254, v254, v255
    v_accvgpr_write_b32 a56, v254
    v_accvgpr_read_b32 v254, a57
    v_mul_f32 v254, v254, v255
    v_accvgpr_write_b32 a57, v254
    v_accvgpr_read_b32 v254, a58
    v_mul_f32 v254, v254, v255
    v_accvgpr_write_b32 a58, v254
    v_accvgpr_read_b32 v254, a59
    v_mul_f32 v254, v254, v255
    v_accvgpr_write_b32 a59, v254
    v_accvgpr_read_b32 v254, a68
    v_mul_f32 v254, v254, v255
    v_accvgpr_write_b32 a68, v254
    v_accvgpr_read_b32 v254, a69
    v_mul_f32 v254, v254, v255
    v_accvgpr_write_b32 a69, v254
    v_accvgpr_read_b32 v254, a70
    v_mul_f32 v254, v254, v255
    v_accvgpr_write_b32 a70, v254
    v_accvgpr_read_b32 v254, a71
    v_mul_f32 v254, v254, v255
    v_accvgpr_write_b32 a71, v254
    v_accvgpr_read_b32 v254, a80
    v_mul_f32 v254, v254, v255
    v_accvgpr_write_b32 a80, v254
    v_accvgpr_read_b32 v254, a81
    v_mul_f32 v254, v254, v255
    v_accvgpr_write_b32 a81, v254
    v_accvgpr_read_b32 v254, a82
    v_mul_f32 v254, v254, v255
    v_accvgpr_write_b32 a82, v254
    v_accvgpr_read_b32 v254, a83
    v_mul_f32 v254, v254, v255
    v_accvgpr_write_b32 a83, v254
    v_accvgpr_read_b32 v254, a92
    v_mul_f32 v254, v254, v255
    v_accvgpr_write_b32 a92, v254
    v_accvgpr_read_b32 v254, a93
    v_mul_f32 v254, v254, v255
    v_accvgpr_write_b32 a93, v254
    v_accvgpr_read_b32 v254, a94
    v_mul_f32 v254, v254, v255
    v_accvgpr_write_b32 a94, v254
    v_accvgpr_read_b32 v254, a95
    v_mul_f32 v254, v254, v255
    v_accvgpr_write_b32 a95, v254
    v_accvgpr_read_b32 v254, a104
    v_mul_f32 v254, v254, v255
    v_accvgpr_write_b32 a104, v254
    v_accvgpr_read_b32 v254, a105
    v_mul_f32 v254, v254, v255
    v_accvgpr_write_b32 a105, v254
    v_accvgpr_read_b32 v254, a106
    v_mul_f32 v254, v254, v255
    v_accvgpr_write_b32 a106, v254
    v_accvgpr_read_b32 v254, a107
    v_mul_f32 v254, v254, v255
    v_accvgpr_write_b32 a107, v254
    s_nop 7
    s_nop 7
    s_branch L_back3
L_slow4:
    s_nop 7
    s_nop 7
    v_and_b32 v254, 63, v0
    v_xor_b32 v252, 16, v254
    v_lshlrev_b32 v252, 2, v252
    v_xor_b32 v253, 32, v254
    v_lshlrev_b32 v253, 2, v253
    v_max3_f32 v248, v112, v113, v114
    v_max3_f32 v248, v248, v115, v124
    v_max3_f32 v248, v248, v125, v126
    v_max3_f32 v248, v248, v127, v136
    v_max3_f32 v248, v248, v137, v138
    v_max3_f32 v248, v248, v139, v148
    v_max3_f32 v248, v248, v149, v150
    v_max_f32 v248, v248, v151
    ds_bpermute_b32 v255, v252, v248
    s_waitcnt lgkmcnt(0)
    v_max_f32 v248, v248, v255
    ds_bpermute_b32 v255, v253, v248
    s_waitcnt lgkmcnt(0)
    v_max_f32 v248, v248, v255
    v_max_f32 v248, 0, v248
    v_sub_f32 v112, v112, v248
    v_sub_f32 v113, v113, v248
    v_sub_f32 v114, v114, v248
    v_sub_f32 v115, v115, v248
    v_sub_f32 v124, v124, v248
    v_sub_f32 v125, v125, v248
    v_sub_f32 v126, v126, v248
    v_sub_f32 v127, v127, v248
    v_sub_f32 v136, v136, v248
    v_sub_f32 v137, v137, v248
    v_sub_f32 v138, v138, v248
    v_sub_f32 v139, v139, v248
    v_sub_f32 v148, v148, v248
    v_sub_f32 v149, v149, v248
    v_sub_f32 v150, v150, v248
    v_sub_f32 v151, v151, v248
    v_sub_f32 v32, v32, v248
    v_sub_f32 v33, v33, v248
    v_sub_f32 v34, v34, v248
    v_sub_f32 v35, v35, v248
    v_sub_f32 v255, 0, v248
    v_exp_f32 v255, v255
    v_accvgpr_read_b32 v254, a0
    v_mul_f32 v254, v254, v255
    v_accvgpr_write_b32 a0, v254
    v_accvgpr_read_b32 v254, a1
    v_mul_f32 v254, v254, v255
    v_accvgpr_write_b32 a1, v254
    v_accvgpr_read_b32 v254, a2
    v_mul_f32 v254, v254, v255
    v_accvgpr_write_b32 a2, v254
    v_accvgpr_read_b32 v254, a3
    v_mul_f32 v254, v254, v255
    v_accvgpr_write_b32 a3, v254
    v_accvgpr_read_b32 v254, a12
    v_mul_f32 v254, v254, v255
    v_accvgpr_write_b32 a12, v254
    v_accvgpr_read_b32 v254, a13
    v_mul_f32 v254, v254, v255
    v_accvgpr_write_b32 a13, v254
    v_accvgpr_read_b32 v254, a14
    v_mul_f32 v254, v254, v255
    v_accvgpr_write_b32 a14, v254
    v_accvgpr_read_b32 v254, a15
    v_mul_f32 v254, v254, v255
    v_accvgpr_write_b32 a15, v254
    v_accvgpr_read_b32 v254, a24
    v_mul_f32 v254, v254, v255
    v_accvgpr_write_b32 a24, v254
    v_accvgpr_read_b32 v254, a25
    v_mul_f32 v254, v254, v255
    v_accvgpr_write_b32 a25, v254
    v_accvgpr_read_b32 v254, a26
    v_mul_f32 v254, v254, v255
    v_accvgpr_write_b32 a26, v254
    v_accvgpr_read_b32 v254, a27
    v_mul_f32 v254, v254, v255
    v_accvgpr_write_b32 a27, v254
    v_accvgpr_read_b32 v254, a36
    v_mul_f32 v254, v254, v255
    v_accvgpr_write_b32 a36, v254
    v_accvgpr_read_b32 v254, a37
    v_mul_f32 v254, v254, v255
    v_accvgpr_write_b32 a37, v254
    v_accvgpr_read_b32 v254, a38
    v_mul_f32 v254, v254, v255
    v_accvgpr_write_b32 a38, v254
    v_accvgpr_read_b32 v254, a39
    v_mul_f32 v254, v254, v255
    v_accvgpr_write_b32 a39, v254
    v_accvgpr_read_b32 v254, a48
    v_mul_f32 v254, v254, v255
    v_accvgpr_write_b32 a48, v254
    v_accvgpr_read_b32 v254, a49
    v_mul_f32 v254, v254, v255
    v_accvgpr_write_b32 a49, v254
    v_accvgpr_read_b32 v254, a50
    v_mul_f32 v254, v254, v255
    v_accvgpr_write_b32 a50, v254
    v_accvgpr_read_b32 v254, a51
    v_mul_f32 v254, v254, v255
    v_accvgpr_write_b32 a51, v254
    v_accvgpr_read_b32 v254, a60
    v_mul_f32 v254, v254, v255
    v_accvgpr_write_b32 a60, v254
    v_accvgpr_read_b32 v254, a61
    v_mul_f32 v254, v254, v255
    v_accvgpr_write_b32 a61, v254
    v_accvgpr_read_b32 v254, a62
    v_mul_f32 v254, v254, v255
    v_accvgpr_write_b32 a62, v254
    v_accvgpr_read_b32 v254, a63
    v_mul_f32 v254, v254, v255
    v_accvgpr_write_b32 a63, v254
    v_accvgpr_read_b32 v254, a72
    v_mul_f32 v254, v254, v255
    v_accvgpr_write_b32 a72, v254
    v_accvgpr_read_b32 v254, a73
    v_mul_f32 v254, v254, v255
    v_accvgpr_write_b32 a73, v254
    v_accvgpr_read_b32 v254, a74
    v_mul_f32 v254, v254, v255
    v_accvgpr_write_b32 a74, v254
    v_accvgpr_read_b32 v254, a75
    v_mul_f32 v254, v254, v255
    v_accvgpr_write_b32 a75, v254
    v_accvgpr_read_b32 v254, a84
    v_mul_f32 v254, v254, v255
    v_accvgpr_write_b32 a84, v254
    v_accvgpr_read_b32 v254, a85
    v_mul_f32 v254, v254, v255
    v_accvgpr_write_b32 a85, v254
    v_accvgpr_read_b32 v254, a86
    v_mul_f32 v254, v254, v255
    v_accvgpr_write_b32 a86, v254
    v_accvgpr_read_b32 v254, a87
    v_mul_f32 v254, v254, v255
    v_accvgpr_write_b32 a87, v254
    v_accvgpr_read_b32 v254, a96
    v_mul_f32 v254, v254, v255
    v_accvgpr_write_b32 a96, v254
    v_accvgpr_read_b32 v254, a97
    v_mul_f32 v254, v254, v255
    v_accvgpr_write_b32 a97, v254
    v_accvgpr_read_b32 v254, a98
    v_mul_f32 v254, v254, v255
    v_accvgpr_write_b32 a98, v254
    v_accvgpr_read_b32 v254, a99
    v_mul_f32 v254, v254, v255
    v_accvgpr_write_b32 a99, v254
    v_max3_f32 v249, v116, v117, v118
    v_max3_f32 v249, v249, v119, v128
    v_max3_f32 v249, v249, v129, v130
    v_max3_f32 v249, v249, v131, v140
    v_max3_f32 v249, v249, v141, v142
    v_max3_f32 v249, v249, v143, v152
    v_max3_f32 v249, v249, v153, v154
    v_max_f32 v249, v249, v155
    ds_bpermute_b32 v255, v252, v249
    s_waitcnt lgkmcnt(0)
    v_max_f32 v249, v249, v255
    ds_bpermute_b32 v255, v253, v249
    s_waitcnt lgkmcnt(0)
    v_max_f32 v249, v249, v255
    v_max_f32 v249, 0, v249
    v_sub_f32 v116, v116, v249
    v_sub_f32 v117, v117, v249
    v_sub_f32 v118, v118, v249
    v_sub_f32 v119, v119, v249
    v_sub_f32 v128, v128, v249
    v_sub_f32 v129, v129, v249
    v_sub_f32 v130, v130, v249
    v_sub_f32 v131, v131, v249
    v_sub_f32 v140, v140, v249
    v_sub_f32 v141, v141, v249
    v_sub_f32 v142, v142, v249
    v_sub_f32 v143, v143, v249
    v_sub_f32 v152, v152, v249
    v_sub_f32 v153, v153, v249
    v_sub_f32 v154, v154, v249
    v_sub_f32 v155, v155, v249
    v_sub_f32 v36, v36, v249
    v_sub_f32 v37, v37, v249
    v_sub_f32 v38, v38, v249
    v_sub_f32 v39, v39, v249
    v_sub_f32 v255, 0, v249
    v_exp_f32 v255, v255
    v_accvgpr_read_b32 v254, a4
    v_mul_f32 v254, v254, v255
    v_accvgpr_write_b32 a4, v254
    v_accvgpr_read_b32 v254, a5
    v_mul_f32 v254, v254, v255
    v_accvgpr_write_b32 a5, v254
    v_accvgpr_read_b32 v254, a6
    v_mul_f32 v254, v254, v255
    v_accvgpr_write_b32 a6, v254
    v_accvgpr_read_b32 v254, a7
    v_mul_f32 v254, v254, v255
    v_accvgpr_write_b32 a7, v254
    v_accvgpr_read_b32 v254, a16
    v_mul_f32 v254, v254, v255
    v_accvgpr_write_b32 a16, v254
    v_accvgpr_read_b32 v254, a17
    v_mul_f32 v254, v254, v255
    v_accvgpr_write_b32 a17, v254
    v_accvgpr_read_b32 v254, a18
    v_mul_f32 v254, v254, v255
    v_accvgpr_write_b32 a18, v254
    v_accvgpr_read_b32 v254, a19
    v_mul_f32 v254, v254, v255
    v_accvgpr_write_b32 a19, v254
    v_accvgpr_read_b32 v254, a28
    v_mul_f32 v254, v254, v255
    v_accvgpr_write_b32 a28, v254
    v_accvgpr_read_b32 v254, a29
    v_mul_f32 v254, v254, v255
    v_accvgpr_write_b32 a29, v254
    v_accvgpr_read_b32 v254, a30
    v_mul_f32 v254, v254, v255
    v_accvgpr_write_b32 a30, v254
    v_accvgpr_read_b32 v254, a31
    v_mul_f32 v254, v254, v255
    v_accvgpr_write_b32 a31, v254
    v_accvgpr_read_b32 v254, a40
    v_mul_f32 v254, v254, v255
    v_accvgpr_write_b32 a40, v254
    v_accvgpr_read_b32 v254, a41
    v_mul_f32 v254, v254, v255
    v_accvgpr_write_b32 a41, v254
    v_accvgpr_read_b32 v254, a42
    v_mul_f32 v254, v254, v255
    v_accvgpr_write_b32 a42, v254
    v_accvgpr_read_b32 v254, a43
    v_mul_f32 v254, v254, v255
    v_accvgpr_write_b32 a43, v254
    v_accvgpr_read_b32 v254, a52
    v_mul_f32 v254, v254, v255
    v_accvgpr_write_b32 a52, v254
    v_accvgpr_read_b32 v254, a53
    v_mul_f32 v254, v254, v255
    v_accvgpr_write_b32 a53, v254
    v_accvgpr_read_b32 v254, a54
    v_mul_f32 v254, v254, v255
    v_accvgpr_write_b32 a54, v254
    v_accvgpr_read_b32 v254, a55
    v_mul_f32 v254, v254, v255
    v_accvgpr_write_b32 a55, v254
    v_accvgpr_read_b32 v254, a64
    v_mul_f32 v254, v254, v255
    v_accvgpr_write_b32 a64, v254
    v_accvgpr_read_b32 v254, a65
    v_mul_f32 v254, v254, v255
    v_accvgpr_write_b32 a65, v254
    v_accvgpr_read_b32 v254, a66
    v_mul_f32 v254, v254, v255
    v_accvgpr_write_b32 a66, v254
    v_accvgpr_read_b32 v254, a67
    v_mul_f32 v254, v254, v255
    v_accvgpr_write_b32 a67, v254
    v_accvgpr_read_b32 v254, a76
    v_mul_f32 v254, v254, v255
    v_accvgpr_write_b32 a76, v254
    v_accvgpr_read_b32 v254, a77
    v_mul_f32 v254, v254, v255
    v_accvgpr_write_b32 a77, v254
    v_accvgpr_read_b32 v254, a78
    v_mul_f32 v254, v254, v255
    v_accvgpr_write_b32 a78, v254
    v_accvgpr_read_b32 v254, a79
    v_mul_f32 v254, v254, v255
    v_accvgpr_write_b32 a79, v254
    v_accvgpr_read_b32 v254, a88
    v_mul_f32 v254, v254, v255
    v_accvgpr_write_b32 a88, v254
    v_accvgpr_read_b32 v254, a89
    v_mul_f32 v254, v254, v255
    v_accvgpr_write_b32 a89, v254
    v_accvgpr_read_b32 v254, a90
    v_mul_f32 v254, v254, v255
    v_accvgpr_write_b32 a90, v254
    v_accvgpr_read_b32 v254, a91
    v_mul_f32 v254, v254, v255
    v_accvgpr_write_b32 a91, v254
    v_accvgpr_read_b32 v254, a100
    v_mul_f32 v254, v254, v255
    v_accvgpr_write_b32 a100, v254
    v_accvgpr_read_b32 v254, a101
    v_mul_f32 v254, v254, v255
    v_accvgpr_write_b32 a101, v254
    v_accvgpr_read_b32 v254, a102
    v_mul_f32 v254, v254, v255
    v_accvgpr_write_b32 a102, v254
    v_accvgpr_read_b32 v254, a103
    v_mul_f32 v254, v254, v255
    v_accvgpr_write_b32 a103, v254
    v_max3_f32 v250, v120, v121, v122
    v_max3_f32 v250, v250, v123, v132
    v_max3_f32 v250, v250, v133, v134
    v_max3_f32 v250, v250, v135, v144
    v_max3_f32 v250, v250, v145, v146
    v_max3_f32 v250, v250, v147, v156
    v_max3_f32 v250, v250, v157, v158
    v_max_f32 v250, v250, v159
    ds_bpermute_b32 v255, v252, v250
    s_waitcnt lgkmcnt(0)
    v_max_f32 v250, v250, v255
    ds_bpermute_b32 v255, v253, v250
    s_waitcnt lgkmcnt(0)
    v_max_f32 v250, v250, v255
    v_max_f32 v250, 0, v250
    v_sub_f32 v120, v120, v250
    v_sub_f32 v121, v121, v250
    v_sub_f32 v122, v122, v250
    v_sub_f32 v123, v123, v250
    v_sub_f32 v132, v132, v250
    v_sub_f32 v133, v133, v250
    v_sub_f32 v134, v134, v250
    v_sub_f32 v135, v135, v250
    v_sub_f32 v144, v144, v250
    v_sub_f32 v145, v145, v250
    v_sub_f32 v146, v146, v250
    v_sub_f32 v147, v147, v250
    v_sub_f32 v156, v156, v250
    v_sub_f32 v157, v157, v250
    v_sub_f32 v158, v158, v250
    v_sub_f32 v159, v159, v250
    v_sub_f32 v40, v40, v250
    v_sub_f32 v41, v41, v250
    v_sub_f32 v42, v42, v250
    v_sub_f32 v43, v43, v250
    v_sub_f32 v255, 0, v250
    v_exp_f32 v255, v255
    v_accvgpr_read_b32 v254, a8
    v_mul_f32 v254, v254, v255
    v_accvgpr_write_b32 a8, v254
    v_accvgpr_read_b32 v254, a9
    v_mul_f32 v254, v254, v255
    v_accvgpr_write_b32 a9, v254
    v_accvgpr_read_b32 v254, a10
    v_mul_f32 v254, v254, v255
    v_accvgpr_write_b32 a10, v254
    v_accvgpr_read_b32 v254, a11
    v_mul_f32 v254, v254, v255
    v_accvgpr_write_b32 a11, v254
    v_accvgpr_read_b32 v254, a20
    v_mul_f32 v254, v254, v255
    v_accvgpr_write_b32 a20, v254
    v_accvgpr_read_b32 v254, a21
    v_mul_f32 v254, v254, v255
    v_accvgpr_write_b32 a21, v254
    v_accvgpr_read_b32 v254, a22
    v_mul_f32 v254, v254, v255
    v_accvgpr_write_b32 a22, v254
    v_accvgpr_read_b32 v254, a23
    v_mul_f32 v254, v254, v255
    v_accvgpr_write_b32 a23, v254
    v_accvgpr_read_b32 v254, a32
    v_mul_f32 v254, v254, v255
    v_accvgpr_write_b32 a32, v254
    v_accvgpr_read_b32 v254, a33
    v_mul_f32 v254, v254, v255
    v_accvgpr_write_b32 a33, v254
    v_accvgpr_read_b32 v254, a34
    v_mul_f32 v254, v254, v255
    v_accvgpr_write_b32 a34, v254
    v_accvgpr_read_b32 v254, a35
    v_mul_f32 v254, v254, v255
    v_accvgpr_write_b32 a35, v254
    v_accvgpr_read_b32 v254, a44
    v_mul_f32 v254, v254, v255
    v_accvgpr_write_b32 a44, v254
    v_accvgpr_read_b32 v254, a45
    v_mul_f32 v254, v254, v255
    v_accvgpr_write_b32 a45, v254
    v_accvgpr_read_b32 v254, a46
    v_mul_f32 v254, v254, v255
    v_accvgpr_write_b32 a46, v254
    v_accvgpr_read_b32 v254, a47
    v_mul_f32 v254, v254, v255
    v_accvgpr_write_b32 a47, v254
    v_accvgpr_read_b32 v254, a56
    v_mul_f32 v254, v254, v255
    v_accvgpr_write_b32 a56, v254
    v_accvgpr_read_b32 v254, a57
    v_mul_f32 v254, v254, v255
    v_accvgpr_write_b32 a57, v254
    v_accvgpr_read_b32 v254, a58
    v_mul_f32 v254, v254, v255
    v_accvgpr_write_b32 a58, v254
    v_accvgpr_read_b32 v254, a59
    v_mul_f32 v254, v254, v255
    v_accvgpr_write_b32 a59, v254
    v_accvgpr_read_b32 v254, a68
    v_mul_f32 v254, v254, v255
    v_accvgpr_write_b32 a68, v254
    v_accvgpr_read_b32 v254, a69
    v_mul_f32 v254, v254, v255
    v_accvgpr_write_b32 a69, v254
    v_accvgpr_read_b32 v254, a70
    v_mul_f32 v254, v254, v255
    v_accvgpr_write_b32 a70, v254
    v_accvgpr_read_b32 v254, a71
    v_mul_f32 v254, v254, v255
    v_accvgpr_write_b32 a71, v254
    v_accvgpr_read_b32 v254, a80
    v_mul_f32 v254, v254, v255
    v_accvgpr_write_b32 a80, v254
    v_accvgpr_read_b32 v254, a81
    v_mul_f32 v254, v254, v255
    v_accvgpr_write_b32 a81, v254
    v_accvgpr_read_b32 v254, a82
    v_mul_f32 v254, v254, v255
    v_accvgpr_write_b32 a82, v254
    v_accvgpr_read_b32 v254, a83
    v_mul_f32 v254, v254, v255
    v_accvgpr_write_b32 a83, v254
    v_accvgpr_read_b32 v254, a92
    v_mul_f32 v254, v254, v255
    v_accvgpr_write_b32 a92, v254
    v_accvgpr_read_b32 v254, a93
    v_mul_f32 v254, v254, v255
    v_accvgpr_write_b32 a93, v254
    v_accvgpr_read_b32 v254, a94
    v_mul_f32 v254, v254, v255
    v_accvgpr_write_b32 a94, v254
    v_accvgpr_read_b32 v254, a95
    v_mul_f32 v254, v254, v255
    v_accvgpr_write_b32 a95, v254
    v_accvgpr_read_b32 v254, a104
    v_mul_f32 v254, v254, v255
    v_accvgpr_write_b32 a104, v254
    v_accvgpr_read_b32 v254, a105
    v_mul_f32 v254, v254, v255
    v_accvgpr_write_b32 a105, v254
    v_accvgpr_read_b32 v254, a106
    v_mul_f32 v254, v254, v255
    v_accvgpr_write_b32 a106, v254
    v_accvgpr_read_b32 v254, a107
    v_mul_f32 v254, v254, v255
    v_accvgpr_write_b32 a107, v254
    s_nop 7
    s_nop 7
    s_branch L_back4
L_slow5:
    s_nop 7
    s_nop 7
    v_and_b32 v254, 63, v0
    v_xor_b32 v252, 16, v254
    v_lshlrev_b32 v252, 2, v252
    v_xor_b32 v253, 32, v254
    v_lshlrev_b32 v253, 2, v253
    v_max3_f32 v248, v64, v65, v66
    v_max3_f32 v248, v248, v67, v76
    v_max3_f32 v248, v248, v77, v78
    v_max3_f32 v248, v248, v79, v88
    v_max3_f32 v248, v248, v89, v90
    v_max3_f32 v248, v248, v91, v100
    v_max3_f32 v248, v248, v101, v102
    v_max_f32 v248, v248, v103
    ds_bpermute_b32 v255, v252, v248
    s_waitcnt lgkmcnt(0)
    v_max_f32 v248, v248, v255
    ds_bpermute_b32 v255, v253, v248
    s_waitcnt lgkmcnt(0)
    v_max_f32 v248, v248, v255
    v_max_f32 v248, 0, v248
    v_sub_f32 v64, v64, v248
    v_sub_f32 v65, v65, v248
    v_sub_f32 v66, v66, v248
    v_sub_f32 v67, v67, v248
    v_sub_f32 v76, v76, v248
    v_sub_f32 v77, v77, v248
    v_sub_f32 v78, v78, v248
    v_sub_f32 v79, v79, v248
    v_sub_f32 v88, v88, v248
    v_sub_f32 v89, v89, v248
    v_sub_f32 v90, v90, v248
    v_sub_f32 v91, v91, v248
    v_sub_f32 v100, v100, v248
    v_sub_f32 v101, v101, v248
    v_sub_f32 v102, v102, v248
    v_sub_f32 v103, v103, v248
    v_sub_f32 v32, v32, v248
    v_sub_f32 v33, v33, v248
    v_sub_f32 v34, v34, v248
    v_sub_f32 v35, v35, v248
    v_sub_f32 v255, 0, v248
    v_exp_f32 v255, v255
    v_accvgpr_read_b32 v254, a0
    v_mul_f32 v254, v254, v255
    v_accvgpr_write_b32 a0, v254
    v_accvgpr_read_b32 v254, a1
    v_mul_f32 v254, v254, v255
    v_accvgpr_write_b32 a1, v254
    v_accvgpr_read_b32 v254, a2
    v_mul_f32 v254, v254, v255
    v_accvgpr_write_b32 a2, v254
    v_accvgpr_read_b32 v254, a3
    v_mul_f32 v254, v254, v255
    v_accvgpr_write_b32 a3, v254
    v_accvgpr_read_b32 v254, a12
    v_mul_f32 v254, v254, v255
    v_accvgpr_write_b32 a12, v254
    v_accvgpr_read_b32 v254, a13
    v_mul_f32 v254, v254, v255
    v_accvgpr_write_b32 a13, v254
    v_accvgpr_read_b32 v254, a14
    v_mul_f32 v254, v254, v255
    v_accvgpr_write_b32 a14, v254
    v_accvgpr_read_b32 v254, a15
    v_mul_f32 v254, v254, v255
    v_accvgpr_write_b32 a15, v254
    v_accvgpr_read_b32 v254, a24
    v_mul_f32 v254, v254, v255
    v_accvgpr_write_b32 a24, v254
    v_accvgpr_read_b32 v254, a25
    v_mul_f32 v254, v254, v255
    v_accvgpr_write_b32 a25, v254
    v_accvgpr_read_b32 v254, a26
    v_mul_f32 v254, v254, v255
    v_accvgpr_write_b32 a26, v254
    v_accvgpr_read_b32 v254, a27
    v_mul_f32 v254, v254, v255
    v_accvgpr_write_b32 a27, v254
    v_accvgpr_read_b32 v254, a36
    v_mul_f32 v254, v254, v255
    v_accvgpr_write_b32 a36, v254
    v_accvgpr_read_b32 v254, a37
    v_mul_f32 v254, v254, v255
    v_accvgpr_write_b32 a37, v254
    v_accvgpr_read_b32 v254, a38
    v_mul_f32 v254, v254, v255
    v_accvgpr_write_b32 a38, v254
    v_accvgpr_read_b32 v254, a39
    v_mul_f32 v254, v254, v255
    v_accvgpr_write_b32 a39, v254
    v_accvgpr_read_b32 v254, a48
    v_mul_f32 v254, v254, v255
    v_accvgpr_write_b32 a48, v254
    v_accvgpr_read_b32 v254, a49
    v_mul_f32 v254, v254, v255
    v_accvgpr_write_b32 a49, v254
    v_accvgpr_read_b32 v254, a50
    v_mul_f32 v254, v254, v255
    v_accvgpr_write_b32 a50, v254
    v_accvgpr_read_b32 v254, a51
    v_mul_f32 v254, v254, v255
    v_accvgpr_write_b32 a51, v254
    v_accvgpr_read_b32 v254, a60
    v_mul_f32 v254, v254, v255
    v_accvgpr_write_b32 a60, v254
    v_accvgpr_read_b32 v254, a61
    v_mul_f32 v254, v254, v255
    v_accvgpr_write_b32 a61, v254
    v_accvgpr_read_b32 v254, a62
    v_mul_f32 v254, v254, v255
    v_accvgpr_write_b32 a62, v254
    v_accvgpr_read_b32 v254, a63
    v_mul_f32 v254, v254, v255
    v_accvgpr_write_b32 a63, v254
    v_accvgpr_read_b32 v254, a72
    v_mul_f32 v254, v254, v255
    v_accvgpr_write_b32 a72, v254
    v_accvgpr_read_b32 v254, a73
    v_mul_f32 v254, v254, v255
    v_accvgpr_write_b32 a73, v254
    v_accvgpr_read_b32 v254, a74
    v_mul_f32 v254, v254, v255
    v_accvgpr_write_b32 a74, v254
    v_accvgpr_read_b32 v254, a75
    v_mul_f32 v254, v254, v255
    v_accvgpr_write_b32 a75, v254
    v_accvgpr_read_b32 v254, a84
    v_mul_f32 v254, v254, v255
    v_accvgpr_write_b32 a84, v254
    v_accvgpr_read_b32 v254, a85
    v_mul_f32 v254, v254, v255
    v_accvgpr_write_b32 a85, v254
    v_accvgpr_read_b32 v254, a86
    v_mul_f32 v254, v254, v255
    v_accvgpr_write_b32 a86, v254
    v_accvgpr_read_b32 v254, a87
    v_mul_f32 v254, v254, v255
    v_accvgpr_write_b32 a87, v254
    v_accvgpr_read_b32 v254, a96
    v_mul_f32 v254, v254, v255
    v_accvgpr_write_b32 a96, v254
    v_accvgpr_read_b32 v254, a97
    v_mul_f32 v254, v254, v255
    v_accvgpr_write_b32 a97, v254
    v_accvgpr_read_b32 v254, a98
    v_mul_f32 v254, v254, v255
    v_accvgpr_write_b32 a98, v254
    v_accvgpr_read_b32 v254, a99
    v_mul_f32 v254, v254, v255
    v_accvgpr_write_b32 a99, v254
    v_max3_f32 v249, v68, v69, v70
    v_max3_f32 v249, v249, v71, v80
    v_max3_f32 v249, v249, v81, v82
    v_max3_f32 v249, v249, v83, v92
    v_max3_f32 v249, v249, v93, v94
    v_max3_f32 v249, v249, v95, v104
    v_max3_f32 v249, v249, v105, v106
    v_max_f32 v249, v249, v107
    ds_bpermute_b32 v255, v252, v249
    s_waitcnt lgkmcnt(0)
    v_max_f32 v249, v249, v255
    ds_bpermute_b32 v255, v253, v249
    s_waitcnt lgkmcnt(0)
    v_max_f32 v249, v249, v255
    v_max_f32 v249, 0, v249
    v_sub_f32 v68, v68, v249
    v_sub_f32 v69, v69, v249
    v_sub_f32 v70, v70, v249
    v_sub_f32 v71, v71, v249
    v_sub_f32 v80, v80, v249
    v_sub_f32 v81, v81, v249
    v_sub_f32 v82, v82, v249
    v_sub_f32 v83, v83, v249
    v_sub_f32 v92, v92, v249
    v_sub_f32 v93, v93, v249
    v_sub_f32 v94, v94, v249
    v_sub_f32 v95, v95, v249
    v_sub_f32 v104, v104, v249
    v_sub_f32 v105, v105, v249
    v_sub_f32 v106, v106, v249
    v_sub_f32 v107, v107, v249
    v_sub_f32 v36, v36, v249
    v_sub_f32 v37, v37, v249
    v_sub_f32 v38, v38, v249
    v_sub_f32 v39, v39, v249
    v_sub_f32 v255, 0, v249
    v_exp_f32 v255, v255
    v_accvgpr_read_b32 v254, a4
    v_mul_f32 v254, v254, v255
    v_accvgpr_write_b32 a4, v254
    v_accvgpr_read_b32 v254, a5
    v_mul_f32 v254, v254, v255
    v_accvgpr_write_b32 a5, v254
    v_accvgpr_read_b32 v254, a6
    v_mul_f32 v254, v254, v255
    v_accvgpr_write_b32 a6, v254
    v_accvgpr_read_b32 v254, a7
    v_mul_f32 v254, v254, v255
    v_accvgpr_write_b32 a7, v254
    v_accvgpr_read_b32 v254, a16
    v_mul_f32 v254, v254, v255
    v_accvgpr_write_b32 a16, v254
    v_accvgpr_read_b32 v254, a17
    v_mul_f32 v254, v254, v255
    v_accvgpr_write_b32 a17, v254
    v_accvgpr_read_b32 v254, a18
    v_mul_f32 v254, v254, v255
    v_accvgpr_write_b32 a18, v254
    v_accvgpr_read_b32 v254, a19
    v_mul_f32 v254, v254, v255
    v_accvgpr_write_b32 a19, v254
    v_accvgpr_read_b32 v254, a28
    v_mul_f32 v254, v254, v255
    v_accvgpr_write_b32 a28, v254
    v_accvgpr_read_b32 v254, a29
    v_mul_f32 v254, v254, v255
    v_accvgpr_write_b32 a29, v254
    v_accvgpr_read_b32 v254, a30
    v_mul_f32 v254, v254, v255
    v_accvgpr_write_b32 a30, v254
    v_accvgpr_read_b32 v254, a31
    v_mul_f32 v254, v254, v255
    v_accvgpr_write_b32 a31, v254
    v_accvgpr_read_b32 v254, a40
    v_mul_f32 v254, v254, v255
    v_accvgpr_write_b32 a40, v254
    v_accvgpr_read_b32 v254, a41
    v_mul_f32 v254, v254, v255
    v_accvgpr_write_b32 a41, v254
    v_accvgpr_read_b32 v254, a42
    v_mul_f32 v254, v254, v255
    v_accvgpr_write_b32 a42, v254
    v_accvgpr_read_b32 v254, a43
    v_mul_f32 v254, v254, v255
    v_accvgpr_write_b32 a43, v254
    v_accvgpr_read_b32 v254, a52
    v_mul_f32 v254, v254, v255
    v_accvgpr_write_b32 a52, v254
    v_accvgpr_read_b32 v254, a53
    v_mul_f32 v254, v254, v255
    v_accvgpr_write_b32 a53, v254
    v_accvgpr_read_b32 v254, a54
    v_mul_f32 v254, v254, v255
    v_accvgpr_write_b32 a54, v254
    v_accvgpr_read_b32 v254, a55
    v_mul_f32 v254, v254, v255
    v_accvgpr_write_b32 a55, v254
    v_accvgpr_read_b32 v254, a64
    v_mul_f32 v254, v254, v255
    v_accvgpr_write_b32 a64, v254
    v_accvgpr_read_b32 v254, a65
    v_mul_f32 v254, v254, v255
    v_accvgpr_write_b32 a65, v254
    v_accvgpr_read_b32 v254, a66
    v_mul_f32 v254, v254, v255
    v_accvgpr_write_b32 a66, v254
    v_accvgpr_read_b32 v254, a67
    v_mul_f32 v254, v254, v255
    v_accvgpr_write_b32 a67, v254
    v_accvgpr_read_b32 v254, a76
    v_mul_f32 v254, v254, v255
    v_accvgpr_write_b32 a76, v254
    v_accvgpr_read_b32 v254, a77
    v_mul_f32 v254, v254, v255
    v_accvgpr_write_b32 a77, v254
    v_accvgpr_read_b32 v254, a78
    v_mul_f32 v254, v254, v255
    v_accvgpr_write_b32 a78, v254
    v_accvgpr_read_b32 v254, a79
    v_mul_f32 v254, v254, v255
    v_accvgpr_write_b32 a79, v254
    v_accvgpr_read_b32 v254, a88
    v_mul_f32 v254, v254, v255
    v_accvgpr_write_b32 a88, v254
    v_accvgpr_read_b32 v254, a89
    v_mul_f32 v254, v254, v255
    v_accvgpr_write_b32 a89, v254
    v_accvgpr_read_b32 v254, a90
    v_mul_f32 v254, v254, v255
    v_accvgpr_write_b32 a90, v254
    v_accvgpr_read_b32 v254, a91
    v_mul_f32 v254, v254, v255
    v_accvgpr_write_b32 a91, v254
    v_accvgpr_read_b32 v254, a100
    v_mul_f32 v254, v254, v255
    v_accvgpr_write_b32 a100, v254
    v_accvgpr_read_b32 v254, a101
    v_mul_f32 v254, v254, v255
    v_accvgpr_write_b32 a101, v254
    v_accvgpr_read_b32 v254, a102
    v_mul_f32 v254, v254, v255
    v_accvgpr_write_b32 a102, v254
    v_accvgpr_read_b32 v254, a103
    v_mul_f32 v254, v254, v255
    v_accvgpr_write_b32 a103, v254
    v_max3_f32 v250, v72, v73, v74
    v_max3_f32 v250, v250, v75, v84
    v_max3_f32 v250, v250, v85, v86
    v_max3_f32 v250, v250, v87, v96
    v_max3_f32 v250, v250, v97, v98
    v_max3_f32 v250, v250, v99, v108
    v_max3_f32 v250, v250, v109, v110
    v_max_f32 v250, v250, v111
    ds_bpermute_b32 v255, v252, v250
    s_waitcnt lgkmcnt(0)
    v_max_f32 v250, v250, v255
    ds_bpermute_b32 v255, v253, v250
    s_waitcnt lgkmcnt(0)
    v_max_f32 v250, v250, v255
    v_max_f32 v250, 0, v250
    v_sub_f32 v72, v72, v250
    v_sub_f32 v73, v73, v250
    v_sub_f32 v74, v74, v250
    v_sub_f32 v75, v75, v250
    v_sub_f32 v84, v84, v250
    v_sub_f32 v85, v85, v250
    v_sub_f32 v86, v86, v250
    v_sub_f32 v87, v87, v250
    v_sub_f32 v96, v96, v250
    v_sub_f32 v97, v97, v250
    v_sub_f32 v98, v98, v250
    v_sub_f32 v99, v99, v250
    v_sub_f32 v108, v108, v250
    v_sub_f32 v109, v109, v250
    v_sub_f32 v110, v110, v250
    v_sub_f32 v111, v111, v250
    v_sub_f32 v40, v40, v250
    v_sub_f32 v41, v41, v250
    v_sub_f32 v42, v42, v250
    v_sub_f32 v43, v43, v250
    v_sub_f32 v255, 0, v250
    v_exp_f32 v255, v255
    v_accvgpr_read_b32 v254, a8
    v_mul_f32 v254, v254, v255
    v_accvgpr_write_b32 a8, v254
    v_accvgpr_read_b32 v254, a9
    v_mul_f32 v254, v254, v255
    v_accvgpr_write_b32 a9, v254
    v_accvgpr_read_b32 v254, a10
    v_mul_f32 v254, v254, v255
    v_accvgpr_write_b32 a10, v254
    v_accvgpr_read_b32 v254, a11
    v_mul_f32 v254, v254, v255
    v_accvgpr_write_b32 a11, v254
    v_accvgpr_read_b32 v254, a20
    v_mul_f32 v254, v254, v255
    v_accvgpr_write_b32 a20, v254
    v_accvgpr_read_b32 v254, a21
    v_mul_f32 v254, v254, v255
    v_accvgpr_write_b32 a21, v254
    v_accvgpr_read_b32 v254, a22
    v_mul_f32 v254, v254, v255
    v_accvgpr_write_b32 a22, v254
    v_accvgpr_read_b32 v254, a23
    v_mul_f32 v254, v254, v255
    v_accvgpr_write_b32 a23, v254
    v_accvgpr_read_b32 v254, a32
    v_mul_f32 v254, v254, v255
    v_accvgpr_write_b32 a32, v254
    v_accvgpr_read_b32 v254, a33
    v_mul_f32 v254, v254, v255
    v_accvgpr_write_b32 a33, v254
    v_accvgpr_read_b32 v254, a34
    v_mul_f32 v254, v254, v255
    v_accvgpr_write_b32 a34, v254
    v_accvgpr_read_b32 v254, a35
    v_mul_f32 v254, v254, v255
    v_accvgpr_write_b32 a35, v254
    v_accvgpr_read_b32 v254, a44
    v_mul_f32 v254, v254, v255
    v_accvgpr_write_b32 a44, v254
    v_accvgpr_read_b32 v254, a45
    v_mul_f32 v254, v254, v255
    v_accvgpr_write_b32 a45, v254
    v_accvgpr_read_b32 v254, a46
    v_mul_f32 v254, v254, v255
    v_accvgpr_write_b32 a46, v254
    v_accvgpr_read_b32 v254, a47
    v_mul_f32 v254, v254, v255
    v_accvgpr_write_b32 a47, v254
    v_accvgpr_read_b32 v254, a56
    v_mul_f32 v254, v254, v255
    v_accvgpr_write_b32 a56, v254
    v_accvgpr_read_b32 v254, a57
    v_mul_f32 v254, v254, v255
    v_accvgpr_write_b32 a57, v254
    v_accvgpr_read_b32 v254, a58
    v_mul_f32 v254, v254, v255
    v_accvgpr_write_b32 a58, v254
    v_accvgpr_read_b32 v254, a59
    v_mul_f32 v254, v254, v255
    v_accvgpr_write_b32 a59, v254
    v_accvgpr_read_b32 v254, a68
    v_mul_f32 v254, v254, v255
    v_accvgpr_write_b32 a68, v254
    v_accvgpr_read_b32 v254, a69
    v_mul_f32 v254, v254, v255
    v_accvgpr_write_b32 a69, v254
    v_accvgpr_read_b32 v254, a70
    v_mul_f32 v254, v254, v255
    v_accvgpr_write_b32 a70, v254
    v_accvgpr_read_b32 v254, a71
    v_mul_f32 v254, v254, v255
    v_accvgpr_write_b32 a71, v254
    v_accvgpr_read_b32 v254, a80
    v_mul_f32 v254, v254, v255
    v_accvgpr_write_b32 a80, v254
    v_accvgpr_read_b32 v254, a81
    v_mul_f32 v254, v254, v255
    v_accvgpr_write_b32 a81, v254
    v_accvgpr_read_b32 v254, a82
    v_mul_f32 v254, v254, v255
    v_accvgpr_write_b32 a82, v254
    v_accvgpr_read_b32 v254, a83
    v_mul_f32 v254, v254, v255
    v_accvgpr_write_b32 a83, v254
    v_accvgpr_read_b32 v254, a92
    v_mul_f32 v254, v254, v255
    v_accvgpr_write_b32 a92, v254
    v_accvgpr_read_b32 v254, a93
    v_mul_f32 v254, v254, v255
    v_accvgpr_write_b32 a93, v254
    v_accvgpr_read_b32 v254, a94
    v_mul_f32 v254, v254, v255
    v_accvgpr_write_b32 a94, v254
    v_accvgpr_read_b32 v254, a95
    v_mul_f32 v254, v254, v255
    v_accvgpr_write_b32 a95, v254
    v_accvgpr_read_b32 v254, a104
    v_mul_f32 v254, v254, v255
    v_accvgpr_write_b32 a104, v254
    v_accvgpr_read_b32 v254, a105
    v_mul_f32 v254, v254, v255
    v_accvgpr_write_b32 a105, v254
    v_accvgpr_read_b32 v254, a106
    v_mul_f32 v254, v254, v255
    v_accvgpr_write_b32 a106, v254
    v_accvgpr_read_b32 v254, a107
    v_mul_f32 v254, v254, v255
    v_accvgpr_write_b32 a107, v254
    s_nop 7
    s_nop 7
    s_branch L_back5
L_slow6:
    s_nop 7
    s_nop 7
    v_and_b32 v254, 63, v0
    v_xor_b32 v252, 16, v254
    v_lshlrev_b32 v252, 2, v252
    v_xor_b32 v253, 32, v254
    v_lshlrev_b32 v253, 2, v253
    v_max3_f32 v248, v112, v113, v114
    v_max3_f32 v248, v248, v115, v124
    v_max3_f32 v248, v248, v125, v126
    v_max3_f32 v248, v248, v127, v136
    v_max3_f32 v248, v248, v137, v138
    v_max3_f32 v248, v248, v139, v148
    v_max3_f32 v248, v248, v149, v150
    v_max_f32 v248, v248, v151
    ds_bpermute_b32 v255, v252, v248
    s_waitcnt lgkmcnt(0)
    v_max_f32 v248, v248, v255
    ds_bpermute_b32 v255, v253, v248
    s_waitcnt lgkmcnt(0)
    v_max_f32 v248, v248, v255
    v_max_f32 v248, 0, v248
    v_sub_f32 v112, v112, v248
    v_sub_f32 v113, v113, v248
    v_sub_f32 v114, v114, v248
    v_sub_f32 v115, v115, v248
    v_sub_f32 v124, v124, v248
    v_sub_f32 v125, v125, v248
    v_sub_f32 v126, v126, v248
    v_sub_f32 v127, v127, v248
    v_sub_f32 v136, v136, v248
    v_sub_f32 v137, v137, v248
    v_sub_f32 v138, v138, v248
    v_sub_f32 v139, v139, v248
    v_sub_f32 v148, v148, v248
    v_sub_f32 v149, v149, v248
    v_sub_f32 v150, v150, v248
    v_sub_f32 v151, v151, v248
    v_sub_f32 v32, v32, v248
    v_sub_f32 v33, v33, v248
    v_sub_f32 v34, v34, v248
    v_sub_f32 v35, v35, v248
    v_sub_f32 v255, 0, v248
    v_exp_f32 v255, v255
    v_accvgpr_read_b32 v254, a0
    v_mul_f32 v254, v254, v255
    v_accvgpr_write_b32 a0, v254
    v_accvgpr_read_b32 v254, a1
    v_mul_f32 v254, v254, v255
    v_accvgpr_write_b32 a1, v254
    v_accvgpr_read_b32 v254, a2
    v_mul_f32 v254, v254, v255
    v_accvgpr_write_b32 a2, v254
    v_accvgpr_read_b32 v254, a3
    v_mul_f32 v254, v254, v255
    v_accvgpr_write_b32 a3, v254
    v_accvgpr_read_b32 v254, a12
    v_mul_f32 v254, v254, v255
    v_accvgpr_write_b32 a12, v254
    v_accvgpr_read_b32 v254, a13
    v_mul_f32 v254, v254, v255
    v_accvgpr_write_b32 a13, v254
    v_accvgpr_read_b32 v254, a14
    v_mul_f32 v254, v254, v255
    v_accvgpr_write_b32 a14, v254
    v_accvgpr_read_b32 v254, a15
    v_mul_f32 v254, v254, v255
    v_accvgpr_write_b32 a15, v254
    v_accvgpr_read_b32 v254, a24
    v_mul_f32 v254, v254, v255
    v_accvgpr_write_b32 a24, v254
    v_accvgpr_read_b32 v254, a25
    v_mul_f32 v254, v254, v255
    v_accvgpr_write_b32 a25, v254
    v_accvgpr_read_b32 v254, a26
    v_mul_f32 v254, v254, v255
    v_accvgpr_write_b32 a26, v254
    v_accvgpr_read_b32 v254, a27
    v_mul_f32 v254, v254, v255
    v_accvgpr_write_b32 a27, v254
    v_accvgpr_read_b32 v254, a36
    v_mul_f32 v254, v254, v255
    v_accvgpr_write_b32 a36, v254
    v_accvgpr_read_b32 v254, a37
    v_mul_f32 v254, v254, v255
    v_accvgpr_write_b32 a37, v254
    v_accvgpr_read_b32 v254, a38
    v_mul_f32 v254, v254, v255
    v_accvgpr_write_b32 a38, v254
    v_accvgpr_read_b32 v254, a39
    v_mul_f32 v254, v254, v255
    v_accvgpr_write_b32 a39, v254
    v_accvgpr_read_b32 v254, a48
    v_mul_f32 v254, v254, v255
    v_accvgpr_write_b32 a48, v254
    v_accvgpr_read_b32 v254, a49
    v_mul_f32 v254, v254, v255
    v_accvgpr_write_b32 a49, v254
    v_accvgpr_read_b32 v254, a50
    v_mul_f32 v254, v254, v255
    v_accvgpr_write_b32 a50, v254
    v_accvgpr_read_b32 v254, a51
    v_mul_f32 v254, v254, v255
    v_accvgpr_write_b32 a51, v254
    v_accvgpr_read_b32 v254, a60
    v_mul_f32 v254, v254, v255
    v_accvgpr_write_b32 a60, v254
    v_accvgpr_read_b32 v254, a61
    v_mul_f32 v254, v254, v255
    v_accvgpr_write_b32 a61, v254
    v_accvgpr_read_b32 v254, a62
    v_mul_f32 v254, v254, v255
    v_accvgpr_write_b32 a62, v254
    v_accvgpr_read_b32 v254, a63
    v_mul_f32 v254, v254, v255
    v_accvgpr_write_b32 a63, v254
    v_accvgpr_read_b32 v254, a72
    v_mul_f32 v254, v254, v255
    v_accvgpr_write_b32 a72, v254
    v_accvgpr_read_b32 v254, a73
    v_mul_f32 v254, v254, v255
    v_accvgpr_write_b32 a73, v254
    v_accvgpr_read_b32 v254, a74
    v_mul_f32 v254, v254, v255
    v_accvgpr_write_b32 a74, v254
    v_accvgpr_read_b32 v254, a75
    v_mul_f32 v254, v254, v255
    v_accvgpr_write_b32 a75, v254
    v_accvgpr_read_b32 v254, a84
    v_mul_f32 v254, v254, v255
    v_accvgpr_write_b32 a84, v254
    v_accvgpr_read_b32 v254, a85
    v_mul_f32 v254, v254, v255
    v_accvgpr_write_b32 a85, v254
    v_accvgpr_read_b32 v254, a86
    v_mul_f32 v254, v254, v255
    v_accvgpr_write_b32 a86, v254
    v_accvgpr_read_b32 v254, a87
    v_mul_f32 v254, v254, v255
    v_accvgpr_write_b32 a87, v254
    v_accvgpr_read_b32 v254, a96
    v_mul_f32 v254, v254, v255
    v_accvgpr_write_b32 a96, v254
    v_accvgpr_read_b32 v254, a97
    v_mul_f32 v254, v254, v255
    v_accvgpr_write_b32 a97, v254
    v_accvgpr_read_b32 v254, a98
    v_mul_f32 v254, v254, v255
    v_accvgpr_write_b32 a98, v254
    v_accvgpr_read_b32 v254, a99
    v_mul_f32 v254, v254, v255
    v_accvgpr_write_b32 a99, v254
    v_max3_f32 v249, v116, v117, v118
    v_max3_f32 v249, v249, v119, v128
    v_max3_f32 v249, v249, v129, v130
    v_max3_f32 v249, v249, v131, v140
    v_max3_f32 v249, v249, v141, v142
    v_max3_f32 v249, v249, v143, v152
    v_max3_f32 v249, v249, v153, v154
    v_max_f32 v249, v249, v155
    ds_bpermute_b32 v255, v252, v249
    s_waitcnt lgkmcnt(0)
    v_max_f32 v249, v249, v255
    ds_bpermute_b32 v255, v253, v249
    s_waitcnt lgkmcnt(0)
    v_max_f32 v249, v249, v255
    v_max_f32 v249, 0, v249
    v_sub_f32 v116, v116, v249
    v_sub_f32 v117, v117, v249
    v_sub_f32 v118, v118, v249
    v_sub_f32 v119, v119, v249
    v_sub_f32 v128, v128, v249
    v_sub_f32 v129, v129, v249
    v_sub_f32 v130, v130, v249
    v_sub_f32 v131, v131, v249
    v_sub_f32 v140, v140, v249
    v_sub_f32 v141, v141, v249
    v_sub_f32 v142, v142, v249
    v_sub_f32 v143, v143, v249
    v_sub_f32 v152, v152, v249
    v_sub_f32 v153, v153, v249
    v_sub_f32 v154, v154, v249
    v_sub_f32 v155, v155, v249
    v_sub_f32 v36, v36, v249
    v_sub_f32 v37, v37, v249
    v_sub_f32 v38, v38, v249
    v_sub_f32 v39, v39, v249
    v_sub_f32 v255, 0, v249
    v_exp_f32 v255, v255
    v_accvgpr_read_b32 v254, a4
    v_mul_f32 v254, v254, v255
    v_accvgpr_write_b32 a4, v254
    v_accvgpr_read_b32 v254, a5
    v_mul_f32 v254, v254, v255
    v_accvgpr_write_b32 a5, v254
    v_accvgpr_read_b32 v254, a6
    v_mul_f32 v254, v254, v255
    v_accvgpr_write_b32 a6, v254
    v_accvgpr_read_b32 v254, a7
    v_mul_f32 v254, v254, v255
    v_accvgpr_write_b32 a7, v254
    v_accvgpr_read_b32 v254, a16
    v_mul_f32 v254, v254, v255
    v_accvgpr_write_b32 a16, v254
    v_accvgpr_read_b32 v254, a17
    v_mul_f32 v254, v254, v255
    v_accvgpr_write_b32 a17, v254
    v_accvgpr_read_b32 v254, a18
    v_mul_f32 v254, v254, v255
    v_accvgpr_write_b32 a18, v254
    v_accvgpr_read_b32 v254, a19
    v_mul_f32 v254, v254, v255
    v_accvgpr_write_b32 a19, v254
    v_accvgpr_read_b32 v254, a28
    v_mul_f32 v254, v254, v255
    v_accvgpr_write_b32 a28, v254
    v_accvgpr_read_b32 v254, a29
    v_mul_f32 v254, v254, v255
    v_accvgpr_write_b32 a29, v254
    v_accvgpr_read_b32 v254, a30
    v_mul_f32 v254, v254, v255
    v_accvgpr_write_b32 a30, v254
    v_accvgpr_read_b32 v254, a31
    v_mul_f32 v254, v254, v255
    v_accvgpr_write_b32 a31, v254
    v_accvgpr_read_b32 v254, a40
    v_mul_f32 v254, v254, v255
    v_accvgpr_write_b32 a40, v254
    v_accvgpr_read_b32 v254, a41
    v_mul_f32 v254, v254, v255
    v_accvgpr_write_b32 a41, v254
    v_accvgpr_read_b32 v254, a42
    v_mul_f32 v254, v254, v255
    v_accvgpr_write_b32 a42, v254
    v_accvgpr_read_b32 v254, a43
    v_mul_f32 v254, v254, v255
    v_accvgpr_write_b32 a43, v254
    v_accvgpr_read_b32 v254, a52
    v_mul_f32 v254, v254, v255
    v_accvgpr_write_b32 a52, v254
    v_accvgpr_read_b32 v254, a53
    v_mul_f32 v254, v254, v255
    v_accvgpr_write_b32 a53, v254
    v_accvgpr_read_b32 v254, a54
    v_mul_f32 v254, v254, v255
    v_accvgpr_write_b32 a54, v254
    v_accvgpr_read_b32 v254, a55
    v_mul_f32 v254, v254, v255
    v_accvgpr_write_b32 a55, v254
    v_accvgpr_read_b32 v254, a64
    v_mul_f32 v254, v254, v255
    v_accvgpr_write_b32 a64, v254
    v_accvgpr_read_b32 v254, a65
    v_mul_f32 v254, v254, v255
    v_accvgpr_write_b32 a65, v254
    v_accvgpr_read_b32 v254, a66
    v_mul_f32 v254, v254, v255
    v_accvgpr_write_b32 a66, v254
    v_accvgpr_read_b32 v254, a67
    v_mul_f32 v254, v254, v255
    v_accvgpr_write_b32 a67, v254
    v_accvgpr_read_b32 v254, a76
    v_mul_f32 v254, v254, v255
    v_accvgpr_write_b32 a76, v254
    v_accvgpr_read_b32 v254, a77
    v_mul_f32 v254, v254, v255
    v_accvgpr_write_b32 a77, v254
    v_accvgpr_read_b32 v254, a78
    v_mul_f32 v254, v254, v255
    v_accvgpr_write_b32 a78, v254
    v_accvgpr_read_b32 v254, a79
    v_mul_f32 v254, v254, v255
    v_accvgpr_write_b32 a79, v254
    v_accvgpr_read_b32 v254, a88
    v_mul_f32 v254, v254, v255
    v_accvgpr_write_b32 a88, v254
    v_accvgpr_read_b32 v254, a89
    v_mul_f32 v254, v254, v255
    v_accvgpr_write_b32 a89, v254
    v_accvgpr_read_b32 v254, a90
    v_mul_f32 v254, v254, v255
    v_accvgpr_write_b32 a90, v254
    v_accvgpr_read_b32 v254, a91
    v_mul_f32 v254, v254, v255
    v_accvgpr_write_b32 a91, v254
    v_accvgpr_read_b32 v254, a100
    v_mul_f32 v254, v254, v255
    v_accvgpr_write_b32 a100, v254
    v_accvgpr_read_b32 v254, a101
    v_mul_f32 v254, v254, v255
    v_accvgpr_write_b32 a101, v254
    v_accvgpr_read_b32 v254, a102
    v_mul_f32 v254, v254, v255
    v_accvgpr_write_b32 a102, v254
    v_accvgpr_read_b32 v254, a103
    v_mul_f32 v254, v254, v255
    v_accvgpr_write_b32 a103, v254
    v_max3_f32 v250, v120, v121, v122
    v_max3_f32 v250, v250, v123, v132
    v_max3_f32 v250, v250, v133, v134
    v_max3_f32 v250, v250, v135, v144
    v_max3_f32 v250, v250, v145, v146
    v_max3_f32 v250, v250, v147, v156
    v_max3_f32 v250, v250, v157, v158
    v_max_f32 v250, v250, v159
    ds_bpermute_b32 v255, v252, v250
    s_waitcnt lgkmcnt(0)
    v_max_f32 v250, v250, v255
    ds_bpermute_b32 v255, v253, v250
    s_waitcnt lgkmcnt(0)
    v_max_f32 v250, v250, v255
    v_max_f32 v250, 0, v250
    v_sub_f32 v120, v120, v250
    v_sub_f32 v121, v121, v250
    v_sub_f32 v122, v122, v250
    v_sub_f32 v123, v123, v250
    v_sub_f32 v132, v132, v250
    v_sub_f32 v133, v133, v250
    v_sub_f32 v134, v134, v250
    v_sub_f32 v135, v135, v250
    v_sub_f32 v144, v144, v250
    v_sub_f32 v145, v145, v250
    v_sub_f32 v146, v146, v250
    v_sub_f32 v147, v147, v250
    v_sub_f32 v156, v156, v250
    v_sub_f32 v157, v157, v250
    v_sub_f32 v158, v158, v250
    v_sub_f32 v159, v159, v250
    v_sub_f32 v40, v40, v250
    v_sub_f32 v41, v41, v250
    v_sub_f32 v42, v42, v250
    v_sub_f32 v43, v43, v250
    v_sub_f32 v255, 0, v250
    v_exp_f32 v255, v255
    v_accvgpr_read_b32 v254, a8
    v_mul_f32 v254, v254, v255
    v_accvgpr_write_b32 a8, v254
    v_accvgpr_read_b32 v254, a9
    v_mul_f32 v254, v254, v255
    v_accvgpr_write_b32 a9, v254
    v_accvgpr_read_b32 v254, a10
    v_mul_f32 v254, v254, v255
    v_accvgpr_write_b32 a10, v254
    v_accvgpr_read_b32 v254, a11
    v_mul_f32 v254, v254, v255
    v_accvgpr_write_b32 a11, v254
    v_accvgpr_read_b32 v254, a20
    v_mul_f32 v254, v254, v255
    v_accvgpr_write_b32 a20, v254
    v_accvgpr_read_b32 v254, a21
    v_mul_f32 v254, v254, v255
    v_accvgpr_write_b32 a21, v254
    v_accvgpr_read_b32 v254, a22
    v_mul_f32 v254, v254, v255
    v_accvgpr_write_b32 a22, v254
    v_accvgpr_read_b32 v254, a23
    v_mul_f32 v254, v254, v255
    v_accvgpr_write_b32 a23, v254
    v_accvgpr_read_b32 v254, a32
    v_mul_f32 v254, v254, v255
    v_accvgpr_write_b32 a32, v254
    v_accvgpr_read_b32 v254, a33
    v_mul_f32 v254, v254, v255
    v_accvgpr_write_b32 a33, v254
    v_accvgpr_read_b32 v254, a34
    v_mul_f32 v254, v254, v255
    v_accvgpr_write_b32 a34, v254
    v_accvgpr_read_b32 v254, a35
    v_mul_f32 v254, v254, v255
    v_accvgpr_write_b32 a35, v254
    v_accvgpr_read_b32 v254, a44
    v_mul_f32 v254, v254, v255
    v_accvgpr_write_b32 a44, v254
    v_accvgpr_read_b32 v254, a45
    v_mul_f32 v254, v254, v255
    v_accvgpr_write_b32 a45, v254
    v_accvgpr_read_b32 v254, a46
    v_mul_f32 v254, v254, v255
    v_accvgpr_write_b32 a46, v254
    v_accvgpr_read_b32 v254, a47
    v_mul_f32 v254, v254, v255
    v_accvgpr_write_b32 a47, v254
    v_accvgpr_read_b32 v254, a56
    v_mul_f32 v254, v254, v255
    v_accvgpr_write_b32 a56, v254
    v_accvgpr_read_b32 v254, a57
    v_mul_f32 v254, v254, v255
    v_accvgpr_write_b32 a57, v254
    v_accvgpr_read_b32 v254, a58
    v_mul_f32 v254, v254, v255
    v_accvgpr_write_b32 a58, v254
    v_accvgpr_read_b32 v254, a59
    v_mul_f32 v254, v254, v255
    v_accvgpr_write_b32 a59, v254
    v_accvgpr_read_b32 v254, a68
    v_mul_f32 v254, v254, v255
    v_accvgpr_write_b32 a68, v254
    v_accvgpr_read_b32 v254, a69
    v_mul_f32 v254, v254, v255
    v_accvgpr_write_b32 a69, v254
    v_accvgpr_read_b32 v254, a70
    v_mul_f32 v254, v254, v255
    v_accvgpr_write_b32 a70, v254
    v_accvgpr_read_b32 v254, a71
    v_mul_f32 v254, v254, v255
    v_accvgpr_write_b32 a71, v254
    v_accvgpr_read_b32 v254, a80
    v_mul_f32 v254, v254, v255
    v_accvgpr_write_b32 a80, v254
    v_accvgpr_read_b32 v254, a81
    v_mul_f32 v254, v254, v255
    v_accvgpr_write_b32 a81, v254
    v_accvgpr_read_b32 v254, a82
    v_mul_f32 v254, v254, v255
    v_accvgpr_write_b32 a82, v254
    v_accvgpr_read_b32 v254, a83
    v_mul_f32 v254, v254, v255
    v_accvgpr_write_b32 a83, v254
    v_accvgpr_read_b32 v254, a92
    v_mul_f32 v254, v254, v255
    v_accvgpr_write_b32 a92, v254
    v_accvgpr_read_b32 v254, a93
    v_mul_f32 v254, v254, v255
    v_accvgpr_write_b32 a93, v254
    v_accvgpr_read_b32 v254, a94
    v_mul_f32 v254, v254, v255
    v_accvgpr_write_b32 a94, v254
    v_accvgpr_read_b32 v254, a95
    v_mul_f32 v254, v254, v255
    v_accvgpr_write_b32 a95, v254
    v_accvgpr_read_b32 v254, a104
    v_mul_f32 v254, v254, v255
    v_accvgpr_write_b32 a104, v254
    v_accvgpr_read_b32 v254, a105
    v_mul_f32 v254, v254, v255
    v_accvgpr_write_b32 a105, v254
    v_accvgpr_read_b32 v254, a106
    v_mul_f32 v254, v254, v255
    v_accvgpr_write_b32 a106, v254
    v_accvgpr_read_b32 v254, a107
    v_mul_f32 v254, v254, v255
    v_accvgpr_write_b32 a107, v254
    s_nop 7
    s_nop 7
    s_branch L_back6
.globl reduce_kernel
.p2align 8
.type reduce_kernel,@function
reduce_kernel:
    s_cmp_ge_u32 s2, 384
    s_cbranch_scc1 R_exit
    s_load_dwordx2 s[4:5], s[0:1], 80
    s_load_dwordx2 s[6:7], s[0:1], 96
    s_mul_i32 s20, s2, 0x1556
    s_lshr_b32 s20, s20, 16
    s_mul_i32 s21, s20, 12
    s_sub_u32 s21, s2, s21
    s_mul_i32 s26, s21, 11
    s_lshr_b32 s26, s26, 5
    s_mul_i32 s27, s26, 3
    s_sub_u32 s27, s21, s27
    v_lshlrev_b32 v3, 4, v0
    s_mul_i32 s23, s20, 0x60000
    s_mul_i32 s28, s26, 0x3000
    s_add_u32 s23, s23, s28
    s_lshl_b32 s28, s27, 12
    s_add_u32 s23, s23, s28
    v_and_b32 v1, 15, v0
    v_bfe_u32 v2, v0, 4, 2
    v_lshlrev_b32 v2, 6, v2
    v_lshl_add_u32 v4, v1, 11, v2
    v_lshrrev_b32 v2, 6, v0
    v_lshl_add_u32 v4, v2, 4, v4
    s_and_b32 s24, s20, 15
    s_mul_i32 s24, s24, 0x18000
    s_lshr_b32 s25, s20, 4
    s_lshl_b32 s25, s25, 10
    s_add_u32 s24, s24, s25
    s_lshl_b32 s25, s27, 15
    s_add_u32 s24, s24, s25
    s_lshl_b32 s25, s26, 8
    s_add_u32 s24, s24, s25
    s_waitcnt lgkmcnt(0)
    s_mov_b64 s[8:9], s[4:5]
    s_mov_b32 s10, 0x180000
    s_mov_b32 s11, 0x20000
    s_mov_b64 s[12:13], s[6:7]
    s_mov_b32 s14, 0xc00000
    s_mov_b32 s15, 0x20000
    buffer_load_dwordx4 v[8:11], v3, s[12:15], s23 offen
    s_add_u32 s23, s23, 0xc000
    buffer_load_dwordx4 v[12:15], v3, s[12:15], s23 offen
    s_add_u32 s23, s23, 0xc000
    buffer_load_dwordx4 v[16:19], v3, s[12:15], s23 offen
    s_add_u32 s23, s23, 0xc000
    buffer_load_dwordx4 v[20:23], v3, s[12:15], s23 offen
    s_add_u32 s23, s23, 0xc000
    buffer_load_dwordx4 v[24:27], v3, s[12:15], s23 offen
    s_add_u32 s23, s23, 0xc000
    buffer_load_dwordx4 v[28:31], v3, s[12:15], s23 offen
    s_add_u32 s23, s23, 0xc000
    buffer_load_dwordx4 v[32:35], v3, s[12:15], s23 offen
    s_add_u32 s23, s23, 0xc000
    buffer_load_dwordx4 v[36:39], v3, s[12:15], s23 offen
    s_mov_b32 s30, 0xffff0000
    s_waitcnt vmcnt(7)
    v_lshlrev_b32 v40, 16, v8
    v_and_b32 v41, s30, v8
    v_lshlrev_b32 v42, 16, v9
    v_and_b32 v43, s30, v9
    v_lshlrev_b32 v44, 16, v10
    v_and_b32 v45, s30, v10
    v_lshlrev_b32 v46, 16, v11
    v_and_b32 v47, s30, v11
    s_waitcnt vmcnt(6)
    v_lshlrev_b32 v48, 16, v12
    v_and_b32 v49, s30, v12
    v_add_f32 v40, v40, v48
    v_add_f32 v41, v41, v49
    v_lshlrev_b32 v50, 16, v13
    v_and_b32 v51, s30, v13
    v_add_f32 v42, v42, v50
    v_add_f32 v43, v43, v51
    v_lshlrev_b32 v48, 16, v14
    v_and_b32 v49, s30, v14
    v_add_f32 v44, v44, v48
    v_add_f32 v45, v45, v49
    v_lshlrev_b32 v50, 16, v15
    v_and_b32 v51, s30, v15
    v_add_f32 v46, v46, v50
    v_add_f32 v47, v47, v51
    s_waitcnt vmcnt(5)
    v_lshlrev_b32 v48, 16, v16
    v_and_b32 v49, s30, v16
    v_add_f32 v40, v40, v48
    v_add_f32 v41, v41, v49
    v_lshlrev_b32 v50, 16, v17
    v_and_b32 v51, s30, v17
    v_add_f32 v42, v42, v50
    v_add_f32 v43, v43, v51
    v_lshlrev_b32 v48, 16, v18
    v_and_b32 v49, s30, v18
    v_add_f32 v44, v44, v48
    v_add_f32 v45, v45, v49
    v_lshlrev_b32 v50, 16, v19
    v_and_b32 v51, s30, v19
    v_add_f32 v46, v46, v50
    v_add_f32 v47, v47, v51
    s_waitcnt vmcnt(4)
    v_lshlrev_b32 v48, 16, v20
    v_and_b32 v49, s30, v20
    v_add_f32 v40, v40, v48
    v_add_f32 v41, v41, v49
    v_lshlrev_b32 v50, 16, v21
    v_and_b32 v51, s30, v21
    v_add_f32 v42, v42, v50
    v_add_f32 v43, v43, v51
    v_lshlrev_b32 v48, 16, v22
    v_and_b32 v49, s30, v22
    v_add_f32 v44, v44, v48
    v_add_f32 v45, v45, v49
    v_lshlrev_b32 v50, 16, v23
    v_and_b32 v51, s30, v23
    v_add_f32 v46, v46, v50
    v_add_f32 v47, v47, v51
    s_waitcnt vmcnt(3)
    v_lshlrev_b32 v48, 16, v24
    v_and_b32 v49, s30, v24
    v_add_f32 v40, v40, v48
    v_add_f32 v41, v41, v49
    v_lshlrev_b32 v50, 16, v25
    v_and_b32 v51, s30, v25
    v_add_f32 v42, v42, v50
    v_add_f32 v43, v43, v51
    v_lshlrev_b32 v48, 16, v26
    v_and_b32 v49, s30, v26
    v_add_f32 v44, v44, v48
    v_add_f32 v45, v45, v49
    v_lshlrev_b32 v50, 16, v27
    v_and_b32 v51, s30, v27
    v_add_f32 v46, v46, v50
    v_add_f32 v47, v47, v51
    s_waitcnt vmcnt(2)
    v_lshlrev_b32 v48, 16, v28
    v_and_b32 v49, s30, v28
    v_add_f32 v40, v40, v48
    v_add_f32 v41, v41, v49
    v_lshlrev_b32 v50, 16, v29
    v_and_b32 v51, s30, v29
    v_add_f32 v42, v42, v50
    v_add_f32 v43, v43, v51
    v_lshlrev_b32 v48, 16, v30
    v_and_b32 v49, s30, v30
    v_add_f32 v44, v44, v48
    v_add_f32 v45, v45, v49
    v_lshlrev_b32 v50, 16, v31
    v_and_b32 v51, s30, v31
    v_add_f32 v46, v46, v50
    v_add_f32 v47, v47, v51
    s_waitcnt vmcnt(1)
    v_lshlrev_b32 v48, 16, v32
    v_and_b32 v49, s30, v32
    v_add_f32 v40, v40, v48
    v_add_f32 v41, v41, v49
    v_lshlrev_b32 v50, 16, v33
    v_and_b32 v51, s30, v33
    v_add_f32 v42, v42, v50
    v_add_f32 v43, v43, v51
    v_lshlrev_b32 v48, 16, v34
    v_and_b32 v49, s30, v34
    v_add_f32 v44, v44, v48
    v_add_f32 v45, v45, v49
    v_lshlrev_b32 v50, 16, v35
    v_and_b32 v51, s30, v35
    v_add_f32 v46, v46, v50
    v_add_f32 v47, v47, v51
    s_waitcnt vmcnt(0)
    v_lshlrev_b32 v48, 16, v36
    v_and_b32 v49, s30, v36
    v_add_f32 v40, v40, v48
    v_add_f32 v41, v41, v49
    v_lshlrev_b32 v50, 16, v37
    v_and_b32 v51, s30, v37
    v_add_f32 v42, v42, v50
    v_add_f32 v43, v43, v51
    v_lshlrev_b32 v48, 16, v38
    v_and_b32 v49, s30, v38
    v_add_f32 v44, v44, v48
    v_add_f32 v45, v45, v49
    v_lshlrev_b32 v50, 16, v39
    v_and_b32 v51, s30, v39
    v_add_f32 v46, v46, v50
    v_add_f32 v47, v47, v51
    v_cvt_pk_bf16_f32 v8, v40, v41
    v_cvt_pk_bf16_f32 v9, v42, v43
    v_cvt_pk_bf16_f32 v10, v44, v45
    v_cvt_pk_bf16_f32 v11, v46, v47
    buffer_store_dwordx4 v[8:11], v4, s[8:11], s24 offen
R_exit:
    s_endpgm
.section .rodata,"a"
.p2align 6
.amdhsa_kernel concat_heads__gqa_block_cached__gqa_block_cached__near_ridge_kernel
  .amdhsa_next_free_vgpr 512
  .amdhsa_next_free_sgpr 96
  .amdhsa_accum_offset 256
  .amdhsa_group_segment_fixed_size 0
  .amdhsa_kernarg_size 104
  .amdhsa_user_sgpr_count 2
  .amdhsa_user_sgpr_kernarg_segment_ptr 1
  .amdhsa_system_sgpr_workgroup_id_x 1
.end_amdhsa_kernel
.p2align 6
.amdhsa_kernel reduce_kernel
  .amdhsa_next_free_vgpr 56
  .amdhsa_next_free_sgpr 32
  .amdhsa_accum_offset 56
  .amdhsa_group_segment_fixed_size 0
  .amdhsa_kernarg_size 104
  .amdhsa_user_sgpr_count 2
  .amdhsa_user_sgpr_kernarg_segment_ptr 1
  .amdhsa_system_sgpr_workgroup_id_x 1
.end_amdhsa_kernel
```
